```python
import torch

def _softmax(x, axis=-1):
    return torch.softmax(x, dim=axis)

def _gelu(x):
    return torch.nn.functional.gelu(x, approximate='tanh')

def _silu(x):
    return torch.nn.functional.silu(x)

def _sigmoid(x):
    return torch.sigmoid(x)

def _layernorm(x, axis=-1, eps=1e-05):
    m = x.mean(dim=axis, keepdim=True)
    v = x.var(dim=axis, keepdim=True, unbiased=False)
    return (x - m) / torch.sqrt(v + eps)

def _scatter_add(tgt, idx, src, axis=0):
    return tgt.clone().index_add_(axis, idx, src)

def _segment_sum(src, seg, n):
    out = torch.zeros((n,) + src.shape[1:], dtype=src.dtype)
    return out.index_add_(0, seg, src)

def _pad(x, pw):
    flat = tuple((v for pair in reversed(pw) for v in pair))
    return torch.nn.functional.pad(x, flat)
kernel_name = 'parallel_sum__sliding_local_dilated__mixer_gmlp__prompt'

def setup_inputs():

    _w = lambda a: (lambda t: t.to(torch.bfloat16) if t.is_floating_point() else t)(torch.as_tensor(a))

    def _A_setup():
        B, S, D = (1, 2048, 448)
        return {'x': _w((lambda *s: torch.randn(*s, dtype=torch.bfloat16) * 0.05)(B, S, D)), 'wqkv': _w((lambda *s: torch.randn(*s, dtype=torch.bfloat16) * 0.1)(D, 3 * D)), 'wo': _w((lambda *s: torch.randn(*s, dtype=torch.bfloat16) * 0.05)(D, D))}
    _A_in = _A_setup()

    def _B_setup():
        B, S, D, F = (1, 2048, 448, 1792)
        Fh = F // 2
        return {'x': _w((lambda *s: torch.randn(*s, dtype=torch.bfloat16) * 0.05)(B, S, D)), 'w_in': _w((lambda *s: torch.randn(*s, dtype=torch.bfloat16) * 0.4)(D, 2 * Fh)), 'w_sp': _w(0.01 * (lambda *s: torch.randn(*s, dtype=torch.bfloat16) * 0.4)(S, S)), 'b_sp': _w(1.0 + 0.01 * (lambda *s: torch.randn(*s, dtype=torch.bfloat16) * 0.05)(S)), 'w_out': _w((lambda *s: torch.randn(*s, dtype=torch.bfloat16) * 0.05)(Fh, D))}
    _B_in = _B_setup()
    return {'A_x': _A_in['x'], 'A_wqkv': _A_in['wqkv'], 'A_wo': _A_in['wo'], 'B_x': _B_in['x'], 'B_w_in': _B_in['w_in'], 'B_w_sp': _B_in['w_sp'], 'B_b_sp': _B_in['b_sp'], 'B_w_out': _B_in['w_out']}

def reference(A_x, A_wqkv, A_wo, B_x, B_w_in, B_w_sp, B_b_sp, B_w_out):

    def _A_ref(x, wqkv, wo):
        B, S, D = x.shape
        H = 16
        Dh = D // H
        W, dil = (8, 2)
        qkv = (lambda x, *d: x.permute(*d))((x @ wqkv).reshape(B, S, 3, H, Dh), 2, 0, 3, 1, 4)
        q, k, v = (qkv[0], qkv[1], qkv[2])
        scale = Dh ** (-0.5)
        pos = torch.arange(S)
        off = torch.arange(W) * dil
        idx = pos[:, None] - off[None, :]
        mask = idx >= 0
        idx_c = torch.where(mask, idx, 0).reshape(-1)
        kg = k[:, :, idx_c, :].reshape(B, H, S, W, Dh)
        vg = v[:, :, idx_c, :].reshape(B, H, S, W, Dh)
        logits = torch.einsum('bhsd,bhswd->bhsw', q, kg) * scale
        logits = torch.where(mask[None, None, :, :], logits, -1000000000.0)
        attn = _softmax(logits, axis=-1)
        o = torch.einsum('bhsw,bhswd->bhsd', attn, vg)
        return (lambda x, *d: x.permute(*d))(o, 0, 2, 1, 3).reshape(B, S, D) @ wo

    def _B_ref(x, w_in, w_sp, b_sp, w_out):
        B, S, D = x.shape
        F = w_in.shape[-1]
        Fh = F // 2
        z = _gelu(torch.einsum('bsd,df->bsf', x, w_in))
        z1 = z[..., :Fh].clone()
        z2 = _layernorm(z[..., Fh:], axis=-1)
        g = torch.einsum('ts,bsf->btf', w_sp, z2) + b_sp[None, :, None]
        return torch.einsum('bsf,fd->bsd', z1 * g, w_out)
    x = A_x
    xn = _layernorm(x, axis=-1)
    return x + _A_ref(xn, A_wqkv, A_wo) + _B_ref(xn, B_w_in, B_w_sp, B_b_sp, B_w_out)
```

```asm
; @launch grid=(256,1,1) block=(768,1,1) lds=163840
.amdgcn_target "amdgcn-amd-amdhsa--gfx950"
.text
.globl parallel_sum__sliding_local_dilated__mixer_gmlp__prompt_kernel
.p2align 8
.type parallel_sum__sliding_local_dilated__mixer_gmlp__prompt_kernel,@function
parallel_sum__sliding_local_dilated__mixer_gmlp__prompt_kernel:
    s_cmp_ge_u32 s2, 256
    s_cbranch_scc1 f_end
    s_load_dwordx16 s[8:23], s[0:1], 0
    s_load_dwordx4 s[24:27], s[0:1], 64
    s_load_dwordx2 s[28:29], s[0:1], 80
    v_lshrrev_b32 v1, 6, v0
    v_and_b32 v0, 63, v0
    v_readfirstlane_b32 s3, v1
    s_lshr_b32 s64, s2, 3
    s_and_b32 s54, s2, 1
    s_lshl_b32 s54, s54, 2
    s_and_b32 s52, s64, 3
    s_add_u32 s54, s54, s52
    s_bfe_u32 s52, s64, 0x10004
    s_xor_b32 s52, s52, 1
    s_lshl_b32 s52, s52, 3
    s_add_u32 s53, s54, s52
    s_bfe_u32 s64, s64, 0x20002
    s_bfe_u32 s52, s2, 0x20001
    s_lshl_b32 s52, s52, 2
    s_add_u32 s52, s52, s64
    s_bfe_u32 s6, s2, 0x10002
    s_bfe_u32 s64, s2, 0x20003
    s_and_b32 s4, s2, 3
    s_lshl_b32 s4, s4, 2
    s_add_u32 s4, s4, s64
    s_lshr_b32 s5, s2, 5
    s_and_b32 s7, s2, 7
    s_lshl_b32 s7, s7, 2
    s_add_u32 s7, s7, s64
    s_mov_b32 s30, s5
    s_cmp_ge_u32 s3, 8
    s_cbranch_scc1 f_load
    s_cmp_ge_u32 s53, 8
    s_cbranch_scc1 f_cB
    s_waitcnt lgkmcnt(0)
    s_mov_b32 s32, s8
    s_mov_b32 s33, s9
    s_mov_b32 s34, 0x1c0000
    s_mov_b32 s35, 0x20000
    s_mov_b32 s36, s10
    s_mov_b32 s37, s11
    s_mov_b32 s38, 0x126000
    s_mov_b32 s39, 0x20000
    s_mov_b32 s44, s28
    s_mov_b32 s45, s29
    s_mov_b32 s46, 0x1600000
    s_mov_b32 s47, 0x20000
    s_mov_b32 s48, s26
    s_mov_b32 s49, s27
    s_mov_b32 s50, 0x100
    s_mov_b32 s51, 0x20000
    s_and_b32 s57, s3, 3
    s_lshr_b32 s56, s3, 2
    s_lshl_b32 s64, s54, 1
    s_add_u32 s56, s56, s64
    v_mov_b32 v7, 0
    s_or_b32 s72, s2, s3
    s_cmp_lg_u32 s72, 0
    s_cbranch_scc1 p1Ac0_non
    s_memrealtime s[74:75]
    s_waitcnt lgkmcnt(0)
    s_or_b32 s74, s74, 1
    v_mov_b32 v8, s74
    v_mov_b32 v9, s75
    s_mov_b64 exec, 1
    buffer_store_dwordx2 v[8:9], v7, s[48:51], 0 offen sc1
    s_mov_b64 exec, -1
p1Ac0_non:
    s_cmp_ge_u32 s3, 4
    s_cbranch_scc1 p1Ac0_ldh
    s_cmp_ge_u32 s52, 12
    s_cbranch_scc1 p1Ac0_cl
    s_lshr_b32 s64, s52, 2
    s_mul_i32 s64, s64, 896
    s_mul_i32 s65, s54, 112
    s_add_u32 s64, s64, s65
    s_bfe_u32 s65, s52, 0x10001
    s_mul_i32 s65, s65, 56
    s_add_u32 s64, s64, s65
    s_and_b32 s65, s52, 1
    s_lshl_b32 s65, s65, 5
    s_add_u32 s64, s64, s65
    s_mul_i32 s66, s57, 301056
    s_add_u32 s64, s64, s66
    v_lshrrev_b32 v84, 1, v0
    v_mul_u32_u24 v84, 2688, v84
    v_and_b32 v85, 1, v0
    v_lshl_add_u32 v84, v85, 4, v84
    buffer_load_dwordx4 v[68:71], v84, s[36:39], s64 offen
    s_add_u32 s64, s64, 86016
    buffer_load_dwordx4 v[72:75], v84, s[36:39], s64 offen
    s_add_u32 s64, s64, 86016
    buffer_load_dwordx4 v[76:79], v84, s[36:39], s64 offen
    s_add_u32 s64, s64, 86016
    v_mov_b32 v85, 0x7ff00000
    v_cmp_gt_u32 vcc, 32, v0
    s_nop 1
    v_cndmask_b32 v84, v85, v84, vcc
    buffer_load_dwordx4 v[80:83], v84, s[36:39], s64 offen
p1Ac0_cl:
    s_branch p1Ac0_lde
p1Ac0_ldh:
    s_lshl_b32 s64, s52, 4
    s_add_u32 s64, s64, s53
    s_lshl_b32 s64, s64, 2
    s_add_u32 s64, s64, s57
    s_mul_i32 s64, s64, 1792
    v_lshlrev_b32 v84, 4, v0
    v_mov_b32 v85, 0x7ff00000
    v_cmp_gt_u32 vcc, 56, v0
    s_nop 1
    v_cndmask_b32 v84, v85, v84, vcc
    buffer_load_dwordx4 v[60:63], v84, s[32:35], s64 offen
    buffer_load_dwordx4 v[64:67], v84, s[32:35], s64 offen offset:896
p1Ac0_lde:
    s_waitcnt vmcnt(0)
    s_cmp_ge_u32 s3, 4
    s_cbranch_scc1 p1Ac0_cph
    s_cmp_ge_u32 s52, 12
    s_cbranch_scc1 p1Ac0_cc
    v_mov_b32 v60, 0x00003f80
    v_mov_b32 v61, 0x3f800000
    v_mov_b32 v88, 0
    v_mov_b32 v89, 0
    v_mov_b32 v90, 0
    v_mov_b32 v91, 0
    v_mov_b32 v92, 0
    v_mov_b32 v93, 0
    v_mov_b32 v94, 0
    v_mov_b32 v95, 0
    v_dot2_f32_bf16 v88, v68, v60, v88
    v_dot2_f32_bf16 v89, v68, v61, v89
    v_dot2_f32_bf16 v90, v69, v60, v90
    v_dot2_f32_bf16 v91, v69, v61, v91
    v_dot2_f32_bf16 v92, v70, v60, v92
    v_dot2_f32_bf16 v93, v70, v61, v93
    v_dot2_f32_bf16 v94, v71, v60, v94
    v_dot2_f32_bf16 v95, v71, v61, v95
    v_dot2_f32_bf16 v88, v72, v60, v88
    v_dot2_f32_bf16 v89, v72, v61, v89
    v_dot2_f32_bf16 v90, v73, v60, v90
    v_dot2_f32_bf16 v91, v73, v61, v91
    v_dot2_f32_bf16 v92, v74, v60, v92
    v_dot2_f32_bf16 v93, v74, v61, v93
    v_dot2_f32_bf16 v94, v75, v60, v94
    v_dot2_f32_bf16 v95, v75, v61, v95
    v_dot2_f32_bf16 v88, v76, v60, v88
    v_dot2_f32_bf16 v89, v76, v61, v89
    v_dot2_f32_bf16 v90, v77, v60, v90
    v_dot2_f32_bf16 v91, v77, v61, v91
    v_dot2_f32_bf16 v92, v78, v60, v92
    v_dot2_f32_bf16 v93, v78, v61, v93
    v_dot2_f32_bf16 v94, v79, v60, v94
    v_dot2_f32_bf16 v95, v79, v61, v95
    v_dot2_f32_bf16 v88, v80, v60, v88
    v_dot2_f32_bf16 v89, v80, v61, v89
    v_dot2_f32_bf16 v90, v81, v60, v90
    v_dot2_f32_bf16 v91, v81, v61, v91
    v_dot2_f32_bf16 v92, v82, v60, v92
    v_dot2_f32_bf16 v93, v82, v61, v93
    v_dot2_f32_bf16 v94, v83, v60, v94
    v_dot2_f32_bf16 v95, v83, v61, v95
    v_add_f32_dpp v88, v88, v88 row_ror:8 row_mask:0xf bank_mask:0xf
    v_add_f32_dpp v89, v89, v89 row_ror:8 row_mask:0xf bank_mask:0xf
    v_add_f32_dpp v90, v90, v90 row_ror:8 row_mask:0xf bank_mask:0xf
    v_add_f32_dpp v91, v91, v91 row_ror:8 row_mask:0xf bank_mask:0xf
    v_add_f32_dpp v92, v92, v92 row_ror:8 row_mask:0xf bank_mask:0xf
    v_add_f32_dpp v93, v93, v93 row_ror:8 row_mask:0xf bank_mask:0xf
    v_add_f32_dpp v94, v94, v94 row_ror:8 row_mask:0xf bank_mask:0xf
    v_add_f32_dpp v95, v95, v95 row_ror:8 row_mask:0xf bank_mask:0xf
    v_add_f32_dpp v88, v88, v88 row_ror:4 row_mask:0xf bank_mask:0xf
    v_add_f32_dpp v89, v89, v89 row_ror:4 row_mask:0xf bank_mask:0xf
    v_add_f32_dpp v90, v90, v90 row_ror:4 row_mask:0xf bank_mask:0xf
    v_add_f32_dpp v91, v91, v91 row_ror:4 row_mask:0xf bank_mask:0xf
    v_add_f32_dpp v92, v92, v92 row_ror:4 row_mask:0xf bank_mask:0xf
    v_add_f32_dpp v93, v93, v93 row_ror:4 row_mask:0xf bank_mask:0xf
    v_add_f32_dpp v94, v94, v94 row_ror:4 row_mask:0xf bank_mask:0xf
    v_add_f32_dpp v95, v95, v95 row_ror:4 row_mask:0xf bank_mask:0xf
    v_add_f32_dpp v88, v88, v88 row_ror:2 row_mask:0xf bank_mask:0xf
    v_add_f32_dpp v89, v89, v89 row_ror:2 row_mask:0xf bank_mask:0xf
    v_add_f32_dpp v90, v90, v90 row_ror:2 row_mask:0xf bank_mask:0xf
    v_add_f32_dpp v91, v91, v91 row_ror:2 row_mask:0xf bank_mask:0xf
    v_add_f32_dpp v92, v92, v92 row_ror:2 row_mask:0xf bank_mask:0xf
    v_add_f32_dpp v93, v93, v93 row_ror:2 row_mask:0xf bank_mask:0xf
    v_add_f32_dpp v94, v94, v94 row_ror:2 row_mask:0xf bank_mask:0xf
    v_add_f32_dpp v95, v95, v95 row_ror:2 row_mask:0xf bank_mask:0xf
    v_mov_b32 v62, v88
    v_mov_b32 v63, v89
    v_mov_b32 v64, v90
    v_mov_b32 v65, v91
    v_mov_b32 v66, v92
    v_mov_b32 v67, v93
    v_mov_b32 v68, v94
    v_mov_b32 v69, v95
    v_permlane16_swap_b32 v88, v62
    v_permlane16_swap_b32 v89, v63
    v_permlane16_swap_b32 v90, v64
    v_permlane16_swap_b32 v91, v65
    v_permlane16_swap_b32 v92, v66
    v_permlane16_swap_b32 v93, v67
    v_permlane16_swap_b32 v94, v68
    v_permlane16_swap_b32 v95, v69
    v_add_f32 v88, v88, v62
    v_add_f32 v89, v89, v63
    v_add_f32 v90, v90, v64
    v_add_f32 v91, v91, v65
    v_add_f32 v92, v92, v66
    v_add_f32 v93, v93, v67
    v_add_f32 v94, v94, v68
    v_add_f32 v95, v95, v69
    v_mov_b32 v62, v88
    v_mov_b32 v63, v89
    v_mov_b32 v64, v90
    v_mov_b32 v65, v91
    v_mov_b32 v66, v92
    v_mov_b32 v67, v93
    v_mov_b32 v68, v94
    v_mov_b32 v69, v95
    v_permlane32_swap_b32 v88, v62
    v_permlane32_swap_b32 v89, v63
    v_permlane32_swap_b32 v90, v64
    v_permlane32_swap_b32 v91, v65
    v_permlane32_swap_b32 v92, v66
    v_permlane32_swap_b32 v93, v67
    v_permlane32_swap_b32 v94, v68
    v_permlane32_swap_b32 v95, v69
    v_add_f32 v88, v88, v62
    v_add_f32 v89, v89, v63
    v_add_f32 v90, v90, v64
    v_add_f32 v91, v91, v65
    v_add_f32 v92, v92, v66
    v_add_f32 v93, v93, v67
    v_add_f32 v94, v94, v68
    v_add_f32 v95, v95, v69
    v_lshrrev_b32 v62, 1, v0
    v_cmp_eq_u32 vcc, 1, v62
    s_nop 1
    v_cndmask_b32 v88, v88, v90, vcc
    v_cndmask_b32 v89, v89, v91, vcc
    v_cmp_eq_u32 vcc, 2, v62
    s_nop 1
    v_cndmask_b32 v88, v88, v92, vcc
    v_cndmask_b32 v89, v89, v93, vcc
    v_cmp_eq_u32 vcc, 3, v62
    s_nop 1
    v_cndmask_b32 v88, v88, v94, vcc
    v_cndmask_b32 v89, v89, v95, vcc
p1Ac0_cc:
    s_branch p1Ac0_cpe
p1Ac0_cph:
    v_mov_b32 v84, 0x3f803f80
    v_mov_b32 v90, 0
    v_mov_b32 v91, 0
    v_mov_b32 v92, 0
    v_mov_b32 v93, 0
    v_dot2_f32_bf16 v90, v60, v84, v90
    v_dot2_f32_bf16 v91, v60, v60, v91
    v_dot2_f32_bf16 v92, v64, v84, v92
    v_dot2_f32_bf16 v93, v64, v64, v93
    v_dot2_f32_bf16 v90, v61, v84, v90
    v_dot2_f32_bf16 v91, v61, v61, v91
    v_dot2_f32_bf16 v92, v65, v84, v92
    v_dot2_f32_bf16 v93, v65, v65, v93
    v_dot2_f32_bf16 v90, v62, v84, v90
    v_dot2_f32_bf16 v91, v62, v62, v91
    v_dot2_f32_bf16 v92, v66, v84, v92
    v_dot2_f32_bf16 v93, v66, v66, v93
    v_dot2_f32_bf16 v90, v63, v84, v90
    v_dot2_f32_bf16 v91, v63, v63, v91
    v_dot2_f32_bf16 v92, v67, v84, v92
    v_dot2_f32_bf16 v93, v67, v67, v93
    v_add_f32_dpp v90, v90, v90 row_ror:8 row_mask:0xf bank_mask:0xf
    v_add_f32_dpp v91, v91, v91 row_ror:8 row_mask:0xf bank_mask:0xf
    v_add_f32_dpp v92, v92, v92 row_ror:8 row_mask:0xf bank_mask:0xf
    v_add_f32_dpp v93, v93, v93 row_ror:8 row_mask:0xf bank_mask:0xf
    v_add_f32_dpp v90, v90, v90 row_ror:4 row_mask:0xf bank_mask:0xf
    v_add_f32_dpp v91, v91, v91 row_ror:4 row_mask:0xf bank_mask:0xf
    v_add_f32_dpp v92, v92, v92 row_ror:4 row_mask:0xf bank_mask:0xf
    v_add_f32_dpp v93, v93, v93 row_ror:4 row_mask:0xf bank_mask:0xf
    v_add_f32_dpp v90, v90, v90 row_ror:2 row_mask:0xf bank_mask:0xf
    v_add_f32_dpp v91, v91, v91 row_ror:2 row_mask:0xf bank_mask:0xf
    v_add_f32_dpp v92, v92, v92 row_ror:2 row_mask:0xf bank_mask:0xf
    v_add_f32_dpp v93, v93, v93 row_ror:2 row_mask:0xf bank_mask:0xf
    v_add_f32_dpp v90, v90, v90 row_ror:1 row_mask:0xf bank_mask:0xf
    v_add_f32_dpp v91, v91, v91 row_ror:1 row_mask:0xf bank_mask:0xf
    v_add_f32_dpp v92, v92, v92 row_ror:1 row_mask:0xf bank_mask:0xf
    v_add_f32_dpp v93, v93, v93 row_ror:1 row_mask:0xf bank_mask:0xf
    v_mov_b32 v68, v90
    v_mov_b32 v69, v91
    v_mov_b32 v70, v92
    v_mov_b32 v71, v93
    v_permlane16_swap_b32 v90, v68
    v_permlane16_swap_b32 v91, v69
    v_permlane16_swap_b32 v92, v70
    v_permlane16_swap_b32 v93, v71
    v_add_f32 v90, v90, v68
    v_add_f32 v91, v91, v69
    v_add_f32 v92, v92, v70
    v_add_f32 v93, v93, v71
    v_mov_b32 v68, v90
    v_mov_b32 v69, v91
    v_mov_b32 v70, v92
    v_mov_b32 v71, v93
    v_permlane32_swap_b32 v90, v68
    v_permlane32_swap_b32 v91, v69
    v_permlane32_swap_b32 v92, v70
    v_permlane32_swap_b32 v93, v71
    v_add_f32 v90, v90, v68
    v_add_f32 v91, v91, v69
    v_add_f32 v92, v92, v70
    v_add_f32 v93, v93, v71
    v_cmp_eq_u32 vcc, 1, v0
    s_nop 1
    v_cndmask_b32 v90, v90, v92, vcc
    v_cndmask_b32 v91, v91, v93, vcc
    v_mul_f32 v90, 0x3b124925, v90
    v_mul_f32 v91, 0x3b124925, v91
    v_fma_f32 v91, -v90, v90, v91
    v_max_f32 v91, 0, v91
    v_add_f32 v91, 0x3727c5ac, v91
    v_rsq_f32 v86, v91
    s_nop 0
    v_mul_f32 v87, v90, v86
    v_sub_f32 v87, 0, v87
p1Ac0_cpe:
    s_lshr_b32 s64, s2, 3
    s_lshr_b32 s65, s3, 1
    s_mov_b32 s92, 4
    s_cmp_eq_u32 s65, 1
    s_cselect_b32 s92, 4, s92
    s_cmp_eq_u32 s65, 2
    s_cselect_b32 s92, 3, s92
    s_cmp_eq_u32 s65, 3
    s_cselect_b32 s92, 6, s92
    s_mov_b32 s94, 0x7ff00000
    s_cmp_ge_u32 s3, 4
    s_cbranch_scc1 p1Ac0_t4
    s_mov_b32 s40, s18
    s_mov_b32 s41, s19
    s_mov_b32 s42, 0x800000
    s_mov_b32 s43, 0x20000
    s_and_b32 s65, s2, 3
    s_lshl_b32 s65, s65, 9
    s_lshl_b32 s66, s64, 4
    s_add_u32 s65, s65, s66
    s_lshl_b32 s66, s3, 2
    s_add_u32 s65, s65, s66
    s_lshl_b32 s65, s65, 12
    s_lshl_b32 s66, s6, 11
    s_add_u32 s93, s65, s66
    v_lshrrev_b32 v161, 4, v0
    v_lshlrev_b32 v161, 12, v161
    v_and_b32 v160, 15, v0
    v_lshl_add_u32 v161, v160, 7, v161
    s_sub_u32 s94, s93, 1048576
    s_branch p1Ac0_te
p1Ac0_t4:
    v_lshlrev_b32 v161, 7, v0
    s_cmp_ge_u32 s3, 6
    s_cbranch_scc1 p1Ac0_t6
    s_mov_b32 s40, s12
    s_mov_b32 s41, s13
    s_mov_b32 s42, 0x62000
    s_mov_b32 s43, 0x20000
    s_lshl_b32 s65, s64, 14
    s_and_b32 s66, s3, 1
    s_lshl_b32 s66, s66, 13
    s_add_u32 s93, s65, s66
    s_sub_u32 s94, s93, 262144
    s_branch p1Ac0_te
p1Ac0_t6:
    s_mov_b32 s40, s22
    s_mov_b32 s41, s23
    s_mov_b32 s42, 0xc4000
    s_mov_b32 s43, 0x20000
    s_lshl_b32 s65, s64, 15
    s_and_b32 s66, s3, 1
    s_lshl_b32 s66, s66, 14
    s_add_u32 s93, s65, s66
    s_add_u32 s94, s93, 8192
    s_sub_u32 s95, s93, 524288
    s_sub_u32 s91, s94, 524288
p1Ac0_te:
    v_and_b32 v8, 15, v0
    v_lshrrev_b32 v9, 4, v0
    v_lshrrev_b32 v10, 1, v8
    v_xor_b32 v10, v10, v9
    v_lshlrev_b32 v10, 4, v10
    v_lshl_add_u32 v10, v8, 7, v10
    s_lshl_b32 s72, s57, 12
    v_add_u32 v2, s72, v10
    v_xor_b32 v3, 64, v2
    v_lshrrev_b32 v10, 2, v8
    v_lshl_add_u32 v10, v9, 2, v10
    v_and_b32 v11, 3, v8
    v_lshlrev_b32 v11, 3, v11
    v_mul_u32_u24 v12, 384, v10
    v_add_u32 v12, v12, v11
    v_add_u32 v12, 55296, v12
    v_and_b32 v11, 1, v9
    v_lshlrev_b32 v11, 1, v11
    v_lshrrev_b32 v13, 3, v8
    v_add_u32 v11, v11, v13
    s_lshr_b32 s72, s3, 2
    s_lshl_b32 s72, s72, 1
    v_xor_b32 v11, s72, v11
    v_lshl_add_u32 v4, v11, 5, v12
    v_xor_b32 v11, 1, v11
    v_lshl_add_u32 v5, v11, 5, v12
    s_mov_b32 s36, s20
    s_mov_b32 s37, s21
    s_mov_b32 s38, 0x1000
    s_mov_b32 s39, 0x20000
    v_and_b32 v162, 15, v0
    v_lshlrev_b32 v162, 1, v162
    s_lshl_b32 s64, s4, 8
    s_lshl_b32 s65, s57, 6
    s_add_u32 s64, s64, s65
    buffer_load_ushort v163, v162, s[36:39], s64 offen offset:32
    buffer_load_ushort v162, v162, s[36:39], s64 offen
    v_mov_b32 v96, 0
    v_mov_b32 v97, 0
    v_mov_b32 v98, 0
    v_mov_b32 v99, 0
    v_mov_b32 v100, 0
    v_mov_b32 v101, 0
    v_mov_b32 v102, 0
    v_mov_b32 v103, 0
    v_mov_b32 v104, 0
    v_mov_b32 v105, 0
    v_mov_b32 v106, 0
    v_mov_b32 v107, 0
    v_mov_b32 v108, 0
    v_mov_b32 v109, 0
    v_mov_b32 v110, 0
    v_mov_b32 v111, 0
    v_mov_b32 v112, 0
    v_mov_b32 v113, 0
    v_mov_b32 v114, 0
    v_mov_b32 v115, 0
    v_mov_b32 v116, 0
    v_mov_b32 v117, 0
    v_mov_b32 v118, 0
    v_mov_b32 v119, 0
    v_mov_b32 v120, 0
    v_mov_b32 v121, 0
    v_mov_b32 v122, 0
    v_mov_b32 v123, 0
    v_mov_b32 v124, 0
    v_mov_b32 v125, 0
    v_mov_b32 v126, 0
    v_mov_b32 v127, 0
    v_mov_b32 v128, 0
    v_mov_b32 v129, 0
    v_mov_b32 v130, 0
    v_mov_b32 v131, 0
    v_mov_b32 v132, 0
    v_mov_b32 v133, 0
    v_mov_b32 v134, 0
    v_mov_b32 v135, 0
    v_mov_b32 v136, 0
    v_mov_b32 v137, 0
    v_mov_b32 v138, 0
    v_mov_b32 v139, 0
    v_mov_b32 v140, 0
    v_mov_b32 v141, 0
    v_mov_b32 v142, 0
    v_mov_b32 v143, 0
    v_mov_b32 v144, 0
    v_mov_b32 v145, 0
    v_mov_b32 v146, 0
    v_mov_b32 v147, 0
    v_mov_b32 v148, 0
    v_mov_b32 v149, 0
    v_mov_b32 v150, 0
    v_mov_b32 v151, 0
    v_mov_b32 v152, 0
    v_mov_b32 v153, 0
    v_mov_b32 v154, 0
    v_mov_b32 v155, 0
    v_mov_b32 v156, 0
    v_mov_b32 v157, 0
    v_mov_b32 v158, 0
    v_mov_b32 v159, 0
    s_mov_b32 s70, 18432
    s_mov_b32 s71, -36864
    s_mov_b32 s72, 24576
    s_mov_b32 s73, -49152
    s_mov_b32 s59, 0
    s_mov_b32 s58, 7
    s_waitcnt lgkmcnt(0)
    s_barrier
    ds_read_b128 v[8:11], v2 offset:0
    ds_read_b128 v[12:15], v2 offset:2048
    ds_read_b128 v[16:19], v2 offset:4096
    ds_read_b64_tr_b16 v[32:33], v4 offset:0
    ds_read_b64_tr_b16 v[34:35], v4 offset:6144
    ds_read_b64_tr_b16 v[36:37], v5 offset:0
    ds_read_b64_tr_b16 v[38:39], v5 offset:6144
    ds_read_b64_tr_b16 v[40:41], v4 offset:128
    ds_read_b64_tr_b16 v[42:43], v4 offset:6272
    ds_read_b64_tr_b16 v[44:45], v5 offset:128
    ds_read_b64_tr_b16 v[46:47], v5 offset:6272
    ds_read_b64_tr_b16 v[48:49], v4 offset:256
    ds_read_b64_tr_b16 v[50:51], v4 offset:6400
    ds_read_b64_tr_b16 v[52:53], v5 offset:256
    ds_read_b64_tr_b16 v[54:55], v5 offset:6400
p1Ac0_loop:
    ds_read_b128 v[20:23], v3 offset:0
    ds_read_b128 v[24:27], v3 offset:2048
    ds_read_b128 v[28:31], v3 offset:4096
    s_waitcnt lgkmcnt(15)
    s_waitcnt lgkmcnt(13)
    v_mfma_f32_16x16x32_bf16 v[96:99], v[32:35], v[12:15], v[96:99]
    v_mfma_f32_16x16x32_bf16 v[100:103], v[32:35], v[16:19], v[100:103]
    ds_read_b64_tr_b16 v[32:33], v4 offset:12288
    ds_read_b64_tr_b16 v[34:35], v4 offset:18432
    s_waitcnt lgkmcnt(13)
    v_mfma_f32_16x16x32_bf16 v[104:107], v[36:39], v[12:15], v[104:107]
    v_mfma_f32_16x16x32_bf16 v[108:111], v[36:39], v[16:19], v[108:111]
    ds_read_b64_tr_b16 v[36:37], v5 offset:12288
    ds_read_b64_tr_b16 v[38:39], v5 offset:18432
    s_waitcnt lgkmcnt(13)
    v_mfma_f32_16x16x32_bf16 v[112:115], v[40:43], v[8:11], v[112:115]
    v_mfma_f32_16x16x32_bf16 v[116:119], v[40:43], v[12:15], v[116:119]
    v_mfma_f32_16x16x32_bf16 v[120:123], v[40:43], v[16:19], v[120:123]
    ds_read_b64_tr_b16 v[40:41], v4 offset:12416
    ds_read_b64_tr_b16 v[42:43], v4 offset:18560
    s_waitcnt lgkmcnt(13)
    v_mfma_f32_16x16x32_bf16 v[124:127], v[44:47], v[8:11], v[124:127]
    v_mfma_f32_16x16x32_bf16 v[128:131], v[44:47], v[12:15], v[128:131]
    v_mfma_f32_16x16x32_bf16 v[132:135], v[44:47], v[16:19], v[132:135]
    ds_read_b64_tr_b16 v[44:45], v5 offset:12416
    ds_read_b64_tr_b16 v[46:47], v5 offset:18560
    s_waitcnt lgkmcnt(13)
    v_mfma_f32_16x16x32_bf16 v[136:139], v[8:11], v[48:51], v[136:139]
    v_mfma_f32_16x16x32_bf16 v[140:143], v[12:15], v[48:51], v[140:143]
    v_mfma_f32_16x16x32_bf16 v[144:147], v[16:19], v[48:51], v[144:147]
    ds_read_b64_tr_b16 v[48:49], v4 offset:12544
    ds_read_b64_tr_b16 v[50:51], v4 offset:18688
    s_waitcnt lgkmcnt(13)
    v_mfma_f32_16x16x32_bf16 v[148:151], v[8:11], v[52:55], v[148:151]
    v_mfma_f32_16x16x32_bf16 v[152:155], v[12:15], v[52:55], v[152:155]
    v_mfma_f32_16x16x32_bf16 v[156:159], v[16:19], v[52:55], v[156:159]
    ds_read_b64_tr_b16 v[52:53], v5 offset:12544
    ds_read_b64_tr_b16 v[54:55], v5 offset:18688
    s_waitcnt lgkmcnt(12)
    s_waitcnt lgkmcnt(10)
    v_mfma_f32_16x16x32_bf16 v[96:99], v[32:35], v[24:27], v[96:99]
    v_mfma_f32_16x16x32_bf16 v[100:103], v[32:35], v[28:31], v[100:103]
    s_add_u32 s59, s59, 1
    s_cmp_eq_u32 s59, 3
    s_cselect_b32 s68, s71, s70
    s_cselect_b32 s69, s73, s72
    s_cselect_b32 s59, 0, s59
    s_waitcnt lgkmcnt(8)
    v_mfma_f32_16x16x32_bf16 v[104:107], v[36:39], v[24:27], v[104:107]
    v_mfma_f32_16x16x32_bf16 v[108:111], v[36:39], v[28:31], v[108:111]
    v_add_u32 v2, s68, v2
    v_add_u32 v3, s68, v3
    v_add_u32 v4, s69, v4
    v_add_u32 v5, s69, v5
    s_waitcnt lgkmcnt(6)
    v_mfma_f32_16x16x32_bf16 v[112:115], v[40:43], v[20:23], v[112:115]
    v_mfma_f32_16x16x32_bf16 v[116:119], v[40:43], v[24:27], v[116:119]
    v_mfma_f32_16x16x32_bf16 v[120:123], v[40:43], v[28:31], v[120:123]
    s_waitcnt lgkmcnt(0)
    s_barrier
    s_cmp_lg_u32 s58, 7
    s_cbranch_scc1 p1Ac0_nohook
    v_mov_b32 v6, 155648
    ds_read_b64 v[6:7], v6
    s_waitcnt lgkmcnt(0)
    v_readfirstlane_b32 s60, v6
    v_readfirstlane_b32 s61, v7
    s_cmp_ge_u32 s3, 4
    s_cbranch_scc1 p1Ac0_pbh
    s_cmp_ge_u32 s52, 12
    s_cbranch_scc1 p1Ac0_cq
    s_mul_i32 s64, s53, 14
    s_add_u32 s64, s64, s52
    s_lshl_b32 s64, s64, 2
    s_add_u32 s64, s64, s57
    s_lshl_b32 s64, s64, 7
    s_add_u32 s64, s64, 32768
    v_mov_b32 v68, v88
    v_mov_b32 v69, v89
    v_mov_b32 v70, s60
    v_mov_b32 v71, s61
    v_and_b32 v73, 1, v0
    v_lshrrev_b32 v72, 1, v0
    v_lshl_add_u32 v72, v73, 2, v72
    v_lshlrev_b32 v72, 4, v72
    s_mov_b64 exec, 0xff
    buffer_store_dwordx4 v[68:71], v72, s[44:47], s64 offen sc1
    s_mov_b64 exec, -1
p1Ac0_cq:
    s_branch p1Ac0_pbe
p1Ac0_pbh:
    s_lshl_b32 s64, s52, 4
    s_add_u32 s64, s64, s53
    s_lshl_b32 s64, s64, 2
    s_add_u32 s64, s64, s57
    s_lshl_b32 s64, s64, 5
    s_add_u32 s64, s64, 0
    v_mov_b32 v90, v86
    v_mov_b32 v91, v87
    v_mov_b32 v92, s60
    v_mov_b32 v93, s61
    v_lshlrev_b32 v94, 4, v0
    s_mov_b64 exec, 3
    buffer_store_dwordx4 v[90:93], v94, s[44:47], s64 offen sc1
    s_mov_b64 exec, -1
p1Ac0_pbe:
p1Ac0_nohook:
    s_cmp_lg_u32 s58, s92
    s_cbranch_scc1 p1Ac0_notouch
    s_waitcnt vmcnt(0)
    buffer_load_dword v160, v161, s[40:43], s93 offen
    buffer_load_dword v160, v161, s[40:43], s94 offen
    s_cmp_lt_u32 s3, 6
    s_cbranch_scc1 p1Ac0_notouch
    buffer_load_dword v160, v161, s[40:43], s95 offen
    buffer_load_dword v160, v161, s[40:43], s91 offen
p1Ac0_notouch:
    v_mfma_f32_16x16x32_bf16 v[124:127], v[44:47], v[20:23], v[124:127]
    ds_read_b128 v[8:11], v2 offset:0
    ds_read_b128 v[12:15], v2 offset:2048
    v_mfma_f32_16x16x32_bf16 v[128:131], v[44:47], v[24:27], v[128:131]
    ds_read_b128 v[16:19], v2 offset:4096
    ds_read_b64_tr_b16 v[32:33], v4 offset:0
    v_mfma_f32_16x16x32_bf16 v[132:135], v[44:47], v[28:31], v[132:135]
    ds_read_b64_tr_b16 v[34:35], v4 offset:6144
    ds_read_b64_tr_b16 v[36:37], v5 offset:0
    v_mfma_f32_16x16x32_bf16 v[136:139], v[20:23], v[48:51], v[136:139]
    ds_read_b64_tr_b16 v[38:39], v5 offset:6144
    ds_read_b64_tr_b16 v[40:41], v4 offset:128
    v_mfma_f32_16x16x32_bf16 v[140:143], v[24:27], v[48:51], v[140:143]
    ds_read_b64_tr_b16 v[42:43], v4 offset:6272
    ds_read_b64_tr_b16 v[44:45], v5 offset:128
    v_mfma_f32_16x16x32_bf16 v[144:147], v[28:31], v[48:51], v[144:147]
    ds_read_b64_tr_b16 v[46:47], v5 offset:6272
    v_mfma_f32_16x16x32_bf16 v[148:151], v[20:23], v[52:55], v[148:151]
    ds_read_b64_tr_b16 v[48:49], v4 offset:256
    ds_read_b64_tr_b16 v[50:51], v4 offset:6400
    v_mfma_f32_16x16x32_bf16 v[152:155], v[24:27], v[52:55], v[152:155]
    v_mfma_f32_16x16x32_bf16 v[156:159], v[28:31], v[52:55], v[156:159]
    ds_read_b64_tr_b16 v[52:53], v5 offset:256
    ds_read_b64_tr_b16 v[54:55], v5 offset:6400
    s_sub_u32 s58, s58, 1
    s_cmp_lg_u32 s58, 0
    s_cbranch_scc1 p1Ac0_loop
    s_waitcnt lgkmcnt(0)
    v_and_b32 v4, 15, v0
    v_lshrrev_b32 v5, 4, v0
    s_lshl_b32 s72, s57, 7
    v_lshlrev_b32 v4, 2, v4
    v_lshlrev_b32 v5, 4, v5
    s_add_u32 s72, s72, 153600
    v_add_u32 v6, s72, v4
    v_add_u32 v7, s72, v5
    s_lshr_b32 s73, s3, 2
    s_lshl_b32 s73, s73, 7
    s_add_u32 s73, s73, 154752
    v_add_u32 v4, s73, v4
    v_add_u32 v5, s73, v5
    ds_read_b128 v[48:51], v5 offset:0
    ds_read_b128 v[52:55], v5 offset:64
    ds_read_b32 v8, v6 offset:0
    ds_read_b32 v11, v6 offset:576
    ds_read_b32 v9, v6 offset:64
    ds_read_b32 v12, v6 offset:640
    ds_read_b32 v10, v6 offset:128
    ds_read_b32 v13, v6 offset:704
    ds_read_b128 v[56:59], v5 offset:256
    ds_read_b128 v[60:63], v5 offset:320
    ds_read_b32 v44, v4 offset:512
    ds_read_b32 v45, v4 offset:576
    s_waitcnt lgkmcnt(4)
    ds_read_b128 v[20:23], v7 offset:0
    ds_read_b128 v[32:35], v7 offset:576
    ds_read_b128 v[24:27], v7 offset:64
    ds_read_b128 v[36:39], v7 offset:640
    ds_read_b128 v[28:31], v7 offset:128
    ds_read_b128 v[40:43], v7 offset:704
    v_mul_f32 v14, 0x3e8b97f6, v9
    v_mul_f32 v16, 0x3e8b97f6, v12
    v_mul_f32 v15, 0x3e8b97f6, v10
    v_mul_f32 v17, 0x3e8b97f6, v13
    v_pk_mul_f32 v[64:65], v[48:49], v[16:17] op_sel_hi:[1,0]
    v_pk_fma_f32 v[96:97], v[96:97], v[14:15], v[64:65] op_sel_hi:[1,0,1]
    v_pk_mul_f32 v[66:67], v[50:51], v[16:17] op_sel_hi:[1,0]
    v_pk_fma_f32 v[98:99], v[98:99], v[14:15], v[66:67] op_sel_hi:[1,0,1]
    v_pk_mul_f32 v[68:69], v[48:49], v[16:17] op_sel:[0,1]
    v_pk_fma_f32 v[100:101], v[100:101], v[14:15], v[68:69] op_sel:[0,1,0]
    v_pk_mul_f32 v[70:71], v[50:51], v[16:17] op_sel:[0,1]
    v_pk_fma_f32 v[102:103], v[102:103], v[14:15], v[70:71] op_sel:[0,1,0]
    v_pk_mul_f32 v[72:73], v[52:53], v[16:17] op_sel_hi:[1,0]
    v_pk_fma_f32 v[104:105], v[104:105], v[14:15], v[72:73] op_sel_hi:[1,0,1]
    v_pk_mul_f32 v[74:75], v[54:55], v[16:17] op_sel_hi:[1,0]
    v_pk_fma_f32 v[106:107], v[106:107], v[14:15], v[74:75] op_sel_hi:[1,0,1]
    v_pk_mul_f32 v[76:77], v[52:53], v[16:17] op_sel:[0,1]
    v_pk_fma_f32 v[108:109], v[108:109], v[14:15], v[76:77] op_sel:[0,1,0]
    v_pk_mul_f32 v[78:79], v[54:55], v[16:17] op_sel:[0,1]
    v_pk_fma_f32 v[110:111], v[110:111], v[14:15], v[78:79] op_sel:[0,1,0]
    s_waitcnt lgkmcnt(8)
    v_pk_mul_f32 v[64:65], v[56:57], v[10:11] op_sel:[0,1]
    v_pk_fma_f32 v[112:113], v[112:113], v[8:9], v[64:65] op_sel_hi:[1,0,1]
    v_pk_mul_f32 v[66:67], v[58:59], v[10:11] op_sel:[0,1]
    v_pk_fma_f32 v[114:115], v[114:115], v[8:9], v[66:67] op_sel_hi:[1,0,1]
    v_pk_mul_f32 v[68:69], v[56:57], v[12:13] op_sel_hi:[1,0]
    v_pk_fma_f32 v[116:117], v[116:117], v[8:9], v[68:69] op_sel:[0,1,0]
    v_pk_mul_f32 v[70:71], v[58:59], v[12:13] op_sel_hi:[1,0]
    v_pk_fma_f32 v[118:119], v[118:119], v[8:9], v[70:71] op_sel:[0,1,0]
    v_pk_mul_f32 v[72:73], v[56:57], v[12:13] op_sel:[0,1]
    v_pk_fma_f32 v[120:121], v[120:121], v[10:11], v[72:73] op_sel_hi:[1,0,1]
    v_pk_mul_f32 v[74:75], v[58:59], v[12:13] op_sel:[0,1]
    v_pk_fma_f32 v[122:123], v[122:123], v[10:11], v[74:75] op_sel_hi:[1,0,1]
    v_pk_mul_f32 v[76:77], v[60:61], v[10:11] op_sel:[0,1]
    v_pk_fma_f32 v[124:125], v[124:125], v[8:9], v[76:77] op_sel_hi:[1,0,1]
    v_pk_mul_f32 v[78:79], v[62:63], v[10:11] op_sel:[0,1]
    v_pk_fma_f32 v[126:127], v[126:127], v[8:9], v[78:79] op_sel_hi:[1,0,1]
    v_pk_mul_f32 v[64:65], v[60:61], v[12:13] op_sel_hi:[1,0]
    v_pk_fma_f32 v[128:129], v[128:129], v[8:9], v[64:65] op_sel:[0,1,0]
    v_pk_mul_f32 v[66:67], v[62:63], v[12:13] op_sel_hi:[1,0]
    v_pk_fma_f32 v[130:131], v[130:131], v[8:9], v[66:67] op_sel:[0,1,0]
    v_pk_mul_f32 v[68:69], v[60:61], v[12:13] op_sel:[0,1]
    v_pk_fma_f32 v[132:133], v[132:133], v[10:11], v[68:69] op_sel_hi:[1,0,1]
    v_pk_mul_f32 v[70:71], v[62:63], v[12:13] op_sel:[0,1]
    v_pk_fma_f32 v[134:135], v[134:135], v[10:11], v[70:71] op_sel_hi:[1,0,1]
    s_mov_b32 s74, 0x0
    s_mov_b32 s75, 0xffff0000
    v_mov_b32 v18, 0
    v_mov_b32 v19, 0xff61b1e6
    v_cvt_pk_bf16_f32 v96, v96, v97
    v_cvt_pk_bf16_f32 v97, v98, v99
    v_cvt_pk_bf16_f32 v98, v104, v105
    v_cvt_pk_bf16_f32 v99, v106, v107
    v_cndmask_b32 v98, v98, v18, s[74:75]
    v_cndmask_b32 v99, v99, v18, s[74:75]
    v_cvt_pk_bf16_f32 v100, v100, v101
    v_cvt_pk_bf16_f32 v101, v102, v103
    v_cvt_pk_bf16_f32 v102, v108, v109
    v_cvt_pk_bf16_f32 v103, v110, v111
    v_cndmask_b32 v102, v102, v18, s[74:75]
    v_cndmask_b32 v103, v103, v18, s[74:75]
    v_cvt_pk_bf16_f32 v112, v112, v113
    v_cvt_pk_bf16_f32 v113, v114, v115
    v_cvt_pk_bf16_f32 v114, v124, v125
    v_cvt_pk_bf16_f32 v115, v126, v127
    v_cvt_pk_bf16_f32 v116, v116, v117
    v_cvt_pk_bf16_f32 v117, v118, v119
    v_cvt_pk_bf16_f32 v118, v128, v129
    v_cvt_pk_bf16_f32 v119, v130, v131
    v_cvt_pk_bf16_f32 v120, v120, v121
    v_cvt_pk_bf16_f32 v121, v122, v123
    v_cvt_pk_bf16_f32 v122, v132, v133
    v_cvt_pk_bf16_f32 v123, v134, v135
    v_mfma_f32_16x16x32_bf16 v[80:83], v[112:115], v[96:99], 0
    v_mfma_f32_16x16x32_bf16 v[84:87], v[116:119], v[96:99], 0
    v_mfma_f32_16x16x32_bf16 v[88:91], v[116:119], v[100:103], 0
    v_mfma_f32_16x16x32_bf16 v[92:95], v[120:123], v[100:103], 0
    s_waitcnt lgkmcnt(0)
    v_pk_mul_f32 v[72:73], v[32:33], v[44:45] op_sel_hi:[1,0]
    v_pk_fma_f32 v[136:137], v[136:137], v[20:21], v[72:73]
    v_pk_mul_f32 v[74:75], v[34:35], v[44:45] op_sel_hi:[1,0]
    v_pk_fma_f32 v[138:139], v[138:139], v[22:23], v[74:75]
    v_pk_mul_f32 v[76:77], v[36:37], v[44:45] op_sel_hi:[1,0]
    v_pk_fma_f32 v[140:141], v[140:141], v[24:25], v[76:77]
    v_pk_mul_f32 v[78:79], v[38:39], v[44:45] op_sel_hi:[1,0]
    v_pk_fma_f32 v[142:143], v[142:143], v[26:27], v[78:79]
    v_pk_mul_f32 v[64:65], v[40:41], v[44:45] op_sel_hi:[1,0]
    v_pk_fma_f32 v[144:145], v[144:145], v[28:29], v[64:65]
    v_pk_mul_f32 v[66:67], v[42:43], v[44:45] op_sel_hi:[1,0]
    v_pk_fma_f32 v[146:147], v[146:147], v[30:31], v[66:67]
    v_pk_mul_f32 v[68:69], v[32:33], v[44:45] op_sel:[0,1]
    v_pk_fma_f32 v[148:149], v[148:149], v[20:21], v[68:69]
    v_pk_mul_f32 v[70:71], v[34:35], v[44:45] op_sel:[0,1]
    v_pk_fma_f32 v[150:151], v[150:151], v[22:23], v[70:71]
    v_pk_mul_f32 v[72:73], v[36:37], v[44:45] op_sel:[0,1]
    v_pk_fma_f32 v[152:153], v[152:153], v[24:25], v[72:73]
    v_pk_mul_f32 v[74:75], v[38:39], v[44:45] op_sel:[0,1]
    v_pk_fma_f32 v[154:155], v[154:155], v[26:27], v[74:75]
    v_pk_mul_f32 v[76:77], v[40:41], v[44:45] op_sel:[0,1]
    v_pk_fma_f32 v[156:157], v[156:157], v[28:29], v[76:77]
    v_pk_mul_f32 v[78:79], v[42:43], v[44:45] op_sel:[0,1]
    v_pk_fma_f32 v[158:159], v[158:159], v[30:31], v[78:79]
    v_cvt_pk_bf16_f32 v136, v136, v137
    v_cvt_pk_bf16_f32 v137, v138, v139
    v_cvt_pk_bf16_f32 v138, v140, v141
    v_cvt_pk_bf16_f32 v139, v142, v143
    v_cvt_pk_bf16_f32 v140, v144, v145
    v_cvt_pk_bf16_f32 v141, v146, v147
    v_cvt_pk_bf16_f32 v148, v148, v149
    v_cvt_pk_bf16_f32 v149, v150, v151
    v_cvt_pk_bf16_f32 v150, v152, v153
    v_cvt_pk_bf16_f32 v151, v154, v155
    v_cvt_pk_bf16_f32 v152, v156, v157
    v_cvt_pk_bf16_f32 v153, v158, v159
    s_mov_b32 s88, 0x55505555
    s_mov_b32 s89, 0x50005500
    s_mov_b32 s80, 0x50000
    s_mov_b32 s81, 0x5550055
    s_mov_b32 s90, 0xaaa0aaaa
    s_mov_b32 s91, 0xa000aa00
    s_mov_b32 s82, 0xa0000
    s_mov_b32 s83, 0xaaa00aa
    s_mov_b32 s92, 0x55405554
    s_mov_b32 s93, 0x40005400
    s_mov_b32 s84, 0x150001
    s_mov_b32 s85, 0x15550155
    s_mov_b32 s94, 0xaa80aaa8
    s_mov_b32 s95, 0x8000a800
    s_mov_b32 s86, 0x2a0002
    s_mov_b32 s87, 0x2aaa02aa
    v_cndmask_b32 v88, v19, v88, s[80:81]
    v_cndmask_b32 v92, v19, v92, s[88:89]
    v_cndmask_b32 v89, v19, v89, s[82:83]
    v_cndmask_b32 v93, v19, v93, s[90:91]
    v_cndmask_b32 v90, v19, v90, s[84:85]
    v_cndmask_b32 v94, v19, v94, s[92:93]
    v_cndmask_b32 v91, v19, v91, s[86:87]
    v_cndmask_b32 v95, v19, v95, s[94:95]
    s_or_b32 s72, s52, s57
    s_cmp_eq_u32 s72, 0
    s_cselect_b64 s[76:77], 0, -1
    s_and_b64 s[80:81], s[80:81], s[76:77]
    s_and_b64 s[82:83], s[82:83], s[76:77]
    s_and_b64 s[84:85], s[84:85], s[76:77]
    s_and_b64 s[86:87], s[86:87], s[76:77]
    v_cndmask_b32 v80, v19, v80, s[80:81]
    v_cndmask_b32 v84, v19, v84, s[88:89]
    v_cndmask_b32 v81, v19, v81, s[82:83]
    v_cndmask_b32 v85, v19, v85, s[90:91]
    v_cndmask_b32 v82, v19, v82, s[84:85]
    v_cndmask_b32 v86, v19, v86, s[92:93]
    v_cndmask_b32 v83, v19, v83, s[86:87]
    v_cndmask_b32 v87, v19, v87, s[94:95]
    v_max3_f32 v64, v80, v81, v82
    v_max3_f32 v66, v83, v84, v85
    v_max3_f32 v65, v88, v89, v90
    v_max3_f32 v67, v91, v92, v93
    v_max3_f32 v64, v64, v86, v87
    v_max3_f32 v65, v65, v94, v95
    v_max_f32 v64, v64, v66
    v_max_f32 v65, v65, v67
    v_mov_b32 v66, v64
    v_mov_b32 v67, v65
    s_nop 0
    v_permlane16_swap_b32 v64, v66
    v_permlane16_swap_b32 v65, v67
    v_max_f32 v64, v64, v66
    v_max_f32 v65, v65, v67
    v_mov_b32 v66, v64
    v_mov_b32 v67, v65
    s_nop 0
    v_permlane32_swap_b32 v64, v66
    v_permlane32_swap_b32 v65, v67
    v_max_f32 v64, v64, v66
    v_max_f32 v65, v65, v67
    v_pk_add_f32 v[80:81], v[80:81], v[64:65] op_sel_hi:[1,0] neg_lo:[0,1] neg_hi:[0,1]
    v_pk_add_f32 v[82:83], v[82:83], v[64:65] op_sel_hi:[1,0] neg_lo:[0,1] neg_hi:[0,1]
    v_pk_add_f32 v[84:85], v[84:85], v[64:65] op_sel_hi:[1,0] neg_lo:[0,1] neg_hi:[0,1]
    v_pk_add_f32 v[86:87], v[86:87], v[64:65] op_sel_hi:[1,0] neg_lo:[0,1] neg_hi:[0,1]
    v_pk_add_f32 v[88:89], v[88:89], v[64:65] op_sel:[0,1] neg_lo:[0,1] neg_hi:[0,1]
    v_pk_add_f32 v[90:91], v[90:91], v[64:65] op_sel:[0,1] neg_lo:[0,1] neg_hi:[0,1]
    v_pk_add_f32 v[92:93], v[92:93], v[64:65] op_sel:[0,1] neg_lo:[0,1] neg_hi:[0,1]
    v_pk_add_f32 v[94:95], v[94:95], v[64:65] op_sel:[0,1] neg_lo:[0,1] neg_hi:[0,1]
    v_exp_f32 v80, v80
    v_exp_f32 v81, v81
    v_exp_f32 v82, v82
    v_exp_f32 v83, v83
    v_exp_f32 v84, v84
    v_exp_f32 v85, v85
    v_exp_f32 v86, v86
    v_exp_f32 v87, v87
    v_exp_f32 v88, v88
    v_exp_f32 v89, v89
    v_exp_f32 v90, v90
    v_exp_f32 v91, v91
    v_exp_f32 v92, v92
    v_exp_f32 v93, v93
    v_exp_f32 v94, v94
    v_exp_f32 v95, v95
    v_pk_add_f32 v[68:69], v[80:81], v[82:83]
    v_pk_add_f32 v[72:73], v[84:85], v[86:87]
    v_pk_add_f32 v[70:71], v[88:89], v[90:91]
    v_pk_add_f32 v[74:75], v[92:93], v[94:95]
    v_pk_add_f32 v[68:69], v[68:69], v[72:73]
    v_pk_add_f32 v[70:71], v[70:71], v[74:75]
    v_add_f32 v68, v68, v69
    v_add_f32 v70, v70, v71
    v_cvt_pk_bf16_f32 v80, v80, v81
    v_cvt_pk_bf16_f32 v81, v82, v83
    v_cvt_pk_bf16_f32 v82, v84, v85
    v_cvt_pk_bf16_f32 v83, v86, v87
    v_cvt_pk_bf16_f32 v88, v88, v89
    v_cvt_pk_bf16_f32 v89, v90, v91
    v_cvt_pk_bf16_f32 v90, v92, v93
    v_cvt_pk_bf16_f32 v91, v94, v95
    v_mfma_f32_16x16x32_bf16 v[104:107], v[136:139], v[80:83], 0
    v_mfma_f32_16x16x32_bf16 v[124:127], v[148:151], v[80:83], 0
    v_mfma_f32_16x16x32_bf16 v[108:111], v[138:141], v[88:91], 0
    v_mfma_f32_16x16x32_bf16 v[128:131], v[150:153], v[88:91], 0
    v_mov_b32 v66, v68
    v_mov_b32 v67, v70
    s_nop 0
    v_permlane16_swap_b32 v68, v66
    v_permlane16_swap_b32 v70, v67
    v_add_f32 v68, v68, v66
    v_add_f32 v70, v70, v67
    v_mov_b32 v66, v68
    v_mov_b32 v67, v70
    s_nop 0
    v_permlane32_swap_b32 v68, v66
    v_permlane32_swap_b32 v70, v67
    v_add_f32 v68, v68, v66
    v_add_f32 v70, v70, v67
    v_rcp_f32 v68, v68
    v_rcp_f32 v70, v70
    v_pk_mul_f32 v[104:105], v[104:105], v[68:69] op_sel_hi:[1,0]
    v_pk_mul_f32 v[106:107], v[106:107], v[68:69] op_sel_hi:[1,0]
    v_pk_mul_f32 v[124:125], v[124:125], v[68:69] op_sel_hi:[1,0]
    v_pk_mul_f32 v[126:127], v[126:127], v[68:69] op_sel_hi:[1,0]
    v_pk_mul_f32 v[108:109], v[108:109], v[70:71] op_sel_hi:[1,0]
    v_pk_mul_f32 v[110:111], v[110:111], v[70:71] op_sel_hi:[1,0]
    v_pk_mul_f32 v[128:129], v[128:129], v[70:71] op_sel_hi:[1,0]
    v_pk_mul_f32 v[130:131], v[130:131], v[70:71] op_sel_hi:[1,0]
    v_cvt_pk_bf16_f32 v64, v104, v105
    v_cvt_pk_bf16_f32 v65, v106, v107
    v_cvt_pk_bf16_f32 v66, v124, v125
    v_cvt_pk_bf16_f32 v67, v126, v127
    v_cndmask_b32 v66, v66, v18, s[74:75]
    v_cndmask_b32 v67, v67, v18, s[74:75]
    v_cvt_pk_bf16_f32 v68, v108, v109
    v_cvt_pk_bf16_f32 v69, v110, v111
    v_cvt_pk_bf16_f32 v70, v128, v129
    v_cvt_pk_bf16_f32 v71, v130, v131
    v_cndmask_b32 v70, v70, v18, s[74:75]
    v_cndmask_b32 v71, v71, v18, s[74:75]
    s_lshl_b32 s72, s52, 3
    s_lshl_b32 s73, s57, 1
    s_add_u32 s72, s72, s73
    s_lshl_b32 s72, s72, 4
    s_add_u32 s72, s72, s56
    s_lshl_b32 s72, s72, 10
    s_add_u32 s74, s72, 9437184
    s_add_u32 s75, s74, 16384
    s_lshl_b32 s72, s52, 2
    s_add_u32 s72, s72, s57
    s_lshl_b32 s72, s72, 4
    s_add_u32 s72, s72, s56
    s_lshl_b32 s72, s72, 3
    s_add_u32 s31, s72, 20979712
    s_barrier
    s_cmp_ge_u32 s3, 4
    s_cbranch_scc1 f_p2b
    s_branch f_p2a
f_cB:
    s_cmp_ge_u32 s3, 4
    s_cbranch_scc1 f_cB1
    s_waitcnt lgkmcnt(0)
    s_mov_b32 s32, s8
    s_mov_b32 s33, s9
    s_mov_b32 s34, 0x1c0000
    s_mov_b32 s35, 0x20000
    s_mov_b32 s36, s16
    s_mov_b32 s37, s17
    s_mov_b32 s38, 0x188000
    s_mov_b32 s39, 0x20000
    s_mov_b32 s44, s28
    s_mov_b32 s45, s29
    s_mov_b32 s46, 0x1600000
    s_mov_b32 s47, 0x20000
    s_mov_b32 s48, s26
    s_mov_b32 s49, s27
    s_mov_b32 s50, 0x100
    s_mov_b32 s51, 0x20000
    s_and_b32 s57, s3, 3
    s_lshr_b32 s56, s3, 2
    s_lshl_b32 s64, s54, 1
    s_add_u32 s56, s56, s64
    v_mov_b32 v7, 0
    s_or_b32 s72, s2, s3
    s_cmp_lg_u32 s72, 0
    s_cbranch_scc1 p1Bc0_non
    s_memrealtime s[74:75]
    s_waitcnt lgkmcnt(0)
    s_or_b32 s74, s74, 1
    v_mov_b32 v8, s74
    v_mov_b32 v9, s75
    s_mov_b64 exec, 1
    buffer_store_dwordx2 v[8:9], v7, s[48:51], 0 offen sc1
    s_mov_b64 exec, -1
p1Bc0_non:
    s_cmp_ge_u32 s52, 14
    s_cbranch_scc1 p1Bc0_cl
    s_mul_i32 s64, s54, 224
    s_lshl_b32 s65, s52, 5
    s_add_u32 s64, s64, s65
    s_cmp_lt_u32 s52, 7
    s_mov_b32 s65, -224
    s_cselect_b32 s65, 1792, s65
    s_add_u32 s64, s64, s65
    s_mul_i32 s66, s57, 401408
    s_add_u32 s64, s64, s66
    v_lshrrev_b32 v84, 1, v0
    v_mul_u32_u24 v84, 3584, v84
    v_and_b32 v85, 1, v0
    v_lshl_add_u32 v84, v85, 4, v84
    buffer_load_dwordx4 v[68:71], v84, s[36:39], s64 offen
    s_add_u32 s64, s64, 114688
    buffer_load_dwordx4 v[72:75], v84, s[36:39], s64 offen
    s_add_u32 s64, s64, 114688
    buffer_load_dwordx4 v[76:79], v84, s[36:39], s64 offen
    s_add_u32 s64, s64, 114688
    v_mov_b32 v85, 0x7ff00000
    v_cmp_gt_u32 vcc, 32, v0
    s_nop 1
    v_cndmask_b32 v84, v85, v84, vcc
    buffer_load_dwordx4 v[80:83], v84, s[36:39], s64 offen
p1Bc0_cl:
    s_waitcnt vmcnt(0)
    s_cmp_ge_u32 s52, 14
    s_cbranch_scc1 p1Bc0_cc
    v_mov_b32 v60, 0x00003f80
    v_mov_b32 v61, 0x3f800000
    v_mov_b32 v88, 0
    v_mov_b32 v89, 0
    v_mov_b32 v90, 0
    v_mov_b32 v91, 0
    v_mov_b32 v92, 0
    v_mov_b32 v93, 0
    v_mov_b32 v94, 0
    v_mov_b32 v95, 0
    v_dot2_f32_bf16 v88, v68, v60, v88
    v_dot2_f32_bf16 v89, v68, v61, v89
    v_dot2_f32_bf16 v90, v69, v60, v90
    v_dot2_f32_bf16 v91, v69, v61, v91
    v_dot2_f32_bf16 v92, v70, v60, v92
    v_dot2_f32_bf16 v93, v70, v61, v93
    v_dot2_f32_bf16 v94, v71, v60, v94
    v_dot2_f32_bf16 v95, v71, v61, v95
    v_dot2_f32_bf16 v88, v72, v60, v88
    v_dot2_f32_bf16 v89, v72, v61, v89
    v_dot2_f32_bf16 v90, v73, v60, v90
    v_dot2_f32_bf16 v91, v73, v61, v91
    v_dot2_f32_bf16 v92, v74, v60, v92
    v_dot2_f32_bf16 v93, v74, v61, v93
    v_dot2_f32_bf16 v94, v75, v60, v94
    v_dot2_f32_bf16 v95, v75, v61, v95
    v_dot2_f32_bf16 v88, v76, v60, v88
    v_dot2_f32_bf16 v89, v76, v61, v89
    v_dot2_f32_bf16 v90, v77, v60, v90
    v_dot2_f32_bf16 v91, v77, v61, v91
    v_dot2_f32_bf16 v92, v78, v60, v92
    v_dot2_f32_bf16 v93, v78, v61, v93
    v_dot2_f32_bf16 v94, v79, v60, v94
    v_dot2_f32_bf16 v95, v79, v61, v95
    v_dot2_f32_bf16 v88, v80, v60, v88
    v_dot2_f32_bf16 v89, v80, v61, v89
    v_dot2_f32_bf16 v90, v81, v60, v90
    v_dot2_f32_bf16 v91, v81, v61, v91
    v_dot2_f32_bf16 v92, v82, v60, v92
    v_dot2_f32_bf16 v93, v82, v61, v93
    v_dot2_f32_bf16 v94, v83, v60, v94
    v_dot2_f32_bf16 v95, v83, v61, v95
    v_add_f32_dpp v88, v88, v88 row_ror:8 row_mask:0xf bank_mask:0xf
    v_add_f32_dpp v89, v89, v89 row_ror:8 row_mask:0xf bank_mask:0xf
    v_add_f32_dpp v90, v90, v90 row_ror:8 row_mask:0xf bank_mask:0xf
    v_add_f32_dpp v91, v91, v91 row_ror:8 row_mask:0xf bank_mask:0xf
    v_add_f32_dpp v92, v92, v92 row_ror:8 row_mask:0xf bank_mask:0xf
    v_add_f32_dpp v93, v93, v93 row_ror:8 row_mask:0xf bank_mask:0xf
    v_add_f32_dpp v94, v94, v94 row_ror:8 row_mask:0xf bank_mask:0xf
    v_add_f32_dpp v95, v95, v95 row_ror:8 row_mask:0xf bank_mask:0xf
    v_add_f32_dpp v88, v88, v88 row_ror:4 row_mask:0xf bank_mask:0xf
    v_add_f32_dpp v89, v89, v89 row_ror:4 row_mask:0xf bank_mask:0xf
    v_add_f32_dpp v90, v90, v90 row_ror:4 row_mask:0xf bank_mask:0xf
    v_add_f32_dpp v91, v91, v91 row_ror:4 row_mask:0xf bank_mask:0xf
    v_add_f32_dpp v92, v92, v92 row_ror:4 row_mask:0xf bank_mask:0xf
    v_add_f32_dpp v93, v93, v93 row_ror:4 row_mask:0xf bank_mask:0xf
    v_add_f32_dpp v94, v94, v94 row_ror:4 row_mask:0xf bank_mask:0xf
    v_add_f32_dpp v95, v95, v95 row_ror:4 row_mask:0xf bank_mask:0xf
    v_add_f32_dpp v88, v88, v88 row_ror:2 row_mask:0xf bank_mask:0xf
    v_add_f32_dpp v89, v89, v89 row_ror:2 row_mask:0xf bank_mask:0xf
    v_add_f32_dpp v90, v90, v90 row_ror:2 row_mask:0xf bank_mask:0xf
    v_add_f32_dpp v91, v91, v91 row_ror:2 row_mask:0xf bank_mask:0xf
    v_add_f32_dpp v92, v92, v92 row_ror:2 row_mask:0xf bank_mask:0xf
    v_add_f32_dpp v93, v93, v93 row_ror:2 row_mask:0xf bank_mask:0xf
    v_add_f32_dpp v94, v94, v94 row_ror:2 row_mask:0xf bank_mask:0xf
    v_add_f32_dpp v95, v95, v95 row_ror:2 row_mask:0xf bank_mask:0xf
    v_mov_b32 v62, v88
    v_mov_b32 v63, v89
    v_mov_b32 v64, v90
    v_mov_b32 v65, v91
    v_mov_b32 v66, v92
    v_mov_b32 v67, v93
    v_mov_b32 v68, v94
    v_mov_b32 v69, v95
    v_permlane16_swap_b32 v88, v62
    v_permlane16_swap_b32 v89, v63
    v_permlane16_swap_b32 v90, v64
    v_permlane16_swap_b32 v91, v65
    v_permlane16_swap_b32 v92, v66
    v_permlane16_swap_b32 v93, v67
    v_permlane16_swap_b32 v94, v68
    v_permlane16_swap_b32 v95, v69
    v_add_f32 v88, v88, v62
    v_add_f32 v89, v89, v63
    v_add_f32 v90, v90, v64
    v_add_f32 v91, v91, v65
    v_add_f32 v92, v92, v66
    v_add_f32 v93, v93, v67
    v_add_f32 v94, v94, v68
    v_add_f32 v95, v95, v69
    v_mov_b32 v62, v88
    v_mov_b32 v63, v89
    v_mov_b32 v64, v90
    v_mov_b32 v65, v91
    v_mov_b32 v66, v92
    v_mov_b32 v67, v93
    v_mov_b32 v68, v94
    v_mov_b32 v69, v95
    v_permlane32_swap_b32 v88, v62
    v_permlane32_swap_b32 v89, v63
    v_permlane32_swap_b32 v90, v64
    v_permlane32_swap_b32 v91, v65
    v_permlane32_swap_b32 v92, v66
    v_permlane32_swap_b32 v93, v67
    v_permlane32_swap_b32 v94, v68
    v_permlane32_swap_b32 v95, v69
    v_add_f32 v88, v88, v62
    v_add_f32 v89, v89, v63
    v_add_f32 v90, v90, v64
    v_add_f32 v91, v91, v65
    v_add_f32 v92, v92, v66
    v_add_f32 v93, v93, v67
    v_add_f32 v94, v94, v68
    v_add_f32 v95, v95, v69
    v_lshrrev_b32 v62, 1, v0
    v_cmp_eq_u32 vcc, 1, v62
    s_nop 1
    v_cndmask_b32 v88, v88, v90, vcc
    v_cndmask_b32 v89, v89, v91, vcc
    v_cmp_eq_u32 vcc, 2, v62
    s_nop 1
    v_cndmask_b32 v88, v88, v92, vcc
    v_cndmask_b32 v89, v89, v93, vcc
    v_cmp_eq_u32 vcc, 3, v62
    s_nop 1
    v_cndmask_b32 v88, v88, v94, vcc
    v_cndmask_b32 v89, v89, v95, vcc
p1Bc0_cc:
    v_and_b32 v8, 15, v0
    v_lshrrev_b32 v9, 4, v0
    v_lshrrev_b32 v10, 1, v8
    v_xor_b32 v10, v10, v9
    v_lshlrev_b32 v10, 4, v10
    v_lshl_add_u32 v10, v8, 7, v10
    s_lshl_b32 s72, s57, 12
    v_add_u32 v2, s72, v10
    v_xor_b32 v3, 64, v2
    v_lshrrev_b32 v10, 2, v8
    v_lshl_add_u32 v10, v9, 2, v10
    v_and_b32 v11, 3, v8
    v_lshlrev_b32 v11, 3, v11
    v_mul_u32_u24 v12, 448, v10
    v_add_u32 v12, v12, v11
    v_add_u32 v12, 55296, v12
    v_and_b32 v11, 1, v9
    v_lshl_add_u32 v4, v11, 5, v12
    v_xor_b32 v11, 1, v11
    v_lshl_add_u32 v5, v11, 5, v12
    s_mov_b32 s36, s20
    s_mov_b32 s37, s21
    s_mov_b32 s38, 0x1000
    s_mov_b32 s39, 0x20000
    v_and_b32 v162, 15, v0
    v_lshlrev_b32 v162, 1, v162
    s_lshl_b32 s64, s4, 8
    s_lshl_b32 s65, s57, 6
    s_add_u32 s64, s64, s65
    buffer_load_ushort v163, v162, s[36:39], s64 offen offset:32
    buffer_load_ushort v162, v162, s[36:39], s64 offen
    v_mov_b32 v96, 0
    v_mov_b32 v97, 0
    v_mov_b32 v98, 0
    v_mov_b32 v99, 0
    v_mov_b32 v100, 0
    v_mov_b32 v101, 0
    v_mov_b32 v102, 0
    v_mov_b32 v103, 0
    v_mov_b32 v104, 0
    v_mov_b32 v105, 0
    v_mov_b32 v106, 0
    v_mov_b32 v107, 0
    v_mov_b32 v108, 0
    v_mov_b32 v109, 0
    v_mov_b32 v110, 0
    v_mov_b32 v111, 0
    v_mov_b32 v112, 0
    v_mov_b32 v113, 0
    v_mov_b32 v114, 0
    v_mov_b32 v115, 0
    v_mov_b32 v116, 0
    v_mov_b32 v117, 0
    v_mov_b32 v118, 0
    v_mov_b32 v119, 0
    v_mov_b32 v120, 0
    v_mov_b32 v121, 0
    v_mov_b32 v122, 0
    v_mov_b32 v123, 0
    v_mov_b32 v124, 0
    v_mov_b32 v125, 0
    v_mov_b32 v126, 0
    v_mov_b32 v127, 0
    v_mov_b32 v128, 0
    v_mov_b32 v129, 0
    v_mov_b32 v130, 0
    v_mov_b32 v131, 0
    v_mov_b32 v132, 0
    v_mov_b32 v133, 0
    v_mov_b32 v134, 0
    v_mov_b32 v135, 0
    v_mov_b32 v136, 0
    v_mov_b32 v137, 0
    v_mov_b32 v138, 0
    v_mov_b32 v139, 0
    v_mov_b32 v140, 0
    v_mov_b32 v141, 0
    v_mov_b32 v142, 0
    v_mov_b32 v143, 0
    v_mov_b32 v144, 0
    v_mov_b32 v145, 0
    v_mov_b32 v146, 0
    v_mov_b32 v147, 0
    v_mov_b32 v148, 0
    v_mov_b32 v149, 0
    v_mov_b32 v150, 0
    v_mov_b32 v151, 0
    s_mov_b32 s70, 16384
    s_mov_b32 s71, -32768
    s_mov_b32 s72, 28672
    s_mov_b32 s73, -57344
    s_mov_b32 s59, 0
    s_mov_b32 s58, 7
    s_waitcnt lgkmcnt(0)
    s_barrier
    ds_read_b128 v[8:11], v2 offset:0
    ds_read_b128 v[12:15], v2 offset:2048
    ds_read_b64_tr_b16 v[32:33], v4 offset:0
    ds_read_b64_tr_b16 v[34:35], v4 offset:7168
    ds_read_b64_tr_b16 v[36:37], v5 offset:0
    ds_read_b64_tr_b16 v[38:39], v5 offset:7168
    ds_read_b64_tr_b16 v[40:41], v4 offset:64
    ds_read_b64_tr_b16 v[42:43], v4 offset:7232
    ds_read_b64_tr_b16 v[44:45], v5 offset:64
    ds_read_b64_tr_b16 v[46:47], v5 offset:7232
    ds_read_b64_tr_b16 v[48:49], v4 offset:128
    ds_read_b64_tr_b16 v[50:51], v4 offset:7296
    ds_read_b64_tr_b16 v[52:53], v5 offset:128
    ds_read_b64_tr_b16 v[54:55], v5 offset:7296
    ds_read_b64_tr_b16 v[56:57], v4 offset:192
    ds_read_b64_tr_b16 v[58:59], v4 offset:7360
p1Bc0_loop:
    ds_read_b128 v[20:23], v3 offset:0
    ds_read_b128 v[24:27], v3 offset:2048
    s_waitcnt lgkmcnt(15)
    s_waitcnt lgkmcnt(14)
    v_mfma_f32_16x16x32_bf16 v[96:99], v[8:11], v[32:35], v[96:99]
    v_mfma_f32_16x16x32_bf16 v[100:103], v[12:15], v[32:35], v[100:103]
    ds_read_b64_tr_b16 v[32:33], v4 offset:14336
    ds_read_b64_tr_b16 v[34:35], v4 offset:21504
    s_waitcnt lgkmcnt(14)
    v_mfma_f32_16x16x32_bf16 v[104:107], v[8:11], v[36:39], v[104:107]
    v_mfma_f32_16x16x32_bf16 v[108:111], v[12:15], v[36:39], v[108:111]
    ds_read_b64_tr_b16 v[36:37], v5 offset:14336
    ds_read_b64_tr_b16 v[38:39], v5 offset:21504
    s_waitcnt lgkmcnt(14)
    v_mfma_f32_16x16x32_bf16 v[112:115], v[8:11], v[40:43], v[112:115]
    v_mfma_f32_16x16x32_bf16 v[116:119], v[12:15], v[40:43], v[116:119]
    ds_read_b64_tr_b16 v[40:41], v4 offset:14400
    ds_read_b64_tr_b16 v[42:43], v4 offset:21568
    s_waitcnt lgkmcnt(14)
    v_mfma_f32_16x16x32_bf16 v[120:123], v[8:11], v[44:47], v[120:123]
    v_mfma_f32_16x16x32_bf16 v[124:127], v[12:15], v[44:47], v[124:127]
    ds_read_b64_tr_b16 v[44:45], v5 offset:14400
    ds_read_b64_tr_b16 v[46:47], v5 offset:21568
    s_waitcnt lgkmcnt(14)
    v_mfma_f32_16x16x32_bf16 v[128:131], v[8:11], v[48:51], v[128:131]
    v_mfma_f32_16x16x32_bf16 v[132:135], v[12:15], v[48:51], v[132:135]
    ds_read_b64_tr_b16 v[48:49], v4 offset:14464
    ds_read_b64_tr_b16 v[50:51], v4 offset:21632
    s_waitcnt lgkmcnt(14)
    v_mfma_f32_16x16x32_bf16 v[136:139], v[8:11], v[52:55], v[136:139]
    v_mfma_f32_16x16x32_bf16 v[140:143], v[12:15], v[52:55], v[140:143]
    ds_read_b64_tr_b16 v[52:53], v5 offset:14464
    ds_read_b64_tr_b16 v[54:55], v5 offset:21632
    s_waitcnt lgkmcnt(14)
    v_mfma_f32_16x16x32_bf16 v[144:147], v[8:11], v[56:59], v[144:147]
    v_mfma_f32_16x16x32_bf16 v[148:151], v[12:15], v[56:59], v[148:151]
    ds_read_b64_tr_b16 v[56:57], v4 offset:14528
    ds_read_b64_tr_b16 v[58:59], v4 offset:21696
    s_waitcnt lgkmcnt(14)
    s_waitcnt lgkmcnt(12)
    v_mfma_f32_16x16x32_bf16 v[96:99], v[20:23], v[32:35], v[96:99]
    v_mfma_f32_16x16x32_bf16 v[100:103], v[24:27], v[32:35], v[100:103]
    s_add_u32 s59, s59, 1
    s_cmp_eq_u32 s59, 3
    s_cselect_b32 s68, s71, s70
    s_cselect_b32 s69, s73, s72
    s_cselect_b32 s59, 0, s59
    s_waitcnt lgkmcnt(10)
    v_mfma_f32_16x16x32_bf16 v[104:107], v[20:23], v[36:39], v[104:107]
    v_mfma_f32_16x16x32_bf16 v[108:111], v[24:27], v[36:39], v[108:111]
    v_add_u32 v2, s68, v2
    v_add_u32 v3, s68, v3
    v_add_u32 v4, s69, v4
    v_add_u32 v5, s69, v5
    s_waitcnt lgkmcnt(8)
    v_mfma_f32_16x16x32_bf16 v[112:115], v[20:23], v[40:43], v[112:115]
    v_mfma_f32_16x16x32_bf16 v[116:119], v[24:27], v[40:43], v[116:119]
    s_waitcnt lgkmcnt(0)
    s_barrier
    s_cmp_lg_u32 s58, 7
    s_cbranch_scc1 p1Bc0_nohook
    v_mov_b32 v6, 155648
    ds_read_b64 v[6:7], v6
    s_waitcnt lgkmcnt(0)
    v_readfirstlane_b32 s60, v6
    v_readfirstlane_b32 s61, v7
    s_cmp_ge_u32 s52, 14
    s_cbranch_scc1 p1Bc0_cq
    s_mul_i32 s64, s53, 14
    s_add_u32 s64, s64, s52
    s_lshl_b32 s64, s64, 2
    s_add_u32 s64, s64, s57
    s_lshl_b32 s64, s64, 7
    s_add_u32 s64, s64, 32768
    v_mov_b32 v68, v88
    v_mov_b32 v69, v89
    v_mov_b32 v70, s60
    v_mov_b32 v71, s61
    v_and_b32 v73, 1, v0
    v_lshrrev_b32 v72, 1, v0
    v_lshl_add_u32 v72, v73, 2, v72
    v_lshlrev_b32 v72, 4, v72
    s_mov_b64 exec, 0xff
    buffer_store_dwordx4 v[68:71], v72, s[44:47], s64 offen sc1
    s_mov_b64 exec, -1
p1Bc0_cq:
p1Bc0_nohook:
    v_mfma_f32_16x16x32_bf16 v[120:123], v[20:23], v[44:47], v[120:123]
    ds_read_b128 v[8:11], v2 offset:0
    ds_read_b128 v[12:15], v2 offset:2048
    v_mfma_f32_16x16x32_bf16 v[124:127], v[24:27], v[44:47], v[124:127]
    ds_read_b64_tr_b16 v[32:33], v4 offset:0
    ds_read_b64_tr_b16 v[34:35], v4 offset:7168
    v_mfma_f32_16x16x32_bf16 v[128:131], v[20:23], v[48:51], v[128:131]
    ds_read_b64_tr_b16 v[36:37], v5 offset:0
    ds_read_b64_tr_b16 v[38:39], v5 offset:7168
    v_mfma_f32_16x16x32_bf16 v[132:135], v[24:27], v[48:51], v[132:135]
    ds_read_b64_tr_b16 v[40:41], v4 offset:64
    ds_read_b64_tr_b16 v[42:43], v4 offset:7232
    v_mfma_f32_16x16x32_bf16 v[136:139], v[20:23], v[52:55], v[136:139]
    ds_read_b64_tr_b16 v[44:45], v5 offset:64
    ds_read_b64_tr_b16 v[46:47], v5 offset:7232
    v_mfma_f32_16x16x32_bf16 v[140:143], v[24:27], v[52:55], v[140:143]
    ds_read_b64_tr_b16 v[48:49], v4 offset:128
    ds_read_b64_tr_b16 v[50:51], v4 offset:7296
    v_mfma_f32_16x16x32_bf16 v[144:147], v[20:23], v[56:59], v[144:147]
    ds_read_b64_tr_b16 v[52:53], v5 offset:128
    ds_read_b64_tr_b16 v[54:55], v5 offset:7296
    v_mfma_f32_16x16x32_bf16 v[148:151], v[24:27], v[56:59], v[148:151]
    ds_read_b64_tr_b16 v[56:57], v4 offset:192
    ds_read_b64_tr_b16 v[58:59], v4 offset:7360
    s_sub_u32 s58, s58, 1
    s_cmp_lg_u32 s58, 0
    s_cbranch_scc1 p1Bc0_loop
    s_waitcnt lgkmcnt(0)
    s_waitcnt vmcnt(0)
    s_setprio 3
    s_mov_b32 s62, 0xbdd2d3e8
    s_mov_b32 s63, 0xbdd2d3e8
    s_mov_b32 s78, 1.0
    s_mov_b32 s79, 1.0
    v_mov_b32 v44, 0xc0135761
    v_mov_b32 v45, 0xc0135761
    v_and_b32 v4, 15, v0
    v_lshrrev_b32 v5, 4, v0
    s_lshl_b32 s72, s57, 7
    s_add_u32 s72, s72, 153664
    v_lshlrev_b32 v4, 2, v4
    v_lshlrev_b32 v5, 4, v5
    v_add_u32 v7, s72, v5
    v_add_u32 v4, 154752, v4
    v_lshlrev_b32 v14, 4, v0
    ds_read_b128 v[20:23], v7 offset:0
    ds_read_b128 v[28:31], v7 offset:576
    ds_read_b128 v[24:27], v7 offset:64
    ds_read_b128 v[32:35], v7 offset:640
    ds_read_b32 v36, v4 offset:0
    ds_read_b32 v37, v4 offset:64
    ds_read_b32 v38, v4 offset:128
    ds_read_b32 v39, v4 offset:192
    ds_read_b32 v40, v4 offset:256
    ds_read_b32 v41, v4 offset:320
    ds_read_b32 v42, v4 offset:384
    s_waitcnt lgkmcnt(0)
    v_pk_mul_f32 v[48:49], v[28:29], v[36:37] op_sel_hi:[1,0]
    v_pk_fma_f32 v[96:97], v[96:97], v[20:21], v[48:49]
    v_pk_mul_f32 v[50:51], v[30:31], v[36:37] op_sel_hi:[1,0]
    v_pk_fma_f32 v[98:99], v[98:99], v[22:23], v[50:51]
    v_pk_mul_f32 v[52:53], v[32:33], v[36:37] op_sel_hi:[1,0]
    v_pk_fma_f32 v[100:101], v[100:101], v[24:25], v[52:53]
    v_pk_mul_f32 v[54:55], v[34:35], v[36:37] op_sel_hi:[1,0]
    v_pk_fma_f32 v[102:103], v[102:103], v[26:27], v[54:55]
    v_pk_mul_f32 v[56:57], v[28:29], v[36:37] op_sel:[0,1]
    v_pk_fma_f32 v[104:105], v[104:105], v[20:21], v[56:57]
    v_pk_mul_f32 v[58:59], v[30:31], v[36:37] op_sel:[0,1]
    v_pk_fma_f32 v[106:107], v[106:107], v[22:23], v[58:59]
    v_pk_mul_f32 v[60:61], v[32:33], v[36:37] op_sel:[0,1]
    v_pk_fma_f32 v[108:109], v[108:109], v[24:25], v[60:61]
    v_pk_mul_f32 v[62:63], v[34:35], v[36:37] op_sel:[0,1]
    v_pk_fma_f32 v[110:111], v[110:111], v[26:27], v[62:63]
    v_pk_mul_f32 v[48:49], v[28:29], v[38:39] op_sel_hi:[1,0]
    v_pk_fma_f32 v[112:113], v[112:113], v[20:21], v[48:49]
    v_pk_mul_f32 v[50:51], v[30:31], v[38:39] op_sel_hi:[1,0]
    v_pk_fma_f32 v[114:115], v[114:115], v[22:23], v[50:51]
    v_pk_mul_f32 v[52:53], v[32:33], v[38:39] op_sel_hi:[1,0]
    v_pk_fma_f32 v[116:117], v[116:117], v[24:25], v[52:53]
    v_pk_mul_f32 v[54:55], v[34:35], v[38:39] op_sel_hi:[1,0]
    v_pk_fma_f32 v[118:119], v[118:119], v[26:27], v[54:55]
    v_pk_mul_f32 v[56:57], v[28:29], v[38:39] op_sel:[0,1]
    v_pk_fma_f32 v[120:121], v[120:121], v[20:21], v[56:57]
    v_pk_mul_f32 v[58:59], v[30:31], v[38:39] op_sel:[0,1]
    v_pk_fma_f32 v[122:123], v[122:123], v[22:23], v[58:59]
    v_pk_mul_f32 v[60:61], v[32:33], v[38:39] op_sel:[0,1]
    v_pk_fma_f32 v[124:125], v[124:125], v[24:25], v[60:61]
    v_pk_mul_f32 v[62:63], v[34:35], v[38:39] op_sel:[0,1]
    v_pk_fma_f32 v[126:127], v[126:127], v[26:27], v[62:63]
    v_pk_mul_f32 v[48:49], v[28:29], v[40:41] op_sel_hi:[1,0]
    v_pk_fma_f32 v[128:129], v[128:129], v[20:21], v[48:49]
    v_pk_mul_f32 v[50:51], v[30:31], v[40:41] op_sel_hi:[1,0]
    v_pk_fma_f32 v[130:131], v[130:131], v[22:23], v[50:51]
    v_pk_mul_f32 v[52:53], v[32:33], v[40:41] op_sel_hi:[1,0]
    v_pk_fma_f32 v[132:133], v[132:133], v[24:25], v[52:53]
    v_pk_mul_f32 v[54:55], v[34:35], v[40:41] op_sel_hi:[1,0]
    v_pk_fma_f32 v[134:135], v[134:135], v[26:27], v[54:55]
    v_pk_mul_f32 v[56:57], v[28:29], v[40:41] op_sel:[0,1]
    v_pk_fma_f32 v[136:137], v[136:137], v[20:21], v[56:57]
    v_pk_mul_f32 v[58:59], v[30:31], v[40:41] op_sel:[0,1]
    v_pk_fma_f32 v[138:139], v[138:139], v[22:23], v[58:59]
    v_pk_mul_f32 v[60:61], v[32:33], v[40:41] op_sel:[0,1]
    v_pk_fma_f32 v[140:141], v[140:141], v[24:25], v[60:61]
    v_pk_mul_f32 v[62:63], v[34:35], v[40:41] op_sel:[0,1]
    v_pk_fma_f32 v[142:143], v[142:143], v[26:27], v[62:63]
    v_pk_mul_f32 v[48:49], v[28:29], v[42:43] op_sel_hi:[1,0]
    v_pk_fma_f32 v[144:145], v[144:145], v[20:21], v[48:49]
    v_pk_mul_f32 v[50:51], v[30:31], v[42:43] op_sel_hi:[1,0]
    v_pk_fma_f32 v[146:147], v[146:147], v[22:23], v[50:51]
    v_pk_mul_f32 v[52:53], v[32:33], v[42:43] op_sel_hi:[1,0]
    v_pk_fma_f32 v[148:149], v[148:149], v[24:25], v[52:53]
    v_pk_mul_f32 v[54:55], v[34:35], v[42:43] op_sel_hi:[1,0]
    v_pk_fma_f32 v[150:151], v[150:151], v[26:27], v[54:55]
    v_pk_mul_f32 v[48:49], v[96:97], v[96:97]
    v_pk_mul_f32 v[50:51], v[98:99], v[98:99]
    v_pk_mul_f32 v[52:53], v[100:101], v[100:101]
    v_pk_mul_f32 v[54:55], v[102:103], v[102:103]
    v_pk_mul_f32 v[56:57], v[104:105], v[104:105]
    v_pk_mul_f32 v[58:59], v[106:107], v[106:107]
    v_pk_mul_f32 v[60:61], v[108:109], v[108:109]
    v_pk_fma_f32 v[48:49], v[48:49], s[62:63], v[44:45]
    v_pk_fma_f32 v[50:51], v[50:51], s[62:63], v[44:45]
    v_pk_fma_f32 v[52:53], v[52:53], s[62:63], v[44:45]
    v_pk_fma_f32 v[54:55], v[54:55], s[62:63], v[44:45]
    v_pk_fma_f32 v[56:57], v[56:57], s[62:63], v[44:45]
    v_pk_fma_f32 v[58:59], v[58:59], s[62:63], v[44:45]
    v_pk_fma_f32 v[60:61], v[60:61], s[62:63], v[44:45]
    v_pk_mul_f32 v[48:49], v[48:49], v[96:97]
    v_pk_mul_f32 v[50:51], v[50:51], v[98:99]
    v_pk_mul_f32 v[52:53], v[52:53], v[100:101]
    v_pk_mul_f32 v[54:55], v[54:55], v[102:103]
    v_pk_mul_f32 v[56:57], v[56:57], v[104:105]
    v_pk_mul_f32 v[58:59], v[58:59], v[106:107]
    v_pk_mul_f32 v[60:61], v[60:61], v[108:109]
    v_exp_f32 v48, v48
    v_exp_f32 v49, v49
    v_exp_f32 v50, v50
    v_exp_f32 v51, v51
    v_exp_f32 v52, v52
    v_exp_f32 v53, v53
    v_exp_f32 v54, v54
    v_exp_f32 v55, v55
    v_exp_f32 v56, v56
    v_exp_f32 v57, v57
    v_exp_f32 v58, v58
    v_exp_f32 v59, v59
    v_exp_f32 v60, v60
    v_exp_f32 v61, v61
    v_pk_add_f32 v[48:49], v[48:49], s[78:79]
    v_pk_add_f32 v[50:51], v[50:51], s[78:79]
    v_pk_add_f32 v[52:53], v[52:53], s[78:79]
    v_pk_add_f32 v[54:55], v[54:55], s[78:79]
    v_pk_add_f32 v[56:57], v[56:57], s[78:79]
    v_pk_add_f32 v[58:59], v[58:59], s[78:79]
    v_pk_add_f32 v[60:61], v[60:61], s[78:79]
    v_rcp_f32 v48, v48
    v_rcp_f32 v49, v49
    v_rcp_f32 v50, v50
    v_rcp_f32 v51, v51
    v_rcp_f32 v52, v52
    v_rcp_f32 v53, v53
    v_rcp_f32 v54, v54
    v_rcp_f32 v55, v55
    v_rcp_f32 v56, v56
    v_rcp_f32 v57, v57
    v_rcp_f32 v58, v58
    v_rcp_f32 v59, v59
    v_rcp_f32 v60, v60
    v_rcp_f32 v61, v61
    v_pk_mul_f32 v[96:97], v[96:97], v[48:49]
    v_pk_mul_f32 v[98:99], v[98:99], v[50:51]
    v_pk_mul_f32 v[100:101], v[100:101], v[52:53]
    v_pk_mul_f32 v[102:103], v[102:103], v[54:55]
    v_pk_mul_f32 v[104:105], v[104:105], v[56:57]
    v_pk_mul_f32 v[106:107], v[106:107], v[58:59]
    v_pk_mul_f32 v[108:109], v[108:109], v[60:61]
    v_pk_mul_f32 v[48:49], v[110:111], v[110:111]
    v_pk_mul_f32 v[50:51], v[112:113], v[112:113]
    v_pk_mul_f32 v[52:53], v[114:115], v[114:115]
    v_pk_mul_f32 v[54:55], v[116:117], v[116:117]
    v_pk_mul_f32 v[56:57], v[118:119], v[118:119]
    v_pk_mul_f32 v[58:59], v[120:121], v[120:121]
    v_pk_mul_f32 v[60:61], v[122:123], v[122:123]
    v_pk_fma_f32 v[48:49], v[48:49], s[62:63], v[44:45]
    v_pk_fma_f32 v[50:51], v[50:51], s[62:63], v[44:45]
    v_pk_fma_f32 v[52:53], v[52:53], s[62:63], v[44:45]
    v_pk_fma_f32 v[54:55], v[54:55], s[62:63], v[44:45]
    v_pk_fma_f32 v[56:57], v[56:57], s[62:63], v[44:45]
    v_pk_fma_f32 v[58:59], v[58:59], s[62:63], v[44:45]
    v_pk_fma_f32 v[60:61], v[60:61], s[62:63], v[44:45]
    v_pk_mul_f32 v[48:49], v[48:49], v[110:111]
    v_pk_mul_f32 v[50:51], v[50:51], v[112:113]
    v_pk_mul_f32 v[52:53], v[52:53], v[114:115]
    v_pk_mul_f32 v[54:55], v[54:55], v[116:117]
    v_pk_mul_f32 v[56:57], v[56:57], v[118:119]
    v_pk_mul_f32 v[58:59], v[58:59], v[120:121]
    v_pk_mul_f32 v[60:61], v[60:61], v[122:123]
    v_exp_f32 v48, v48
    v_exp_f32 v49, v49
    v_exp_f32 v50, v50
    v_exp_f32 v51, v51
    v_exp_f32 v52, v52
    v_exp_f32 v53, v53
    v_exp_f32 v54, v54
    v_exp_f32 v55, v55
    v_exp_f32 v56, v56
    v_exp_f32 v57, v57
    v_exp_f32 v58, v58
    v_exp_f32 v59, v59
    v_exp_f32 v60, v60
    v_exp_f32 v61, v61
    v_pk_add_f32 v[48:49], v[48:49], s[78:79]
    v_pk_add_f32 v[50:51], v[50:51], s[78:79]
    v_pk_add_f32 v[52:53], v[52:53], s[78:79]
    v_pk_add_f32 v[54:55], v[54:55], s[78:79]
    v_pk_add_f32 v[56:57], v[56:57], s[78:79]
    v_pk_add_f32 v[58:59], v[58:59], s[78:79]
    v_pk_add_f32 v[60:61], v[60:61], s[78:79]
    v_rcp_f32 v48, v48
    v_rcp_f32 v49, v49
    v_rcp_f32 v50, v50
    v_rcp_f32 v51, v51
    v_rcp_f32 v52, v52
    v_rcp_f32 v53, v53
    v_rcp_f32 v54, v54
    v_rcp_f32 v55, v55
    v_rcp_f32 v56, v56
    v_rcp_f32 v57, v57
    v_rcp_f32 v58, v58
    v_rcp_f32 v59, v59
    v_rcp_f32 v60, v60
    v_rcp_f32 v61, v61
    v_pk_mul_f32 v[110:111], v[110:111], v[48:49]
    v_pk_mul_f32 v[112:113], v[112:113], v[50:51]
    v_pk_mul_f32 v[114:115], v[114:115], v[52:53]
    v_pk_mul_f32 v[116:117], v[116:117], v[54:55]
    v_pk_mul_f32 v[118:119], v[118:119], v[56:57]
    v_pk_mul_f32 v[120:121], v[120:121], v[58:59]
    v_pk_mul_f32 v[122:123], v[122:123], v[60:61]
    v_pk_mul_f32 v[48:49], v[124:125], v[124:125]
    v_pk_mul_f32 v[50:51], v[126:127], v[126:127]
    v_pk_mul_f32 v[52:53], v[128:129], v[128:129]
    v_pk_mul_f32 v[54:55], v[130:131], v[130:131]
    v_pk_mul_f32 v[56:57], v[132:133], v[132:133]
    v_pk_mul_f32 v[58:59], v[134:135], v[134:135]
    v_pk_mul_f32 v[60:61], v[136:137], v[136:137]
    v_pk_fma_f32 v[48:49], v[48:49], s[62:63], v[44:45]
    v_pk_fma_f32 v[50:51], v[50:51], s[62:63], v[44:45]
    v_pk_fma_f32 v[52:53], v[52:53], s[62:63], v[44:45]
    v_pk_fma_f32 v[54:55], v[54:55], s[62:63], v[44:45]
    v_pk_fma_f32 v[56:57], v[56:57], s[62:63], v[44:45]
    v_pk_fma_f32 v[58:59], v[58:59], s[62:63], v[44:45]
    v_pk_fma_f32 v[60:61], v[60:61], s[62:63], v[44:45]
    v_pk_mul_f32 v[48:49], v[48:49], v[124:125]
    v_pk_mul_f32 v[50:51], v[50:51], v[126:127]
    v_pk_mul_f32 v[52:53], v[52:53], v[128:129]
    v_pk_mul_f32 v[54:55], v[54:55], v[130:131]
    v_pk_mul_f32 v[56:57], v[56:57], v[132:133]
    v_pk_mul_f32 v[58:59], v[58:59], v[134:135]
    v_pk_mul_f32 v[60:61], v[60:61], v[136:137]
    v_exp_f32 v48, v48
    v_exp_f32 v49, v49
    v_exp_f32 v50, v50
    v_exp_f32 v51, v51
    v_exp_f32 v52, v52
    v_exp_f32 v53, v53
    v_exp_f32 v54, v54
    v_exp_f32 v55, v55
    v_exp_f32 v56, v56
    v_exp_f32 v57, v57
    v_exp_f32 v58, v58
    v_exp_f32 v59, v59
    v_exp_f32 v60, v60
    v_exp_f32 v61, v61
    v_pk_add_f32 v[48:49], v[48:49], s[78:79]
    v_pk_add_f32 v[50:51], v[50:51], s[78:79]
    v_pk_add_f32 v[52:53], v[52:53], s[78:79]
    v_pk_add_f32 v[54:55], v[54:55], s[78:79]
    v_pk_add_f32 v[56:57], v[56:57], s[78:79]
    v_pk_add_f32 v[58:59], v[58:59], s[78:79]
    v_pk_add_f32 v[60:61], v[60:61], s[78:79]
    v_rcp_f32 v48, v48
    v_rcp_f32 v49, v49
    v_rcp_f32 v50, v50
    v_rcp_f32 v51, v51
    v_rcp_f32 v52, v52
    v_rcp_f32 v53, v53
    v_rcp_f32 v54, v54
    v_rcp_f32 v55, v55
    v_rcp_f32 v56, v56
    v_rcp_f32 v57, v57
    v_rcp_f32 v58, v58
    v_rcp_f32 v59, v59
    v_rcp_f32 v60, v60
    v_rcp_f32 v61, v61
    v_pk_mul_f32 v[124:125], v[124:125], v[48:49]
    v_pk_mul_f32 v[126:127], v[126:127], v[50:51]
    v_pk_mul_f32 v[128:129], v[128:129], v[52:53]
    v_pk_mul_f32 v[130:131], v[130:131], v[54:55]
    v_pk_mul_f32 v[132:133], v[132:133], v[56:57]
    v_pk_mul_f32 v[134:135], v[134:135], v[58:59]
    v_pk_mul_f32 v[136:137], v[136:137], v[60:61]
    v_pk_mul_f32 v[48:49], v[138:139], v[138:139]
    v_pk_mul_f32 v[50:51], v[140:141], v[140:141]
    v_pk_mul_f32 v[52:53], v[142:143], v[142:143]
    v_pk_mul_f32 v[54:55], v[144:145], v[144:145]
    v_pk_mul_f32 v[56:57], v[146:147], v[146:147]
    v_pk_mul_f32 v[58:59], v[148:149], v[148:149]
    v_pk_mul_f32 v[60:61], v[150:151], v[150:151]
    v_pk_fma_f32 v[48:49], v[48:49], s[62:63], v[44:45]
    v_pk_fma_f32 v[50:51], v[50:51], s[62:63], v[44:45]
    v_pk_fma_f32 v[52:53], v[52:53], s[62:63], v[44:45]
    v_pk_fma_f32 v[54:55], v[54:55], s[62:63], v[44:45]
    v_pk_fma_f32 v[56:57], v[56:57], s[62:63], v[44:45]
    v_pk_fma_f32 v[58:59], v[58:59], s[62:63], v[44:45]
    v_pk_fma_f32 v[60:61], v[60:61], s[62:63], v[44:45]
    v_pk_mul_f32 v[48:49], v[48:49], v[138:139]
    v_pk_mul_f32 v[50:51], v[50:51], v[140:141]
    v_pk_mul_f32 v[52:53], v[52:53], v[142:143]
    v_pk_mul_f32 v[54:55], v[54:55], v[144:145]
    v_pk_mul_f32 v[56:57], v[56:57], v[146:147]
    v_pk_mul_f32 v[58:59], v[58:59], v[148:149]
    v_pk_mul_f32 v[60:61], v[60:61], v[150:151]
    v_exp_f32 v48, v48
    v_exp_f32 v49, v49
    v_exp_f32 v50, v50
    v_exp_f32 v51, v51
    v_exp_f32 v52, v52
    v_exp_f32 v53, v53
    v_exp_f32 v54, v54
    v_exp_f32 v55, v55
    v_exp_f32 v56, v56
    v_exp_f32 v57, v57
    v_exp_f32 v58, v58
    v_exp_f32 v59, v59
    v_exp_f32 v60, v60
    v_exp_f32 v61, v61
    v_pk_add_f32 v[48:49], v[48:49], s[78:79]
    v_pk_add_f32 v[50:51], v[50:51], s[78:79]
    v_pk_add_f32 v[52:53], v[52:53], s[78:79]
    v_pk_add_f32 v[54:55], v[54:55], s[78:79]
    v_pk_add_f32 v[56:57], v[56:57], s[78:79]
    v_pk_add_f32 v[58:59], v[58:59], s[78:79]
    v_pk_add_f32 v[60:61], v[60:61], s[78:79]
    v_rcp_f32 v48, v48
    v_rcp_f32 v49, v49
    v_rcp_f32 v50, v50
    v_rcp_f32 v51, v51
    v_rcp_f32 v52, v52
    v_rcp_f32 v53, v53
    v_rcp_f32 v54, v54
    v_rcp_f32 v55, v55
    v_rcp_f32 v56, v56
    v_rcp_f32 v57, v57
    v_rcp_f32 v58, v58
    v_rcp_f32 v59, v59
    v_rcp_f32 v60, v60
    v_rcp_f32 v61, v61
    v_pk_mul_f32 v[138:139], v[138:139], v[48:49]
    v_pk_mul_f32 v[140:141], v[140:141], v[50:51]
    v_pk_mul_f32 v[142:143], v[142:143], v[52:53]
    v_pk_mul_f32 v[144:145], v[144:145], v[54:55]
    v_pk_mul_f32 v[146:147], v[146:147], v[56:57]
    v_pk_mul_f32 v[148:149], v[148:149], v[58:59]
    v_pk_mul_f32 v[150:151], v[150:151], v[60:61]
    v_pk_mul_f32 v[72:73], v[96:97], v[96:97]
    v_pk_add_f32 v[64:65], v[96:97], v[104:105]
    v_pk_fma_f32 v[72:73], v[104:105], v[104:105], v[72:73]
    v_pk_add_f32 v[64:65], v[64:65], v[112:113]
    v_pk_fma_f32 v[72:73], v[112:113], v[112:113], v[72:73]
    v_pk_add_f32 v[64:65], v[64:65], v[120:121]
    v_pk_fma_f32 v[72:73], v[120:121], v[120:121], v[72:73]
    v_pk_add_f32 v[64:65], v[64:65], v[128:129]
    v_pk_fma_f32 v[72:73], v[128:129], v[128:129], v[72:73]
    v_pk_add_f32 v[64:65], v[64:65], v[136:137]
    v_pk_fma_f32 v[72:73], v[136:137], v[136:137], v[72:73]
    v_pk_add_f32 v[64:65], v[64:65], v[144:145]
    v_pk_fma_f32 v[72:73], v[144:145], v[144:145], v[72:73]
    v_pk_mul_f32 v[74:75], v[98:99], v[98:99]
    v_pk_add_f32 v[66:67], v[98:99], v[106:107]
    v_pk_fma_f32 v[74:75], v[106:107], v[106:107], v[74:75]
    v_pk_add_f32 v[66:67], v[66:67], v[114:115]
    v_pk_fma_f32 v[74:75], v[114:115], v[114:115], v[74:75]
    v_pk_add_f32 v[66:67], v[66:67], v[122:123]
    v_pk_fma_f32 v[74:75], v[122:123], v[122:123], v[74:75]
    v_pk_add_f32 v[66:67], v[66:67], v[130:131]
    v_pk_fma_f32 v[74:75], v[130:131], v[130:131], v[74:75]
    v_pk_add_f32 v[66:67], v[66:67], v[138:139]
    v_pk_fma_f32 v[74:75], v[138:139], v[138:139], v[74:75]
    v_pk_add_f32 v[66:67], v[66:67], v[146:147]
    v_pk_fma_f32 v[74:75], v[146:147], v[146:147], v[74:75]
    v_pk_mul_f32 v[76:77], v[100:101], v[100:101]
    v_pk_add_f32 v[68:69], v[100:101], v[108:109]
    v_pk_fma_f32 v[76:77], v[108:109], v[108:109], v[76:77]
    v_pk_add_f32 v[68:69], v[68:69], v[116:117]
    v_pk_fma_f32 v[76:77], v[116:117], v[116:117], v[76:77]
    v_pk_add_f32 v[68:69], v[68:69], v[124:125]
    v_pk_fma_f32 v[76:77], v[124:125], v[124:125], v[76:77]
    v_pk_add_f32 v[68:69], v[68:69], v[132:133]
    v_pk_fma_f32 v[76:77], v[132:133], v[132:133], v[76:77]
    v_pk_add_f32 v[68:69], v[68:69], v[140:141]
    v_pk_fma_f32 v[76:77], v[140:141], v[140:141], v[76:77]
    v_pk_add_f32 v[68:69], v[68:69], v[148:149]
    v_pk_fma_f32 v[76:77], v[148:149], v[148:149], v[76:77]
    v_pk_mul_f32 v[78:79], v[102:103], v[102:103]
    v_pk_add_f32 v[70:71], v[102:103], v[110:111]
    v_pk_fma_f32 v[78:79], v[110:111], v[110:111], v[78:79]
    v_pk_add_f32 v[70:71], v[70:71], v[118:119]
    v_pk_fma_f32 v[78:79], v[118:119], v[118:119], v[78:79]
    v_pk_add_f32 v[70:71], v[70:71], v[126:127]
    v_pk_fma_f32 v[78:79], v[126:127], v[126:127], v[78:79]
    v_pk_add_f32 v[70:71], v[70:71], v[134:135]
    v_pk_fma_f32 v[78:79], v[134:135], v[134:135], v[78:79]
    v_pk_add_f32 v[70:71], v[70:71], v[142:143]
    v_pk_fma_f32 v[78:79], v[142:143], v[142:143], v[78:79]
    v_pk_add_f32 v[70:71], v[70:71], v[150:151]
    v_pk_fma_f32 v[78:79], v[150:151], v[150:151], v[78:79]
    v_add_f32_dpp v48, v64, v64 row_mirror row_mask:0xf bank_mask:0x3
    v_add_f32_dpp v49, v65, v65 row_mirror row_mask:0xf bank_mask:0x3
    v_add_f32_dpp v50, v66, v66 row_mirror row_mask:0xf bank_mask:0x3
    v_add_f32_dpp v51, v67, v67 row_mirror row_mask:0xf bank_mask:0x3
    v_add_f32_dpp v52, v68, v68 row_mirror row_mask:0xf bank_mask:0x3
    v_add_f32_dpp v53, v69, v69 row_mirror row_mask:0xf bank_mask:0x3
    v_add_f32_dpp v54, v70, v70 row_mirror row_mask:0xf bank_mask:0x3
    v_add_f32_dpp v55, v71, v71 row_mirror row_mask:0xf bank_mask:0x3
    v_add_f32_dpp v48, v72, v72 row_mirror row_mask:0xf bank_mask:0xc
    v_add_f32_dpp v49, v73, v73 row_mirror row_mask:0xf bank_mask:0xc
    v_add_f32_dpp v50, v74, v74 row_mirror row_mask:0xf bank_mask:0xc
    v_add_f32_dpp v51, v75, v75 row_mirror row_mask:0xf bank_mask:0xc
    v_add_f32_dpp v52, v76, v76 row_mirror row_mask:0xf bank_mask:0xc
    v_add_f32_dpp v53, v77, v77 row_mirror row_mask:0xf bank_mask:0xc
    v_add_f32_dpp v54, v78, v78 row_mirror row_mask:0xf bank_mask:0xc
    v_add_f32_dpp v55, v79, v79 row_mirror row_mask:0xf bank_mask:0xc
    v_add_f32_dpp v56, v48, v48 row_half_mirror row_mask:0xf bank_mask:0x5
    v_add_f32_dpp v57, v49, v49 row_half_mirror row_mask:0xf bank_mask:0x5
    v_add_f32_dpp v58, v50, v50 row_half_mirror row_mask:0xf bank_mask:0x5
    v_add_f32_dpp v59, v51, v51 row_half_mirror row_mask:0xf bank_mask:0x5
    v_add_f32_dpp v56, v52, v52 row_half_mirror row_mask:0xf bank_mask:0xa
    v_add_f32_dpp v57, v53, v53 row_half_mirror row_mask:0xf bank_mask:0xa
    v_add_f32_dpp v58, v54, v54 row_half_mirror row_mask:0xf bank_mask:0xa
    v_add_f32_dpp v59, v55, v55 row_half_mirror row_mask:0xf bank_mask:0xa
    s_mov_b32 s74, 0xcccccccc
    s_mov_b32 s75, 0xcccccccc
    s_mov_b32 s76, 0xaaaaaaaa
    s_mov_b32 s77, 0xaaaaaaaa
    v_cndmask_b32 v60, v56, v58, s[74:75]
    v_cndmask_b32 v62, v58, v56, s[74:75]
    v_cndmask_b32 v61, v57, v59, s[74:75]
    v_cndmask_b32 v63, v59, v57, s[74:75]
    v_add_f32_dpp v60, v62, v60 quad_perm:[2,3,0,1] row_mask:0xf bank_mask:0xf
    s_nop 0
    v_add_f32_dpp v61, v63, v61 quad_perm:[2,3,0,1] row_mask:0xf bank_mask:0xf
    v_cndmask_b32 v64, v60, v61, s[76:77]
    v_cndmask_b32 v65, v61, v60, s[76:77]
    s_nop 1
    v_add_f32_dpp v64, v65, v64 quad_perm:[1,0,3,2] row_mask:0xf bank_mask:0xf
    s_nop 1
    v_mov_b32_dpp v65, v64 row_ror:8 row_mask:0xf bank_mask:0xf
    v_mov_b32 v66, s60
    v_mov_b32 v67, s61
    v_bfe_u32 v68, v0, 2, 1
    v_lshlrev_b32 v68, 4, v68
    v_lshrrev_b32 v69, 4, v0
    v_lshl_add_u32 v68, v69, 2, v68
    v_and_b32 v69, 3, v0
    v_add_u32 v68, v68, v69
    v_lshlrev_b32 v68, 4, v68
    s_lshl_b32 s72, s52, 2
    s_add_u32 s72, s72, s57
    s_lshl_b32 s73, s72, 12
    s_add_u32 s73, s73, 196608
    s_lshl_b32 s72, s54, 9
    s_add_u32 s72, s72, s73
    s_mov_b32 s74, 0xff00ff
    s_mov_b32 s75, 0xff00ff
    s_mov_b64 exec, s[74:75]
    buffer_store_dwordx4 v[64:67], v68, s[44:47], s72 offen sc1
    s_mov_b64 exec, -1
    s_mov_b32 s55, 40000
p1Bc0_again:
    buffer_load_dwordx4 v[80:83], v14, s[44:47], s73 offen offset:0 sc1
    buffer_load_dwordx4 v[84:87], v14, s[44:47], s73 offen offset:1024 sc1
    buffer_load_dwordx4 v[88:91], v14, s[44:47], s73 offen offset:2048 sc1
    buffer_load_dwordx4 v[92:95], v14, s[44:47], s73 offen offset:3072 sc1
    s_waitcnt vmcnt(0)
    v_cmp_eq_u32 vcc, s60, v82
    v_cmp_eq_u32 s[76:77], s61, v83
    s_and_b64 vcc, vcc, s[76:77]
    s_mov_b64 s[80:81], vcc
    v_cmp_eq_u32 vcc, s60, v86
    v_cmp_eq_u32 s[76:77], s61, v87
    s_and_b64 vcc, vcc, s[76:77]
    s_and_b64 s[80:81], s[80:81], vcc
    v_cmp_eq_u32 vcc, s60, v90
    v_cmp_eq_u32 s[76:77], s61, v91
    s_and_b64 vcc, vcc, s[76:77]
    s_and_b64 s[80:81], s[80:81], vcc
    v_cmp_eq_u32 vcc, s60, v94
    v_cmp_eq_u32 s[76:77], s61, v95
    s_and_b64 vcc, vcc, s[76:77]
    s_and_b64 s[80:81], s[80:81], vcc
    s_cmp_eq_u64 s[80:81], -1
    s_cbranch_scc1 p1Bc0_ok
    s_sub_u32 s55, s55, 1
    s_cmp_lg_u32 s55, 0
    s_cbranch_scc1 p1Bc0_again
p1Bc0_ok:
    v_pk_add_f32 v[80:81], v[80:81], v[84:85]
    v_pk_add_f32 v[88:89], v[88:89], v[92:93]
    v_pk_add_f32 v[52:53], v[80:81], v[88:89]
    v_mov_b32 v54, v52
    v_mov_b32 v55, v53
    s_nop 0
    v_permlane32_swap_b32 v52, v54
    v_permlane32_swap_b32 v53, v55
    v_pk_add_f32 v[52:53], v[52:53], v[54:55]
    v_mul_f32 v52, 0x3a924925, v52
    v_mul_f32 v53, 0x3a924925, v53
    v_fma_f32 v53, -v52, v52, v53
    v_max_f32 v53, 0, v53
    v_add_f32 v53, 0x3727c5ac, v53
    v_rsq_f32 v53, v53
    s_nop 0
    v_mul_f32 v52, v52, v53
    v_sub_f32 v52, 0, v52
    v_and_b32 v54, 31, v0
    v_lshlrev_b32 v54, 2, v54
    s_lshl_b32 s72, s3, 8
    s_add_u32 s72, s72, 155712
    v_add_u32 v54, s72, v54
    ds_write_b32 v54, v53
    ds_write_b32 v54, v52 offset:128
    v_lshrrev_b32 v55, 4, v0
    v_lshlrev_b32 v55, 4, v55
    v_add_u32 v55, s72, v55
    s_waitcnt lgkmcnt(0)
    ds_read_b128 v[20:23], v55 offset:0
    ds_read_b128 v[28:31], v55 offset:128
    ds_read_b128 v[24:27], v55 offset:64
    ds_read_b128 v[32:35], v55 offset:192
    s_lshl_b32 s72, s52, 2
    s_add_u32 s72, s72, s57
    s_mul_i32 s72, s72, 57344
    s_mul_i32 s74, s54, 7168
    s_add_u32 s72, s72, s74
    s_add_u32 s72, s72, 1048576
    s_add_u32 s73, s72, 4096
    s_waitcnt lgkmcnt(0)
    v_pk_fma_f32 v[96:97], v[96:97], v[20:21], v[28:29]
    v_pk_fma_f32 v[98:99], v[98:99], v[22:23], v[30:31]
    v_pk_fma_f32 v[100:101], v[100:101], v[24:25], v[32:33]
    v_pk_fma_f32 v[102:103], v[102:103], v[26:27], v[34:35]
    v_cvt_pk_bf16_f32 v96, v96, v97
    v_cvt_pk_bf16_f32 v97, v98, v99
    v_cvt_pk_bf16_f32 v98, v100, v101
    v_cvt_pk_bf16_f32 v99, v102, v103
    buffer_store_dwordx4 v[96:99], v14, s[44:47], s72 offen offset:0 sc1
    v_pk_fma_f32 v[104:105], v[104:105], v[20:21], v[28:29]
    v_pk_fma_f32 v[106:107], v[106:107], v[22:23], v[30:31]
    v_pk_fma_f32 v[108:109], v[108:109], v[24:25], v[32:33]
    v_pk_fma_f32 v[110:111], v[110:111], v[26:27], v[34:35]
    v_cvt_pk_bf16_f32 v104, v104, v105
    v_cvt_pk_bf16_f32 v105, v106, v107
    v_cvt_pk_bf16_f32 v106, v108, v109
    v_cvt_pk_bf16_f32 v107, v110, v111
    buffer_store_dwordx4 v[104:107], v14, s[44:47], s72 offen offset:1024 sc1
    v_pk_fma_f32 v[112:113], v[112:113], v[20:21], v[28:29]
    v_pk_fma_f32 v[114:115], v[114:115], v[22:23], v[30:31]
    v_pk_fma_f32 v[116:117], v[116:117], v[24:25], v[32:33]
    v_pk_fma_f32 v[118:119], v[118:119], v[26:27], v[34:35]
    v_cvt_pk_bf16_f32 v112, v112, v113
    v_cvt_pk_bf16_f32 v113, v114, v115
    v_cvt_pk_bf16_f32 v114, v116, v117
    v_cvt_pk_bf16_f32 v115, v118, v119
    buffer_store_dwordx4 v[112:115], v14, s[44:47], s72 offen offset:2048 sc1
    v_pk_fma_f32 v[120:121], v[120:121], v[20:21], v[28:29]
    v_pk_fma_f32 v[122:123], v[122:123], v[22:23], v[30:31]
    v_pk_fma_f32 v[124:125], v[124:125], v[24:25], v[32:33]
    v_pk_fma_f32 v[126:127], v[126:127], v[26:27], v[34:35]
    v_cvt_pk_bf16_f32 v120, v120, v121
    v_cvt_pk_bf16_f32 v121, v122, v123
    v_cvt_pk_bf16_f32 v122, v124, v125
    v_cvt_pk_bf16_f32 v123, v126, v127
    buffer_store_dwordx4 v[120:123], v14, s[44:47], s72 offen offset:3072 sc1
    v_pk_fma_f32 v[128:129], v[128:129], v[20:21], v[28:29]
    v_pk_fma_f32 v[130:131], v[130:131], v[22:23], v[30:31]
    v_pk_fma_f32 v[132:133], v[132:133], v[24:25], v[32:33]
    v_pk_fma_f32 v[134:135], v[134:135], v[26:27], v[34:35]
    v_cvt_pk_bf16_f32 v128, v128, v129
    v_cvt_pk_bf16_f32 v129, v130, v131
    v_cvt_pk_bf16_f32 v130, v132, v133
    v_cvt_pk_bf16_f32 v131, v134, v135
    buffer_store_dwordx4 v[128:131], v14, s[44:47], s73 offen offset:0 sc1
    v_pk_fma_f32 v[136:137], v[136:137], v[20:21], v[28:29]
    v_pk_fma_f32 v[138:139], v[138:139], v[22:23], v[30:31]
    v_pk_fma_f32 v[140:141], v[140:141], v[24:25], v[32:33]
    v_pk_fma_f32 v[142:143], v[142:143], v[26:27], v[34:35]
    v_cvt_pk_bf16_f32 v136, v136, v137
    v_cvt_pk_bf16_f32 v137, v138, v139
    v_cvt_pk_bf16_f32 v138, v140, v141
    v_cvt_pk_bf16_f32 v139, v142, v143
    buffer_store_dwordx4 v[136:139], v14, s[44:47], s73 offen offset:1024 sc1
    v_pk_fma_f32 v[144:145], v[144:145], v[20:21], v[28:29]
    v_pk_fma_f32 v[146:147], v[146:147], v[22:23], v[30:31]
    v_pk_fma_f32 v[148:149], v[148:149], v[24:25], v[32:33]
    v_pk_fma_f32 v[150:151], v[150:151], v[26:27], v[34:35]
    v_cvt_pk_bf16_f32 v144, v144, v145
    v_cvt_pk_bf16_f32 v145, v146, v147
    v_cvt_pk_bf16_f32 v146, v148, v149
    v_cvt_pk_bf16_f32 v147, v150, v151
    buffer_store_dwordx4 v[144:147], v14, s[44:47], s73 offen offset:2048 sc1
    s_lshl_b32 s72, s52, 2
    s_add_u32 s72, s72, s57
    s_lshl_b32 s72, s72, 8
    s_lshl_b32 s73, s54, 14
    s_add_u32 s72, s72, s73
    s_add_u32 s31, s72, 21037056
    s_barrier
    s_waitcnt vmcnt(0)
    v_mov_b32 v56, s60
    v_mov_b32 v57, s61
    v_mov_b32 v58, 0
    s_mov_b64 exec, 1
    buffer_store_dwordx2 v[56:57], v58, s[44:47], s31 offen sc1
    s_mov_b64 exec, -1
    s_mov_b32 s31, 0x7ff00000
    s_setprio 0
f_p2a:
    v_lshlrev_b32 v5, 4, v0
    v_lshlrev_b32 v6, 3, v0
    s_and_b32 s63, s3, 3
    v_add_u32 v2, 81920, v5
    v_and_b32 v40, 15, v0
    v_lshrrev_b32 v41, 4, v0
    v_lshrrev_b32 v42, 1, v41
    v_lshrrev_b32 v43, 1, v40
    v_xor_b32 v42, v42, v43
    v_lshlrev_b32 v42, 4, v42
    v_and_b32 v41, 1, v41
    v_lshl_add_u32 v42, v41, 3, v42
    v_lshl_add_u32 v42, v40, 7, v42
    s_lshl_b32 s66, s63, 12
    v_add_u32 v3, s66, v42
    v_xor_b32 v4, 32, v3
    s_cmp_eq_u32 s6, 0
    s_cselect_b32 s66, -1, 0
    v_lshlrev_b32 v7, 16, v162
    v_and_b32 v7, s66, v7
    v_mov_b32 v96, v7
    v_mov_b32 v97, v7
    v_mov_b32 v98, v7
    v_mov_b32 v99, v7
    v_mov_b32 v100, 0
    v_mov_b32 v101, 0
    v_mov_b32 v102, 0
    v_mov_b32 v103, 0
    v_mov_b32 v104, v7
    v_mov_b32 v105, v7
    v_mov_b32 v106, v7
    v_mov_b32 v107, v7
    v_mov_b32 v108, 0
    v_mov_b32 v109, 0
    v_mov_b32 v110, 0
    v_mov_b32 v111, 0
    v_mov_b32 v112, v7
    v_mov_b32 v113, v7
    v_mov_b32 v114, v7
    v_mov_b32 v115, v7
    v_mov_b32 v116, 0
    v_mov_b32 v117, 0
    v_mov_b32 v118, 0
    v_mov_b32 v119, 0
    v_mov_b32 v120, v7
    v_mov_b32 v121, v7
    v_mov_b32 v122, v7
    v_mov_b32 v123, v7
    v_mov_b32 v124, 0
    v_mov_b32 v125, 0
    v_mov_b32 v126, 0
    v_mov_b32 v127, 0
    v_mov_b32 v128, v7
    v_mov_b32 v129, v7
    v_mov_b32 v130, v7
    v_mov_b32 v131, v7
    v_mov_b32 v132, 0
    v_mov_b32 v133, 0
    v_mov_b32 v134, 0
    v_mov_b32 v135, 0
    v_mov_b32 v136, v7
    v_mov_b32 v137, v7
    v_mov_b32 v138, v7
    v_mov_b32 v139, v7
    v_mov_b32 v140, 0
    v_mov_b32 v141, 0
    v_mov_b32 v142, 0
    v_mov_b32 v143, 0
    v_mov_b32 v144, v7
    v_mov_b32 v145, v7
    v_mov_b32 v146, v7
    v_mov_b32 v147, v7
    v_mov_b32 v148, 0
    v_mov_b32 v149, 0
    v_mov_b32 v150, 0
    v_mov_b32 v151, 0
    s_lshl_b32 s72, s4, 2
    s_add_u32 s72, s72, s63
    s_lshl_b32 s73, s72, 3
    s_add_u32 s73, s73, s5
    s_lshl_b32 s76, s73, 3
    s_add_u32 s76, s76, 20975616
    s_lshl_b32 s73, s72, 1
    s_lshl_b32 s73, s73, 3
    s_add_u32 s73, s73, s5
    s_lshl_b32 s77, s73, 1
    s_add_u32 s77, s77, s6
    s_lshl_b32 s77, s77, 3
    s_add_u32 s77, s77, 20987904
    s_mul_i32 s73, s73, 3584
    s_add_u32 s79, s73, 5242880
    s_mul_i32 s81, s6, 3670016
    s_add_u32 s81, s81, s73
    s_add_u32 s81, s81, 12582912
    s_lshr_b32 s67, s3, 1
    s_and_b32 s66, s3, 1
    s_lshl_b32 s68, s7, 1
    s_add_u32 s68, s68, s66
    s_lshl_b32 s70, s67, 2
    s_lshl_b32 s84, s68, 4
    s_add_u32 s84, s84, s70
    s_lshl_b32 s84, s84, 3
    s_add_u32 s84, s84, 20979712
    s_lshl_b32 s85, s68, 5
    s_add_u32 s85, s85, s70
    s_lshl_b32 s85, s85, 10
    s_add_u32 s85, s85, 9437184
    s_add_u32 s86, s85, 16384
    v_mov_b32 v156, 0
    v_and_b32 v157, 3, v0
    v_lshlrev_b32 v157, 3, v157
    s_mov_b32 s66, 0
    s_mov_b32 s70, 16384
    s_mov_b32 s71, 14336
    s_mov_b32 s69, 7
    s_barrier
    ds_read_b64 v[8:9], v3 offset:0
    ds_read_b64 v[10:11], v4 offset:0
    ds_read_b64 v[12:13], v3 offset:2048
    ds_read_b64 v[14:15], v4 offset:2048
    ds_read_b128 v[24:27], v2 offset:0
    ds_read_b128 v[28:31], v2 offset:1024
    ds_read_b128 v[32:35], v2 offset:2048
    ds_read_b128 v[36:39], v2 offset:3072
    ds_read_b128 v[40:43], v2 offset:4096
    ds_read_b128 v[44:47], v2 offset:5120
    ds_read_b128 v[48:51], v2 offset:6144
    s_cmp_ge_u32 s53, 8
    s_cbranch_scc1 p2c0_dB
    buffer_store_dwordx4 v[64:67], v5, s[44:47], s74 offen sc1
    buffer_store_dwordx4 v[68:71], v5, s[44:47], s75 offen sc1
p2c0_dB:
p2c0_loop:
    s_waitcnt lgkmcnt(7)
    s_waitcnt lgkmcnt(6)
    v_mfma_f32_16x16x32_bf16 v[96:99], v[24:27], v[8:11], v[96:99]
    v_mfma_f32_16x16x32_bf16 v[100:103], v[24:27], v[12:15], v[100:103]
    s_waitcnt lgkmcnt(5)
    v_mfma_f32_16x16x32_bf16 v[104:107], v[28:31], v[8:11], v[104:107]
    v_mfma_f32_16x16x32_bf16 v[108:111], v[28:31], v[12:15], v[108:111]
    s_waitcnt lgkmcnt(4)
    v_mfma_f32_16x16x32_bf16 v[112:115], v[32:35], v[8:11], v[112:115]
    v_mfma_f32_16x16x32_bf16 v[116:119], v[32:35], v[12:15], v[116:119]
    s_barrier
    s_add_u32 s66, s66, 1
    s_cmp_eq_u32 s66, 5
    s_cselect_b32 s67, -65536, s70
    s_cselect_b32 s68, -57344, s71
    s_cselect_b32 s66, 0, s66
    v_add_u32 v3, s67, v3
    v_add_u32 v4, s67, v4
    v_add_u32 v2, s68, v2
    s_cmp_lg_u32 s69, 2
    s_cbranch_scc1 p2c0_nh2
    buffer_load_dwordx2 v[152:153], v156, s[44:47], s76 offen sc1
    buffer_load_dwordx2 v[154:155], v157, s[44:47], s84 offen sc1
p2c0_nh2:
    s_waitcnt lgkmcnt(3)
    v_mfma_f32_16x16x32_bf16 v[120:123], v[36:39], v[8:11], v[120:123]
    ds_read_b64 v[16:17], v3 offset:0
    ds_read_b64 v[18:19], v4 offset:0
    v_mfma_f32_16x16x32_bf16 v[124:127], v[36:39], v[12:15], v[124:127]
    ds_read_b64 v[20:21], v3 offset:2048
    ds_read_b64 v[22:23], v4 offset:2048
    s_waitcnt lgkmcnt(6)
    v_mfma_f32_16x16x32_bf16 v[128:131], v[40:43], v[8:11], v[128:131]
    ds_read_b128 v[24:27], v2 offset:0
    ds_read_b128 v[28:31], v2 offset:1024
    v_mfma_f32_16x16x32_bf16 v[132:135], v[40:43], v[12:15], v[132:135]
    ds_read_b128 v[32:35], v2 offset:2048
    ds_read_b128 v[36:39], v2 offset:3072
    s_waitcnt lgkmcnt(9)
    v_mfma_f32_16x16x32_bf16 v[136:139], v[44:47], v[8:11], v[136:139]
    ds_read_b128 v[40:43], v2 offset:4096
    v_mfma_f32_16x16x32_bf16 v[140:143], v[44:47], v[12:15], v[140:143]
    s_waitcnt lgkmcnt(9)
    v_mfma_f32_16x16x32_bf16 v[144:147], v[48:51], v[8:11], v[144:147]
    ds_read_b128 v[44:47], v2 offset:5120
    v_mfma_f32_16x16x32_bf16 v[148:151], v[48:51], v[12:15], v[148:151]
    ds_read_b128 v[48:51], v2 offset:6144
    s_waitcnt lgkmcnt(7)
    s_waitcnt lgkmcnt(6)
    v_mfma_f32_16x16x32_bf16 v[96:99], v[24:27], v[16:19], v[96:99]
    v_mfma_f32_16x16x32_bf16 v[100:103], v[24:27], v[20:23], v[100:103]
    s_waitcnt lgkmcnt(5)
    v_mfma_f32_16x16x32_bf16 v[104:107], v[28:31], v[16:19], v[104:107]
    v_mfma_f32_16x16x32_bf16 v[108:111], v[28:31], v[20:23], v[108:111]
    s_waitcnt lgkmcnt(4)
    v_mfma_f32_16x16x32_bf16 v[112:115], v[32:35], v[16:19], v[112:115]
    v_mfma_f32_16x16x32_bf16 v[116:119], v[32:35], v[20:23], v[116:119]
    s_barrier
    s_add_u32 s66, s66, 1
    s_cmp_eq_u32 s66, 5
    s_cselect_b32 s67, -65536, s70
    s_cselect_b32 s68, -57344, s71
    s_cselect_b32 s66, 0, s66
    v_add_u32 v3, s67, v3
    v_add_u32 v4, s67, v4
    v_add_u32 v2, s68, v2
    s_cmp_lg_u32 s69, 5
    s_cbranch_scc1 p2c0_nh1
    s_waitcnt vmcnt(0)
    v_mov_b32 v52, s60
    v_mov_b32 v53, s61
    v_mov_b32 v54, 0
    s_mov_b64 exec, 1
    buffer_store_dwordx2 v[52:53], v54, s[44:47], s31 offen sc1
    s_mov_b64 exec, -1
p2c0_nh1:
    s_cmp_lg_u32 s69, 1
    s_cbranch_scc1 p2c0_nh3
    s_waitcnt vmcnt(0)
    v_cmp_eq_u32 vcc, s60, v152
    v_cmp_eq_u32 s[90:91], s61, v153
    s_and_b64 vcc, vcc, s[90:91]
    s_cmp_eq_u64 vcc, -1
    s_cbranch_scc1 p2c0z_fok
    s_mov_b32 s55, 40000
p2c0z_pl:
    buffer_load_dwordx2 v[152:153], v156, s[44:47], s76 offen sc1
    s_waitcnt vmcnt(0)
    v_cmp_eq_u32 vcc, s60, v152
    v_cmp_eq_u32 s[90:91], s61, v153
    s_and_b64 vcc, vcc, s[90:91]
    s_cmp_eq_u64 vcc, -1
    s_cbranch_scc1 p2c0z_pok
    s_sub_u32 s55, s55, 1
    s_cmp_lg_u32 s55, 0
    s_cbranch_scc1 p2c0z_pl
p2c0z_pok:
p2c0z_fok:
    buffer_load_dwordx4 v[52:55], v5, s[44:47], s79 offen offset:0 sc1
    buffer_load_dwordx4 v[56:59], v5, s[44:47], s79 offen offset:1024 sc1
    buffer_load_dwordx4 v[60:63], v5, s[44:47], s79 offen offset:2048 sc1
    buffer_load_dwordx2 v[64:65], v6, s[44:47], s79 offen offset:3072 sc1
p2c0_nh3:
    s_waitcnt lgkmcnt(3)
    v_mfma_f32_16x16x32_bf16 v[120:123], v[36:39], v[16:19], v[120:123]
    ds_read_b64 v[8:9], v3 offset:0
    ds_read_b64 v[10:11], v4 offset:0
    v_mfma_f32_16x16x32_bf16 v[124:127], v[36:39], v[20:23], v[124:127]
    ds_read_b64 v[12:13], v3 offset:2048
    ds_read_b64 v[14:15], v4 offset:2048
    s_waitcnt lgkmcnt(6)
    v_mfma_f32_16x16x32_bf16 v[128:131], v[40:43], v[16:19], v[128:131]
    ds_read_b128 v[24:27], v2 offset:0
    ds_read_b128 v[28:31], v2 offset:1024
    v_mfma_f32_16x16x32_bf16 v[132:135], v[40:43], v[20:23], v[132:135]
    ds_read_b128 v[32:35], v2 offset:2048
    ds_read_b128 v[36:39], v2 offset:3072
    s_waitcnt lgkmcnt(9)
    v_mfma_f32_16x16x32_bf16 v[136:139], v[44:47], v[16:19], v[136:139]
    ds_read_b128 v[40:43], v2 offset:4096
    v_mfma_f32_16x16x32_bf16 v[140:143], v[44:47], v[20:23], v[140:143]
    s_waitcnt lgkmcnt(9)
    v_mfma_f32_16x16x32_bf16 v[144:147], v[48:51], v[16:19], v[144:147]
    ds_read_b128 v[44:47], v2 offset:5120
    v_mfma_f32_16x16x32_bf16 v[148:151], v[48:51], v[20:23], v[148:151]
    ds_read_b128 v[48:51], v2 offset:6144
    s_sub_u32 s69, s69, 1
    s_cmp_lg_u32 s69, 0
    s_cbranch_scc1 p2c0_loop
    s_waitcnt lgkmcnt(7)
    s_waitcnt lgkmcnt(6)
    v_mfma_f32_16x16x32_bf16 v[96:99], v[24:27], v[8:11], v[96:99]
    v_mfma_f32_16x16x32_bf16 v[100:103], v[24:27], v[12:15], v[100:103]
    s_waitcnt lgkmcnt(5)
    v_mfma_f32_16x16x32_bf16 v[104:107], v[28:31], v[8:11], v[104:107]
    v_mfma_f32_16x16x32_bf16 v[108:111], v[28:31], v[12:15], v[108:111]
    s_waitcnt lgkmcnt(4)
    v_mfma_f32_16x16x32_bf16 v[112:115], v[32:35], v[8:11], v[112:115]
    v_mfma_f32_16x16x32_bf16 v[116:119], v[32:35], v[12:15], v[116:119]
    s_waitcnt lgkmcnt(0)
    s_barrier
    s_add_u32 s66, s66, 1
    s_cmp_eq_u32 s66, 5
    s_cselect_b32 s67, -65536, s70
    s_cselect_b32 s68, -57344, s71
    s_cselect_b32 s66, 0, s66
    v_add_u32 v3, s67, v3
    v_add_u32 v4, s67, v4
    v_add_u32 v2, s68, v2
    v_mfma_f32_16x16x32_bf16 v[120:123], v[36:39], v[8:11], v[120:123]
    ds_read_b64 v[16:17], v3 offset:0
    ds_read_b64 v[18:19], v4 offset:0
    v_mfma_f32_16x16x32_bf16 v[124:127], v[36:39], v[12:15], v[124:127]
    ds_read_b64 v[20:21], v3 offset:2048
    ds_read_b64 v[22:23], v4 offset:2048
    v_mfma_f32_16x16x32_bf16 v[128:131], v[40:43], v[8:11], v[128:131]
    ds_read_b128 v[24:27], v2 offset:0
    ds_read_b128 v[28:31], v2 offset:1024
    v_mfma_f32_16x16x32_bf16 v[132:135], v[40:43], v[12:15], v[132:135]
    ds_read_b128 v[32:35], v2 offset:2048
    ds_read_b128 v[36:39], v2 offset:3072
    v_mfma_f32_16x16x32_bf16 v[136:139], v[44:47], v[8:11], v[136:139]
    ds_read_b128 v[40:43], v2 offset:4096
    v_mfma_f32_16x16x32_bf16 v[140:143], v[44:47], v[12:15], v[140:143]
    v_mfma_f32_16x16x32_bf16 v[144:147], v[48:51], v[8:11], v[144:147]
    ds_read_b128 v[44:47], v2 offset:5120
    v_mfma_f32_16x16x32_bf16 v[148:151], v[48:51], v[12:15], v[148:151]
    ds_read_b128 v[48:51], v2 offset:6144
    s_waitcnt lgkmcnt(7)
    s_waitcnt lgkmcnt(6)
    v_mfma_f32_16x16x32_bf16 v[96:99], v[24:27], v[16:19], v[96:99]
    v_mfma_f32_16x16x32_bf16 v[100:103], v[24:27], v[20:23], v[100:103]
    s_waitcnt lgkmcnt(5)
    v_mfma_f32_16x16x32_bf16 v[104:107], v[28:31], v[16:19], v[104:107]
    v_mfma_f32_16x16x32_bf16 v[108:111], v[28:31], v[20:23], v[108:111]
    s_waitcnt lgkmcnt(4)
    v_mfma_f32_16x16x32_bf16 v[112:115], v[32:35], v[16:19], v[112:115]
    v_mfma_f32_16x16x32_bf16 v[116:119], v[32:35], v[20:23], v[116:119]
    s_waitcnt lgkmcnt(3)
    v_mfma_f32_16x16x32_bf16 v[120:123], v[36:39], v[16:19], v[120:123]
    v_mfma_f32_16x16x32_bf16 v[124:127], v[36:39], v[20:23], v[124:127]
    s_waitcnt lgkmcnt(2)
    v_mfma_f32_16x16x32_bf16 v[128:131], v[40:43], v[16:19], v[128:131]
    v_mfma_f32_16x16x32_bf16 v[132:135], v[40:43], v[20:23], v[132:135]
    s_waitcnt lgkmcnt(1)
    v_mfma_f32_16x16x32_bf16 v[136:139], v[44:47], v[16:19], v[136:139]
    v_mfma_f32_16x16x32_bf16 v[140:143], v[44:47], v[20:23], v[140:143]
    s_waitcnt lgkmcnt(0)
    v_mfma_f32_16x16x32_bf16 v[144:147], v[48:51], v[16:19], v[144:147]
    v_mfma_f32_16x16x32_bf16 v[148:151], v[48:51], v[20:23], v[148:151]
    s_waitcnt lgkmcnt(0)
    s_mul_i32 s66, s63, 7168
    s_add_u32 s67, s66, 16384
    s_add_u32 s68, s66, 45056
    v_add_u32 v2, s67, v5
    v_add_u32 v3, s68, v5
    ds_write_b128 v2, v[100:103] offset:0
    ds_write_b128 v2, v[108:111] offset:1024
    ds_write_b128 v2, v[116:119] offset:2048
    ds_write_b128 v2, v[124:127] offset:3072
    ds_write_b128 v2, v[132:135] offset:4096
    ds_write_b128 v2, v[140:143] offset:5120
    ds_write_b128 v2, v[148:151] offset:6144
    s_waitcnt lgkmcnt(0)
    s_barrier
    ds_read_b128 v[100:103], v3 offset:0
    ds_read_b128 v[108:111], v3 offset:1024
    ds_read_b128 v[116:119], v3 offset:2048
    ds_read_b128 v[124:127], v3 offset:3072
    ds_read_b128 v[132:135], v3 offset:4096
    ds_read_b128 v[140:143], v3 offset:5120
    ds_read_b128 v[148:151], v3 offset:6144
    s_waitcnt lgkmcnt(0)
    s_barrier
    s_waitcnt vmcnt(0)
    v_pk_add_f32 v[96:97], v[96:97], v[100:101]
    v_pk_add_f32 v[98:99], v[98:99], v[102:103]
    v_lshlrev_b32 v8, 16, v52
    v_and_b32 v9, 0xffff0000, v52
    v_lshlrev_b32 v10, 16, v53
    v_and_b32 v11, 0xffff0000, v53
    v_pk_mul_f32 v[96:97], v[96:97], v[8:9]
    v_pk_mul_f32 v[98:99], v[98:99], v[10:11]
    v_cvt_pk_bf16_f32 v40, v96, v97
    v_cvt_pk_bf16_f32 v41, v98, v99
    v_pk_add_f32 v[104:105], v[104:105], v[108:109]
    v_pk_add_f32 v[106:107], v[106:107], v[110:111]
    v_lshlrev_b32 v12, 16, v54
    v_and_b32 v13, 0xffff0000, v54
    v_lshlrev_b32 v14, 16, v55
    v_and_b32 v15, 0xffff0000, v55
    v_pk_mul_f32 v[104:105], v[104:105], v[12:13]
    v_pk_mul_f32 v[106:107], v[106:107], v[14:15]
    v_cvt_pk_bf16_f32 v42, v104, v105
    v_cvt_pk_bf16_f32 v43, v106, v107
    buffer_store_dwordx4 v[40:43], v5, s[44:47], s81 offen offset:0 sc1
    v_pk_add_f32 v[112:113], v[112:113], v[116:117]
    v_pk_add_f32 v[114:115], v[114:115], v[118:119]
    v_lshlrev_b32 v16, 16, v56
    v_and_b32 v17, 0xffff0000, v56
    v_lshlrev_b32 v18, 16, v57
    v_and_b32 v19, 0xffff0000, v57
    v_pk_mul_f32 v[112:113], v[112:113], v[16:17]
    v_pk_mul_f32 v[114:115], v[114:115], v[18:19]
    v_cvt_pk_bf16_f32 v44, v112, v113
    v_cvt_pk_bf16_f32 v45, v114, v115
    v_pk_add_f32 v[120:121], v[120:121], v[124:125]
    v_pk_add_f32 v[122:123], v[122:123], v[126:127]
    v_lshlrev_b32 v20, 16, v58
    v_and_b32 v21, 0xffff0000, v58
    v_lshlrev_b32 v22, 16, v59
    v_and_b32 v23, 0xffff0000, v59
    v_pk_mul_f32 v[120:121], v[120:121], v[20:21]
    v_pk_mul_f32 v[122:123], v[122:123], v[22:23]
    v_cvt_pk_bf16_f32 v46, v120, v121
    v_cvt_pk_bf16_f32 v47, v122, v123
    buffer_store_dwordx4 v[44:47], v5, s[44:47], s81 offen offset:1024 sc1
    v_pk_add_f32 v[128:129], v[128:129], v[132:133]
    v_pk_add_f32 v[130:131], v[130:131], v[134:135]
    v_lshlrev_b32 v24, 16, v60
    v_and_b32 v25, 0xffff0000, v60
    v_lshlrev_b32 v26, 16, v61
    v_and_b32 v27, 0xffff0000, v61
    v_pk_mul_f32 v[128:129], v[128:129], v[24:25]
    v_pk_mul_f32 v[130:131], v[130:131], v[26:27]
    v_cvt_pk_bf16_f32 v48, v128, v129
    v_cvt_pk_bf16_f32 v49, v130, v131
    v_pk_add_f32 v[136:137], v[136:137], v[140:141]
    v_pk_add_f32 v[138:139], v[138:139], v[142:143]
    v_lshlrev_b32 v28, 16, v62
    v_and_b32 v29, 0xffff0000, v62
    v_lshlrev_b32 v30, 16, v63
    v_and_b32 v31, 0xffff0000, v63
    v_pk_mul_f32 v[136:137], v[136:137], v[28:29]
    v_pk_mul_f32 v[138:139], v[138:139], v[30:31]
    v_cvt_pk_bf16_f32 v50, v136, v137
    v_cvt_pk_bf16_f32 v51, v138, v139
    buffer_store_dwordx4 v[48:51], v5, s[44:47], s81 offen offset:2048 sc1
    v_pk_add_f32 v[144:145], v[144:145], v[148:149]
    v_pk_add_f32 v[146:147], v[146:147], v[150:151]
    v_lshlrev_b32 v32, 16, v64
    v_and_b32 v33, 0xffff0000, v64
    v_lshlrev_b32 v34, 16, v65
    v_and_b32 v35, 0xffff0000, v65
    v_pk_mul_f32 v[144:145], v[144:145], v[32:33]
    v_pk_mul_f32 v[146:147], v[146:147], v[34:35]
    v_cvt_pk_bf16_f32 v66, v144, v145
    v_cvt_pk_bf16_f32 v67, v146, v147
    buffer_store_dwordx2 v[66:67], v6, s[44:47], s81 offen offset:3072 sc1
    s_branch f_p3
f_cB1:
    s_waitcnt lgkmcnt(0)
    s_mov_b32 s32, s8
    s_mov_b32 s33, s9
    s_mov_b32 s34, 0x1c0000
    s_mov_b32 s35, 0x20000
    s_mov_b32 s36, s16
    s_mov_b32 s37, s17
    s_mov_b32 s38, 0x188000
    s_mov_b32 s39, 0x20000
    s_mov_b32 s44, s28
    s_mov_b32 s45, s29
    s_mov_b32 s46, 0x1600000
    s_mov_b32 s47, 0x20000
    s_mov_b32 s48, s26
    s_mov_b32 s49, s27
    s_mov_b32 s50, 0x100
    s_mov_b32 s51, 0x20000
    s_and_b32 s57, s3, 3
    s_lshr_b32 s56, s3, 2
    s_lshl_b32 s64, s54, 1
    s_add_u32 s56, s56, s64
    v_mov_b32 v7, 0
    s_or_b32 s72, s2, s3
    s_cmp_lg_u32 s72, 0
    s_cbranch_scc1 p1Bc1_non
    s_memrealtime s[74:75]
    s_waitcnt lgkmcnt(0)
    s_or_b32 s74, s74, 1
    v_mov_b32 v8, s74
    v_mov_b32 v9, s75
    s_mov_b64 exec, 1
    buffer_store_dwordx2 v[8:9], v7, s[48:51], 0 offen sc1
    s_mov_b64 exec, -1
p1Bc1_non:
    s_lshl_b32 s64, s52, 4
    s_add_u32 s64, s64, s53
    s_lshl_b32 s64, s64, 2
    s_add_u32 s64, s64, s57
    s_mul_i32 s64, s64, 1792
    v_lshlrev_b32 v84, 4, v0
    v_mov_b32 v85, 0x7ff00000
    v_cmp_gt_u32 vcc, 56, v0
    s_nop 1
    v_cndmask_b32 v84, v85, v84, vcc
    buffer_load_dwordx4 v[60:63], v84, s[32:35], s64 offen
    buffer_load_dwordx4 v[64:67], v84, s[32:35], s64 offen offset:896
    s_waitcnt vmcnt(0)
    v_mov_b32 v84, 0x3f803f80
    v_mov_b32 v90, 0
    v_mov_b32 v91, 0
    v_mov_b32 v92, 0
    v_mov_b32 v93, 0
    v_dot2_f32_bf16 v90, v60, v84, v90
    v_dot2_f32_bf16 v91, v60, v60, v91
    v_dot2_f32_bf16 v92, v64, v84, v92
    v_dot2_f32_bf16 v93, v64, v64, v93
    v_dot2_f32_bf16 v90, v61, v84, v90
    v_dot2_f32_bf16 v91, v61, v61, v91
    v_dot2_f32_bf16 v92, v65, v84, v92
    v_dot2_f32_bf16 v93, v65, v65, v93
    v_dot2_f32_bf16 v90, v62, v84, v90
    v_dot2_f32_bf16 v91, v62, v62, v91
    v_dot2_f32_bf16 v92, v66, v84, v92
    v_dot2_f32_bf16 v93, v66, v66, v93
    v_dot2_f32_bf16 v90, v63, v84, v90
    v_dot2_f32_bf16 v91, v63, v63, v91
    v_dot2_f32_bf16 v92, v67, v84, v92
    v_dot2_f32_bf16 v93, v67, v67, v93
    v_add_f32_dpp v90, v90, v90 row_ror:8 row_mask:0xf bank_mask:0xf
    v_add_f32_dpp v91, v91, v91 row_ror:8 row_mask:0xf bank_mask:0xf
    v_add_f32_dpp v92, v92, v92 row_ror:8 row_mask:0xf bank_mask:0xf
    v_add_f32_dpp v93, v93, v93 row_ror:8 row_mask:0xf bank_mask:0xf
    v_add_f32_dpp v90, v90, v90 row_ror:4 row_mask:0xf bank_mask:0xf
    v_add_f32_dpp v91, v91, v91 row_ror:4 row_mask:0xf bank_mask:0xf
    v_add_f32_dpp v92, v92, v92 row_ror:4 row_mask:0xf bank_mask:0xf
    v_add_f32_dpp v93, v93, v93 row_ror:4 row_mask:0xf bank_mask:0xf
    v_add_f32_dpp v90, v90, v90 row_ror:2 row_mask:0xf bank_mask:0xf
    v_add_f32_dpp v91, v91, v91 row_ror:2 row_mask:0xf bank_mask:0xf
    v_add_f32_dpp v92, v92, v92 row_ror:2 row_mask:0xf bank_mask:0xf
    v_add_f32_dpp v93, v93, v93 row_ror:2 row_mask:0xf bank_mask:0xf
    v_add_f32_dpp v90, v90, v90 row_ror:1 row_mask:0xf bank_mask:0xf
    v_add_f32_dpp v91, v91, v91 row_ror:1 row_mask:0xf bank_mask:0xf
    v_add_f32_dpp v92, v92, v92 row_ror:1 row_mask:0xf bank_mask:0xf
    v_add_f32_dpp v93, v93, v93 row_ror:1 row_mask:0xf bank_mask:0xf
    v_mov_b32 v68, v90
    v_mov_b32 v69, v91
    v_mov_b32 v70, v92
    v_mov_b32 v71, v93
    v_permlane16_swap_b32 v90, v68
    v_permlane16_swap_b32 v91, v69
    v_permlane16_swap_b32 v92, v70
    v_permlane16_swap_b32 v93, v71
    v_add_f32 v90, v90, v68
    v_add_f32 v91, v91, v69
    v_add_f32 v92, v92, v70
    v_add_f32 v93, v93, v71
    v_mov_b32 v68, v90
    v_mov_b32 v69, v91
    v_mov_b32 v70, v92
    v_mov_b32 v71, v93
    v_permlane32_swap_b32 v90, v68
    v_permlane32_swap_b32 v91, v69
    v_permlane32_swap_b32 v92, v70
    v_permlane32_swap_b32 v93, v71
    v_add_f32 v90, v90, v68
    v_add_f32 v91, v91, v69
    v_add_f32 v92, v92, v70
    v_add_f32 v93, v93, v71
    v_cmp_eq_u32 vcc, 1, v0
    s_nop 1
    v_cndmask_b32 v90, v90, v92, vcc
    v_cndmask_b32 v91, v91, v93, vcc
    v_mul_f32 v90, 0x3b124925, v90
    v_mul_f32 v91, 0x3b124925, v91
    v_fma_f32 v91, -v90, v90, v91
    v_max_f32 v91, 0, v91
    v_add_f32 v91, 0x3727c5ac, v91
    v_rsq_f32 v86, v91
    s_nop 0
    v_mul_f32 v87, v90, v86
    v_sub_f32 v87, 0, v87
    v_and_b32 v8, 15, v0
    v_lshrrev_b32 v9, 4, v0
    v_lshrrev_b32 v10, 1, v8
    v_xor_b32 v10, v10, v9
    v_lshlrev_b32 v10, 4, v10
    v_lshl_add_u32 v10, v8, 7, v10
    s_lshl_b32 s72, s57, 12
    v_add_u32 v2, s72, v10
    v_xor_b32 v3, 64, v2
    v_lshrrev_b32 v10, 2, v8
    v_lshl_add_u32 v10, v9, 2, v10
    v_and_b32 v11, 3, v8
    v_lshlrev_b32 v11, 3, v11
    v_mul_u32_u24 v12, 448, v10
    v_add_u32 v12, v12, v11
    v_add_u32 v12, 55296, v12
    v_and_b32 v11, 1, v9
    v_lshl_add_u32 v4, v11, 5, v12
    v_xor_b32 v11, 1, v11
    v_lshl_add_u32 v5, v11, 5, v12
    s_mov_b32 s36, s20
    s_mov_b32 s37, s21
    s_mov_b32 s38, 0x1000
    s_mov_b32 s39, 0x20000
    v_and_b32 v162, 15, v0
    v_lshlrev_b32 v162, 1, v162
    s_lshl_b32 s64, s4, 8
    s_lshl_b32 s65, s57, 6
    s_add_u32 s64, s64, s65
    buffer_load_ushort v163, v162, s[36:39], s64 offen offset:32
    buffer_load_ushort v162, v162, s[36:39], s64 offen
    v_mov_b32 v96, 0
    v_mov_b32 v97, 0
    v_mov_b32 v98, 0
    v_mov_b32 v99, 0
    v_mov_b32 v100, 0
    v_mov_b32 v101, 0
    v_mov_b32 v102, 0
    v_mov_b32 v103, 0
    v_mov_b32 v104, 0
    v_mov_b32 v105, 0
    v_mov_b32 v106, 0
    v_mov_b32 v107, 0
    v_mov_b32 v108, 0
    v_mov_b32 v109, 0
    v_mov_b32 v110, 0
    v_mov_b32 v111, 0
    v_mov_b32 v112, 0
    v_mov_b32 v113, 0
    v_mov_b32 v114, 0
    v_mov_b32 v115, 0
    v_mov_b32 v116, 0
    v_mov_b32 v117, 0
    v_mov_b32 v118, 0
    v_mov_b32 v119, 0
    v_mov_b32 v120, 0
    v_mov_b32 v121, 0
    v_mov_b32 v122, 0
    v_mov_b32 v123, 0
    v_mov_b32 v124, 0
    v_mov_b32 v125, 0
    v_mov_b32 v126, 0
    v_mov_b32 v127, 0
    v_mov_b32 v128, 0
    v_mov_b32 v129, 0
    v_mov_b32 v130, 0
    v_mov_b32 v131, 0
    v_mov_b32 v132, 0
    v_mov_b32 v133, 0
    v_mov_b32 v134, 0
    v_mov_b32 v135, 0
    v_mov_b32 v136, 0
    v_mov_b32 v137, 0
    v_mov_b32 v138, 0
    v_mov_b32 v139, 0
    v_mov_b32 v140, 0
    v_mov_b32 v141, 0
    v_mov_b32 v142, 0
    v_mov_b32 v143, 0
    v_mov_b32 v144, 0
    v_mov_b32 v145, 0
    v_mov_b32 v146, 0
    v_mov_b32 v147, 0
    v_mov_b32 v148, 0
    v_mov_b32 v149, 0
    v_mov_b32 v150, 0
    v_mov_b32 v151, 0
    s_mov_b32 s70, 16384
    s_mov_b32 s71, -32768
    s_mov_b32 s72, 28672
    s_mov_b32 s73, -57344
    s_mov_b32 s59, 0
    s_mov_b32 s58, 7
    s_waitcnt lgkmcnt(0)
    s_barrier
    ds_read_b128 v[8:11], v2 offset:0
    ds_read_b128 v[12:15], v2 offset:2048
    ds_read_b64_tr_b16 v[32:33], v5 offset:192
    ds_read_b64_tr_b16 v[34:35], v5 offset:7360
    ds_read_b64_tr_b16 v[36:37], v4 offset:256
    ds_read_b64_tr_b16 v[38:39], v4 offset:7424
    ds_read_b64_tr_b16 v[40:41], v5 offset:256
    ds_read_b64_tr_b16 v[42:43], v5 offset:7424
    ds_read_b64_tr_b16 v[44:45], v4 offset:320
    ds_read_b64_tr_b16 v[46:47], v4 offset:7488
    ds_read_b64_tr_b16 v[48:49], v5 offset:320
    ds_read_b64_tr_b16 v[50:51], v5 offset:7488
    ds_read_b64_tr_b16 v[52:53], v4 offset:384
    ds_read_b64_tr_b16 v[54:55], v4 offset:7552
    ds_read_b64_tr_b16 v[56:57], v5 offset:384
    ds_read_b64_tr_b16 v[58:59], v5 offset:7552
p1Bc1_loop:
    ds_read_b128 v[20:23], v3 offset:0
    ds_read_b128 v[24:27], v3 offset:2048
    s_waitcnt lgkmcnt(15)
    s_waitcnt lgkmcnt(14)
    v_mfma_f32_16x16x32_bf16 v[96:99], v[32:35], v[8:11], v[96:99]
    v_mfma_f32_16x16x32_bf16 v[100:103], v[32:35], v[12:15], v[100:103]
    ds_read_b64_tr_b16 v[32:33], v5 offset:14528
    ds_read_b64_tr_b16 v[34:35], v5 offset:21696
    s_waitcnt lgkmcnt(14)
    v_mfma_f32_16x16x32_bf16 v[104:107], v[36:39], v[8:11], v[104:107]
    v_mfma_f32_16x16x32_bf16 v[108:111], v[36:39], v[12:15], v[108:111]
    ds_read_b64_tr_b16 v[36:37], v4 offset:14592
    ds_read_b64_tr_b16 v[38:39], v4 offset:21760
    s_waitcnt lgkmcnt(14)
    v_mfma_f32_16x16x32_bf16 v[112:115], v[40:43], v[8:11], v[112:115]
    v_mfma_f32_16x16x32_bf16 v[116:119], v[40:43], v[12:15], v[116:119]
    ds_read_b64_tr_b16 v[40:41], v5 offset:14592
    ds_read_b64_tr_b16 v[42:43], v5 offset:21760
    s_waitcnt lgkmcnt(14)
    v_mfma_f32_16x16x32_bf16 v[120:123], v[44:47], v[8:11], v[120:123]
    v_mfma_f32_16x16x32_bf16 v[124:127], v[44:47], v[12:15], v[124:127]
    ds_read_b64_tr_b16 v[44:45], v4 offset:14656
    ds_read_b64_tr_b16 v[46:47], v4 offset:21824
    s_waitcnt lgkmcnt(14)
    v_mfma_f32_16x16x32_bf16 v[128:131], v[48:51], v[8:11], v[128:131]
    v_mfma_f32_16x16x32_bf16 v[132:135], v[48:51], v[12:15], v[132:135]
    ds_read_b64_tr_b16 v[48:49], v5 offset:14656
    ds_read_b64_tr_b16 v[50:51], v5 offset:21824
    s_waitcnt lgkmcnt(14)
    v_mfma_f32_16x16x32_bf16 v[136:139], v[52:55], v[8:11], v[136:139]
    v_mfma_f32_16x16x32_bf16 v[140:143], v[52:55], v[12:15], v[140:143]
    ds_read_b64_tr_b16 v[52:53], v4 offset:14720
    ds_read_b64_tr_b16 v[54:55], v4 offset:21888
    s_waitcnt lgkmcnt(14)
    v_mfma_f32_16x16x32_bf16 v[144:147], v[56:59], v[8:11], v[144:147]
    v_mfma_f32_16x16x32_bf16 v[148:151], v[56:59], v[12:15], v[148:151]
    ds_read_b64_tr_b16 v[56:57], v5 offset:14720
    ds_read_b64_tr_b16 v[58:59], v5 offset:21888
    s_waitcnt lgkmcnt(14)
    s_waitcnt lgkmcnt(12)
    v_mfma_f32_16x16x32_bf16 v[96:99], v[32:35], v[20:23], v[96:99]
    v_mfma_f32_16x16x32_bf16 v[100:103], v[32:35], v[24:27], v[100:103]
    s_add_u32 s59, s59, 1
    s_cmp_eq_u32 s59, 3
    s_cselect_b32 s68, s71, s70
    s_cselect_b32 s69, s73, s72
    s_cselect_b32 s59, 0, s59
    s_waitcnt lgkmcnt(10)
    v_mfma_f32_16x16x32_bf16 v[104:107], v[36:39], v[20:23], v[104:107]
    v_mfma_f32_16x16x32_bf16 v[108:111], v[36:39], v[24:27], v[108:111]
    v_add_u32 v2, s68, v2
    v_add_u32 v3, s68, v3
    v_add_u32 v4, s69, v4
    v_add_u32 v5, s69, v5
    s_waitcnt lgkmcnt(8)
    v_mfma_f32_16x16x32_bf16 v[112:115], v[40:43], v[20:23], v[112:115]
    v_mfma_f32_16x16x32_bf16 v[116:119], v[40:43], v[24:27], v[116:119]
    s_waitcnt lgkmcnt(0)
    s_barrier
    s_cmp_lg_u32 s58, 7
    s_cbranch_scc1 p1Bc1_nohook
    v_mov_b32 v6, 155648
    ds_read_b64 v[6:7], v6
    s_waitcnt lgkmcnt(0)
    v_readfirstlane_b32 s60, v6
    v_readfirstlane_b32 s61, v7
    s_lshl_b32 s64, s52, 4
    s_add_u32 s64, s64, s53
    s_lshl_b32 s64, s64, 2
    s_add_u32 s64, s64, s57
    s_lshl_b32 s64, s64, 5
    s_add_u32 s64, s64, 0
    v_mov_b32 v90, v86
    v_mov_b32 v91, v87
    v_mov_b32 v92, s60
    v_mov_b32 v93, s61
    v_lshlrev_b32 v94, 4, v0
    s_mov_b64 exec, 3
    buffer_store_dwordx4 v[90:93], v94, s[44:47], s64 offen sc1
    s_mov_b64 exec, -1
p1Bc1_nohook:
    v_mfma_f32_16x16x32_bf16 v[120:123], v[44:47], v[20:23], v[120:123]
    ds_read_b128 v[8:11], v2 offset:0
    ds_read_b128 v[12:15], v2 offset:2048
    v_mfma_f32_16x16x32_bf16 v[124:127], v[44:47], v[24:27], v[124:127]
    ds_read_b64_tr_b16 v[32:33], v5 offset:192
    ds_read_b64_tr_b16 v[34:35], v5 offset:7360
    v_mfma_f32_16x16x32_bf16 v[128:131], v[48:51], v[20:23], v[128:131]
    ds_read_b64_tr_b16 v[36:37], v4 offset:256
    ds_read_b64_tr_b16 v[38:39], v4 offset:7424
    v_mfma_f32_16x16x32_bf16 v[132:135], v[48:51], v[24:27], v[132:135]
    ds_read_b64_tr_b16 v[40:41], v5 offset:256
    ds_read_b64_tr_b16 v[42:43], v5 offset:7424
    v_mfma_f32_16x16x32_bf16 v[136:139], v[52:55], v[20:23], v[136:139]
    ds_read_b64_tr_b16 v[44:45], v4 offset:320
    ds_read_b64_tr_b16 v[46:47], v4 offset:7488
    v_mfma_f32_16x16x32_bf16 v[140:143], v[52:55], v[24:27], v[140:143]
    ds_read_b64_tr_b16 v[48:49], v5 offset:320
    ds_read_b64_tr_b16 v[50:51], v5 offset:7488
    v_mfma_f32_16x16x32_bf16 v[144:147], v[56:59], v[20:23], v[144:147]
    ds_read_b64_tr_b16 v[52:53], v4 offset:384
    ds_read_b64_tr_b16 v[54:55], v4 offset:7552
    v_mfma_f32_16x16x32_bf16 v[148:151], v[56:59], v[24:27], v[148:151]
    ds_read_b64_tr_b16 v[56:57], v5 offset:384
    ds_read_b64_tr_b16 v[58:59], v5 offset:7552
    s_sub_u32 s58, s58, 1
    s_cmp_lg_u32 s58, 0
    s_cbranch_scc1 p1Bc1_loop
    s_waitcnt lgkmcnt(0)
    s_waitcnt vmcnt(0)
    s_mov_b32 s62, 0xbdd2d3e8
    s_mov_b32 s63, 0xbdd2d3e8
    s_mov_b32 s78, 1.0
    s_mov_b32 s79, 1.0
    v_mov_b32 v44, 0xc0135761
    v_mov_b32 v45, 0xc0135761
    v_and_b32 v4, 15, v0
    v_lshrrev_b32 v5, 4, v0
    s_lshl_b32 s72, s57, 7
    s_add_u32 s72, s72, 153664
    v_lshlrev_b32 v4, 2, v4
    v_lshlrev_b32 v5, 4, v5
    v_add_u32 v6, s72, v4
    v_add_u32 v5, 155200, v5
    v_lshlrev_b32 v46, 3, v0
    ds_read_b32 v8, v6 offset:0
    ds_read_b32 v10, v6 offset:576
    ds_read_b32 v9, v6 offset:64
    ds_read_b32 v11, v6 offset:640
    ds_read_b128 v[12:15], v5 offset:0
    ds_read_b128 v[16:19], v5 offset:64
    ds_read_b128 v[20:23], v5 offset:128
    ds_read_b128 v[24:27], v5 offset:192
    ds_read_b128 v[28:31], v5 offset:256
    ds_read_b128 v[32:35], v5 offset:320
    ds_read_b128 v[36:39], v5 offset:384
    s_lshl_b32 s74, s52, 3
    s_lshl_b32 s75, s57, 1
    s_add_u32 s74, s74, s75
    s_lshl_b32 s74, s74, 3
    s_add_u32 s74, s74, s54
    s_mul_i32 s74, s74, 3584
    s_add_u32 s74, s74, 5242880
    s_add_u32 s75, s74, 28672
    v_lshlrev_b32 v47, 4, v0
    s_waitcnt lgkmcnt(0)
    v_pk_mul_f32 v[48:49], v[12:13], v[10:11] op_sel_hi:[1,0]
    v_pk_fma_f32 v[96:97], v[96:97], v[8:9], v[48:49] op_sel_hi:[1,0,1]
    v_pk_mul_f32 v[50:51], v[14:15], v[10:11] op_sel_hi:[1,0]
    v_pk_fma_f32 v[98:99], v[98:99], v[8:9], v[50:51] op_sel_hi:[1,0,1]
    v_pk_mul_f32 v[52:53], v[16:17], v[10:11] op_sel_hi:[1,0]
    v_pk_fma_f32 v[104:105], v[104:105], v[8:9], v[52:53] op_sel_hi:[1,0,1]
    v_pk_mul_f32 v[54:55], v[18:19], v[10:11] op_sel_hi:[1,0]
    v_pk_fma_f32 v[106:107], v[106:107], v[8:9], v[54:55] op_sel_hi:[1,0,1]
    v_pk_mul_f32 v[56:57], v[20:21], v[10:11] op_sel_hi:[1,0]
    v_pk_fma_f32 v[112:113], v[112:113], v[8:9], v[56:57] op_sel_hi:[1,0,1]
    v_pk_mul_f32 v[58:59], v[22:23], v[10:11] op_sel_hi:[1,0]
    v_pk_fma_f32 v[114:115], v[114:115], v[8:9], v[58:59] op_sel_hi:[1,0,1]
    v_pk_mul_f32 v[60:61], v[24:25], v[10:11] op_sel_hi:[1,0]
    v_pk_fma_f32 v[120:121], v[120:121], v[8:9], v[60:61] op_sel_hi:[1,0,1]
    v_pk_mul_f32 v[62:63], v[26:27], v[10:11] op_sel_hi:[1,0]
    v_pk_fma_f32 v[122:123], v[122:123], v[8:9], v[62:63] op_sel_hi:[1,0,1]
    v_pk_mul_f32 v[48:49], v[28:29], v[10:11] op_sel_hi:[1,0]
    v_pk_fma_f32 v[128:129], v[128:129], v[8:9], v[48:49] op_sel_hi:[1,0,1]
    v_pk_mul_f32 v[50:51], v[30:31], v[10:11] op_sel_hi:[1,0]
    v_pk_fma_f32 v[130:131], v[130:131], v[8:9], v[50:51] op_sel_hi:[1,0,1]
    v_pk_mul_f32 v[52:53], v[32:33], v[10:11] op_sel_hi:[1,0]
    v_pk_fma_f32 v[136:137], v[136:137], v[8:9], v[52:53] op_sel_hi:[1,0,1]
    v_pk_mul_f32 v[54:55], v[34:35], v[10:11] op_sel_hi:[1,0]
    v_pk_fma_f32 v[138:139], v[138:139], v[8:9], v[54:55] op_sel_hi:[1,0,1]
    v_pk_mul_f32 v[56:57], v[36:37], v[10:11] op_sel_hi:[1,0]
    v_pk_fma_f32 v[144:145], v[144:145], v[8:9], v[56:57] op_sel_hi:[1,0,1]
    v_pk_mul_f32 v[58:59], v[38:39], v[10:11] op_sel_hi:[1,0]
    v_pk_fma_f32 v[146:147], v[146:147], v[8:9], v[58:59] op_sel_hi:[1,0,1]
    v_pk_mul_f32 v[48:49], v[96:97], v[96:97]
    v_pk_mul_f32 v[50:51], v[98:99], v[98:99]
    v_pk_mul_f32 v[52:53], v[104:105], v[104:105]
    v_pk_mul_f32 v[54:55], v[106:107], v[106:107]
    v_pk_mul_f32 v[56:57], v[112:113], v[112:113]
    v_pk_mul_f32 v[58:59], v[114:115], v[114:115]
    v_pk_mul_f32 v[60:61], v[120:121], v[120:121]
    v_pk_fma_f32 v[48:49], v[48:49], s[62:63], v[44:45]
    v_pk_fma_f32 v[50:51], v[50:51], s[62:63], v[44:45]
    v_pk_fma_f32 v[52:53], v[52:53], s[62:63], v[44:45]
    v_pk_fma_f32 v[54:55], v[54:55], s[62:63], v[44:45]
    v_pk_fma_f32 v[56:57], v[56:57], s[62:63], v[44:45]
    v_pk_fma_f32 v[58:59], v[58:59], s[62:63], v[44:45]
    v_pk_fma_f32 v[60:61], v[60:61], s[62:63], v[44:45]
    v_pk_mul_f32 v[48:49], v[48:49], v[96:97]
    v_pk_mul_f32 v[50:51], v[50:51], v[98:99]
    v_pk_mul_f32 v[52:53], v[52:53], v[104:105]
    v_pk_mul_f32 v[54:55], v[54:55], v[106:107]
    v_pk_mul_f32 v[56:57], v[56:57], v[112:113]
    v_pk_mul_f32 v[58:59], v[58:59], v[114:115]
    v_pk_mul_f32 v[60:61], v[60:61], v[120:121]
    v_exp_f32 v48, v48
    v_exp_f32 v49, v49
    v_exp_f32 v50, v50
    v_exp_f32 v51, v51
    v_exp_f32 v52, v52
    v_exp_f32 v53, v53
    v_exp_f32 v54, v54
    v_exp_f32 v55, v55
    v_exp_f32 v56, v56
    v_exp_f32 v57, v57
    v_exp_f32 v58, v58
    v_exp_f32 v59, v59
    v_exp_f32 v60, v60
    v_exp_f32 v61, v61
    v_pk_add_f32 v[48:49], v[48:49], s[78:79]
    v_pk_add_f32 v[50:51], v[50:51], s[78:79]
    v_pk_add_f32 v[52:53], v[52:53], s[78:79]
    v_pk_add_f32 v[54:55], v[54:55], s[78:79]
    v_pk_add_f32 v[56:57], v[56:57], s[78:79]
    v_pk_add_f32 v[58:59], v[58:59], s[78:79]
    v_pk_add_f32 v[60:61], v[60:61], s[78:79]
    v_rcp_f32 v48, v48
    v_rcp_f32 v49, v49
    v_rcp_f32 v50, v50
    v_rcp_f32 v51, v51
    v_rcp_f32 v52, v52
    v_rcp_f32 v53, v53
    v_rcp_f32 v54, v54
    v_rcp_f32 v55, v55
    v_rcp_f32 v56, v56
    v_rcp_f32 v57, v57
    v_rcp_f32 v58, v58
    v_rcp_f32 v59, v59
    v_rcp_f32 v60, v60
    v_rcp_f32 v61, v61
    v_pk_mul_f32 v[96:97], v[96:97], v[48:49]
    v_pk_mul_f32 v[98:99], v[98:99], v[50:51]
    v_pk_mul_f32 v[104:105], v[104:105], v[52:53]
    v_pk_mul_f32 v[106:107], v[106:107], v[54:55]
    v_pk_mul_f32 v[112:113], v[112:113], v[56:57]
    v_pk_mul_f32 v[114:115], v[114:115], v[58:59]
    v_pk_mul_f32 v[120:121], v[120:121], v[60:61]
    v_pk_mul_f32 v[48:49], v[122:123], v[122:123]
    v_pk_mul_f32 v[50:51], v[128:129], v[128:129]
    v_pk_mul_f32 v[52:53], v[130:131], v[130:131]
    v_pk_mul_f32 v[54:55], v[136:137], v[136:137]
    v_pk_mul_f32 v[56:57], v[138:139], v[138:139]
    v_pk_mul_f32 v[58:59], v[144:145], v[144:145]
    v_pk_mul_f32 v[60:61], v[146:147], v[146:147]
    v_pk_fma_f32 v[48:49], v[48:49], s[62:63], v[44:45]
    v_pk_fma_f32 v[50:51], v[50:51], s[62:63], v[44:45]
    v_pk_fma_f32 v[52:53], v[52:53], s[62:63], v[44:45]
    v_pk_fma_f32 v[54:55], v[54:55], s[62:63], v[44:45]
    v_pk_fma_f32 v[56:57], v[56:57], s[62:63], v[44:45]
    v_pk_fma_f32 v[58:59], v[58:59], s[62:63], v[44:45]
    v_pk_fma_f32 v[60:61], v[60:61], s[62:63], v[44:45]
    v_pk_mul_f32 v[48:49], v[48:49], v[122:123]
    v_pk_mul_f32 v[50:51], v[50:51], v[128:129]
    v_pk_mul_f32 v[52:53], v[52:53], v[130:131]
    v_pk_mul_f32 v[54:55], v[54:55], v[136:137]
    v_pk_mul_f32 v[56:57], v[56:57], v[138:139]
    v_pk_mul_f32 v[58:59], v[58:59], v[144:145]
    v_pk_mul_f32 v[60:61], v[60:61], v[146:147]
    v_exp_f32 v48, v48
    v_exp_f32 v49, v49
    v_exp_f32 v50, v50
    v_exp_f32 v51, v51
    v_exp_f32 v52, v52
    v_exp_f32 v53, v53
    v_exp_f32 v54, v54
    v_exp_f32 v55, v55
    v_exp_f32 v56, v56
    v_exp_f32 v57, v57
    v_exp_f32 v58, v58
    v_exp_f32 v59, v59
    v_exp_f32 v60, v60
    v_exp_f32 v61, v61
    v_pk_add_f32 v[48:49], v[48:49], s[78:79]
    v_pk_add_f32 v[50:51], v[50:51], s[78:79]
    v_pk_add_f32 v[52:53], v[52:53], s[78:79]
    v_pk_add_f32 v[54:55], v[54:55], s[78:79]
    v_pk_add_f32 v[56:57], v[56:57], s[78:79]
    v_pk_add_f32 v[58:59], v[58:59], s[78:79]
    v_pk_add_f32 v[60:61], v[60:61], s[78:79]
    v_rcp_f32 v48, v48
    v_rcp_f32 v49, v49
    v_rcp_f32 v50, v50
    v_rcp_f32 v51, v51
    v_rcp_f32 v52, v52
    v_rcp_f32 v53, v53
    v_rcp_f32 v54, v54
    v_rcp_f32 v55, v55
    v_rcp_f32 v56, v56
    v_rcp_f32 v57, v57
    v_rcp_f32 v58, v58
    v_rcp_f32 v59, v59
    v_rcp_f32 v60, v60
    v_rcp_f32 v61, v61
    v_pk_mul_f32 v[122:123], v[122:123], v[48:49]
    v_pk_mul_f32 v[128:129], v[128:129], v[50:51]
    v_pk_mul_f32 v[130:131], v[130:131], v[52:53]
    v_pk_mul_f32 v[136:137], v[136:137], v[54:55]
    v_pk_mul_f32 v[138:139], v[138:139], v[56:57]
    v_pk_mul_f32 v[144:145], v[144:145], v[58:59]
    v_pk_mul_f32 v[146:147], v[146:147], v[60:61]
    v_cvt_pk_bf16_f32 v64, v96, v97
    v_cvt_pk_bf16_f32 v65, v98, v99
    v_cvt_pk_bf16_f32 v66, v104, v105
    v_cvt_pk_bf16_f32 v67, v106, v107
    v_cvt_pk_bf16_f32 v68, v112, v113
    v_cvt_pk_bf16_f32 v69, v114, v115
    v_cvt_pk_bf16_f32 v70, v120, v121
    v_cvt_pk_bf16_f32 v71, v122, v123
    v_cvt_pk_bf16_f32 v72, v128, v129
    v_cvt_pk_bf16_f32 v73, v130, v131
    v_cvt_pk_bf16_f32 v74, v136, v137
    v_cvt_pk_bf16_f32 v75, v138, v139
    v_cvt_pk_bf16_f32 v76, v144, v145
    v_cvt_pk_bf16_f32 v77, v146, v147
    v_pk_mul_f32 v[60:61], v[12:13], v[10:11] op_sel:[0,1]
    v_pk_fma_f32 v[100:101], v[100:101], v[8:9], v[60:61] op_sel:[0,1,0]
    v_pk_mul_f32 v[62:63], v[14:15], v[10:11] op_sel:[0,1]
    v_pk_fma_f32 v[102:103], v[102:103], v[8:9], v[62:63] op_sel:[0,1,0]
    v_pk_mul_f32 v[48:49], v[16:17], v[10:11] op_sel:[0,1]
    v_pk_fma_f32 v[108:109], v[108:109], v[8:9], v[48:49] op_sel:[0,1,0]
    v_pk_mul_f32 v[50:51], v[18:19], v[10:11] op_sel:[0,1]
    v_pk_fma_f32 v[110:111], v[110:111], v[8:9], v[50:51] op_sel:[0,1,0]
    v_pk_mul_f32 v[52:53], v[20:21], v[10:11] op_sel:[0,1]
    v_pk_fma_f32 v[116:117], v[116:117], v[8:9], v[52:53] op_sel:[0,1,0]
    v_pk_mul_f32 v[54:55], v[22:23], v[10:11] op_sel:[0,1]
    v_pk_fma_f32 v[118:119], v[118:119], v[8:9], v[54:55] op_sel:[0,1,0]
    v_pk_mul_f32 v[56:57], v[24:25], v[10:11] op_sel:[0,1]
    v_pk_fma_f32 v[124:125], v[124:125], v[8:9], v[56:57] op_sel:[0,1,0]
    v_pk_mul_f32 v[58:59], v[26:27], v[10:11] op_sel:[0,1]
    v_pk_fma_f32 v[126:127], v[126:127], v[8:9], v[58:59] op_sel:[0,1,0]
    v_pk_mul_f32 v[60:61], v[28:29], v[10:11] op_sel:[0,1]
    v_pk_fma_f32 v[132:133], v[132:133], v[8:9], v[60:61] op_sel:[0,1,0]
    v_pk_mul_f32 v[62:63], v[30:31], v[10:11] op_sel:[0,1]
    v_pk_fma_f32 v[134:135], v[134:135], v[8:9], v[62:63] op_sel:[0,1,0]
    v_pk_mul_f32 v[48:49], v[32:33], v[10:11] op_sel:[0,1]
    v_pk_fma_f32 v[140:141], v[140:141], v[8:9], v[48:49] op_sel:[0,1,0]
    v_pk_mul_f32 v[50:51], v[34:35], v[10:11] op_sel:[0,1]
    v_pk_fma_f32 v[142:143], v[142:143], v[8:9], v[50:51] op_sel:[0,1,0]
    v_pk_mul_f32 v[52:53], v[36:37], v[10:11] op_sel:[0,1]
    v_pk_fma_f32 v[148:149], v[148:149], v[8:9], v[52:53] op_sel:[0,1,0]
    v_pk_mul_f32 v[54:55], v[38:39], v[10:11] op_sel:[0,1]
    v_pk_fma_f32 v[150:151], v[150:151], v[8:9], v[54:55] op_sel:[0,1,0]
    v_pk_mul_f32 v[48:49], v[100:101], v[100:101]
    v_pk_mul_f32 v[50:51], v[102:103], v[102:103]
    v_pk_mul_f32 v[52:53], v[108:109], v[108:109]
    v_pk_mul_f32 v[54:55], v[110:111], v[110:111]
    v_pk_mul_f32 v[56:57], v[116:117], v[116:117]
    v_pk_mul_f32 v[58:59], v[118:119], v[118:119]
    v_pk_mul_f32 v[60:61], v[124:125], v[124:125]
    v_pk_fma_f32 v[48:49], v[48:49], s[62:63], v[44:45]
    v_pk_fma_f32 v[50:51], v[50:51], s[62:63], v[44:45]
    v_pk_fma_f32 v[52:53], v[52:53], s[62:63], v[44:45]
    v_pk_fma_f32 v[54:55], v[54:55], s[62:63], v[44:45]
    v_pk_fma_f32 v[56:57], v[56:57], s[62:63], v[44:45]
    v_pk_fma_f32 v[58:59], v[58:59], s[62:63], v[44:45]
    v_pk_fma_f32 v[60:61], v[60:61], s[62:63], v[44:45]
    v_pk_mul_f32 v[48:49], v[48:49], v[100:101]
    v_pk_mul_f32 v[50:51], v[50:51], v[102:103]
    v_pk_mul_f32 v[52:53], v[52:53], v[108:109]
    v_pk_mul_f32 v[54:55], v[54:55], v[110:111]
    v_pk_mul_f32 v[56:57], v[56:57], v[116:117]
    v_pk_mul_f32 v[58:59], v[58:59], v[118:119]
    v_pk_mul_f32 v[60:61], v[60:61], v[124:125]
    v_exp_f32 v48, v48
    v_exp_f32 v49, v49
    v_exp_f32 v50, v50
    v_exp_f32 v51, v51
    v_exp_f32 v52, v52
    v_exp_f32 v53, v53
    v_exp_f32 v54, v54
    v_exp_f32 v55, v55
    v_exp_f32 v56, v56
    v_exp_f32 v57, v57
    v_exp_f32 v58, v58
    v_exp_f32 v59, v59
    v_exp_f32 v60, v60
    v_exp_f32 v61, v61
    v_pk_add_f32 v[48:49], v[48:49], s[78:79]
    v_pk_add_f32 v[50:51], v[50:51], s[78:79]
    v_pk_add_f32 v[52:53], v[52:53], s[78:79]
    v_pk_add_f32 v[54:55], v[54:55], s[78:79]
    v_pk_add_f32 v[56:57], v[56:57], s[78:79]
    v_pk_add_f32 v[58:59], v[58:59], s[78:79]
    v_pk_add_f32 v[60:61], v[60:61], s[78:79]
    v_rcp_f32 v48, v48
    v_rcp_f32 v49, v49
    v_rcp_f32 v50, v50
    v_rcp_f32 v51, v51
    v_rcp_f32 v52, v52
    v_rcp_f32 v53, v53
    v_rcp_f32 v54, v54
    v_rcp_f32 v55, v55
    v_rcp_f32 v56, v56
    v_rcp_f32 v57, v57
    v_rcp_f32 v58, v58
    v_rcp_f32 v59, v59
    v_rcp_f32 v60, v60
    v_rcp_f32 v61, v61
    v_pk_mul_f32 v[100:101], v[100:101], v[48:49]
    v_pk_mul_f32 v[102:103], v[102:103], v[50:51]
    v_pk_mul_f32 v[108:109], v[108:109], v[52:53]
    v_pk_mul_f32 v[110:111], v[110:111], v[54:55]
    v_pk_mul_f32 v[116:117], v[116:117], v[56:57]
    v_pk_mul_f32 v[118:119], v[118:119], v[58:59]
    v_pk_mul_f32 v[124:125], v[124:125], v[60:61]
    v_pk_mul_f32 v[48:49], v[126:127], v[126:127]
    v_pk_mul_f32 v[50:51], v[132:133], v[132:133]
    v_pk_mul_f32 v[52:53], v[134:135], v[134:135]
    v_pk_mul_f32 v[54:55], v[140:141], v[140:141]
    v_pk_mul_f32 v[56:57], v[142:143], v[142:143]
    v_pk_mul_f32 v[58:59], v[148:149], v[148:149]
    v_pk_mul_f32 v[60:61], v[150:151], v[150:151]
    v_pk_fma_f32 v[48:49], v[48:49], s[62:63], v[44:45]
    v_pk_fma_f32 v[50:51], v[50:51], s[62:63], v[44:45]
    v_pk_fma_f32 v[52:53], v[52:53], s[62:63], v[44:45]
    v_pk_fma_f32 v[54:55], v[54:55], s[62:63], v[44:45]
    v_pk_fma_f32 v[56:57], v[56:57], s[62:63], v[44:45]
    v_pk_fma_f32 v[58:59], v[58:59], s[62:63], v[44:45]
    v_pk_fma_f32 v[60:61], v[60:61], s[62:63], v[44:45]
    v_pk_mul_f32 v[48:49], v[48:49], v[126:127]
    v_pk_mul_f32 v[50:51], v[50:51], v[132:133]
    v_pk_mul_f32 v[52:53], v[52:53], v[134:135]
    v_pk_mul_f32 v[54:55], v[54:55], v[140:141]
    v_pk_mul_f32 v[56:57], v[56:57], v[142:143]
    v_pk_mul_f32 v[58:59], v[58:59], v[148:149]
    v_pk_mul_f32 v[60:61], v[60:61], v[150:151]
    v_exp_f32 v48, v48
    v_exp_f32 v49, v49
    v_exp_f32 v50, v50
    v_exp_f32 v51, v51
    v_exp_f32 v52, v52
    v_exp_f32 v53, v53
    v_exp_f32 v54, v54
    v_exp_f32 v55, v55
    v_exp_f32 v56, v56
    v_exp_f32 v57, v57
    v_exp_f32 v58, v58
    v_exp_f32 v59, v59
    v_exp_f32 v60, v60
    v_exp_f32 v61, v61
    v_pk_add_f32 v[48:49], v[48:49], s[78:79]
    v_pk_add_f32 v[50:51], v[50:51], s[78:79]
    v_pk_add_f32 v[52:53], v[52:53], s[78:79]
    v_pk_add_f32 v[54:55], v[54:55], s[78:79]
    v_pk_add_f32 v[56:57], v[56:57], s[78:79]
    v_pk_add_f32 v[58:59], v[58:59], s[78:79]
    v_pk_add_f32 v[60:61], v[60:61], s[78:79]
    v_rcp_f32 v48, v48
    v_rcp_f32 v49, v49
    v_rcp_f32 v50, v50
    v_rcp_f32 v51, v51
    v_rcp_f32 v52, v52
    v_rcp_f32 v53, v53
    v_rcp_f32 v54, v54
    v_rcp_f32 v55, v55
    v_rcp_f32 v56, v56
    v_rcp_f32 v57, v57
    v_rcp_f32 v58, v58
    v_rcp_f32 v59, v59
    v_rcp_f32 v60, v60
    v_rcp_f32 v61, v61
    v_pk_mul_f32 v[126:127], v[126:127], v[48:49]
    v_pk_mul_f32 v[132:133], v[132:133], v[50:51]
    v_pk_mul_f32 v[134:135], v[134:135], v[52:53]
    v_pk_mul_f32 v[140:141], v[140:141], v[54:55]
    v_pk_mul_f32 v[142:143], v[142:143], v[56:57]
    v_pk_mul_f32 v[148:149], v[148:149], v[58:59]
    v_pk_mul_f32 v[150:151], v[150:151], v[60:61]
    v_cvt_pk_bf16_f32 v80, v100, v101
    v_cvt_pk_bf16_f32 v81, v102, v103
    v_cvt_pk_bf16_f32 v82, v108, v109
    v_cvt_pk_bf16_f32 v83, v110, v111
    v_cvt_pk_bf16_f32 v84, v116, v117
    v_cvt_pk_bf16_f32 v85, v118, v119
    v_cvt_pk_bf16_f32 v86, v124, v125
    v_cvt_pk_bf16_f32 v87, v126, v127
    v_cvt_pk_bf16_f32 v88, v132, v133
    v_cvt_pk_bf16_f32 v89, v134, v135
    v_cvt_pk_bf16_f32 v90, v140, v141
    v_cvt_pk_bf16_f32 v91, v142, v143
    v_cvt_pk_bf16_f32 v92, v148, v149
    v_cvt_pk_bf16_f32 v93, v150, v151
    s_lshl_b32 s72, s52, 2
    s_add_u32 s72, s72, s57
    s_lshl_b32 s72, s72, 3
    s_add_u32 s72, s72, s54
    s_lshl_b32 s72, s72, 3
    s_add_u32 s31, s72, 20975616
    s_barrier
f_p2b:
    v_lshlrev_b32 v5, 4, v0
    v_lshlrev_b32 v6, 3, v0
    s_and_b32 s63, s3, 3
    v_add_u32 v2, 89088, v5
    v_and_b32 v40, 15, v0
    v_lshrrev_b32 v41, 4, v0
    v_lshrrev_b32 v42, 1, v41
    v_add_u32 v42, 4, v42
    v_lshrrev_b32 v43, 1, v40
    v_xor_b32 v42, v42, v43
    v_lshlrev_b32 v42, 4, v42
    v_and_b32 v41, 1, v41
    v_lshl_add_u32 v42, v41, 3, v42
    v_lshl_add_u32 v42, v40, 7, v42
    s_lshl_b32 s66, s63, 12
    v_add_u32 v3, s66, v42
    v_xor_b32 v4, 32, v3
    s_cmp_eq_u32 s6, 0
    s_cselect_b32 s66, -1, 0
    v_lshlrev_b32 v7, 16, v163
    v_and_b32 v7, s66, v7
    v_mov_b32 v96, 0
    v_mov_b32 v97, 0
    v_mov_b32 v98, 0
    v_mov_b32 v99, 0
    v_mov_b32 v100, v7
    v_mov_b32 v101, v7
    v_mov_b32 v102, v7
    v_mov_b32 v103, v7
    v_mov_b32 v104, 0
    v_mov_b32 v105, 0
    v_mov_b32 v106, 0
    v_mov_b32 v107, 0
    v_mov_b32 v108, v7
    v_mov_b32 v109, v7
    v_mov_b32 v110, v7
    v_mov_b32 v111, v7
    v_mov_b32 v112, 0
    v_mov_b32 v113, 0
    v_mov_b32 v114, 0
    v_mov_b32 v115, 0
    v_mov_b32 v116, v7
    v_mov_b32 v117, v7
    v_mov_b32 v118, v7
    v_mov_b32 v119, v7
    v_mov_b32 v120, 0
    v_mov_b32 v121, 0
    v_mov_b32 v122, 0
    v_mov_b32 v123, 0
    v_mov_b32 v124, v7
    v_mov_b32 v125, v7
    v_mov_b32 v126, v7
    v_mov_b32 v127, v7
    v_mov_b32 v128, 0
    v_mov_b32 v129, 0
    v_mov_b32 v130, 0
    v_mov_b32 v131, 0
    v_mov_b32 v132, v7
    v_mov_b32 v133, v7
    v_mov_b32 v134, v7
    v_mov_b32 v135, v7
    v_mov_b32 v136, 0
    v_mov_b32 v137, 0
    v_mov_b32 v138, 0
    v_mov_b32 v139, 0
    v_mov_b32 v140, v7
    v_mov_b32 v141, v7
    v_mov_b32 v142, v7
    v_mov_b32 v143, v7
    v_mov_b32 v144, 0
    v_mov_b32 v145, 0
    v_mov_b32 v146, 0
    v_mov_b32 v147, 0
    v_mov_b32 v148, v7
    v_mov_b32 v149, v7
    v_mov_b32 v150, v7
    v_mov_b32 v151, v7
    s_lshl_b32 s72, s4, 2
    s_add_u32 s72, s72, s63
    s_lshl_b32 s73, s72, 3
    s_add_u32 s73, s73, s5
    s_lshl_b32 s76, s73, 3
    s_add_u32 s76, s76, 20975616
    s_lshl_b32 s73, s72, 1
    s_add_u32 s73, s73, 1
    s_lshl_b32 s73, s73, 3
    s_add_u32 s73, s73, s5
    s_lshl_b32 s77, s73, 1
    s_add_u32 s77, s77, s6
    s_lshl_b32 s77, s77, 3
    s_add_u32 s77, s77, 20987904
    s_mul_i32 s73, s73, 3584
    s_add_u32 s79, s73, 5242880
    s_mul_i32 s81, s6, 3670016
    s_add_u32 s81, s81, s73
    s_add_u32 s81, s81, 12582912
    s_lshr_b32 s67, s3, 1
    s_and_b32 s66, s3, 1
    s_lshl_b32 s68, s7, 1
    s_add_u32 s68, s68, s66
    s_lshl_b32 s70, s67, 2
    s_lshl_b32 s84, s68, 4
    s_add_u32 s84, s84, s70
    s_lshl_b32 s84, s84, 3
    s_add_u32 s84, s84, 20979712
    s_lshl_b32 s85, s68, 5
    s_add_u32 s85, s85, s70
    s_lshl_b32 s85, s85, 10
    s_add_u32 s85, s85, 9437184
    s_add_u32 s86, s85, 16384
    v_mov_b32 v156, 0
    v_and_b32 v157, 3, v0
    v_lshlrev_b32 v157, 3, v157
    s_mov_b32 s66, 0
    s_mov_b32 s70, 16384
    s_mov_b32 s71, 14336
    s_mov_b32 s69, 7
    s_barrier
    ds_read_b64 v[8:9], v3 offset:0
    ds_read_b64 v[10:11], v4 offset:0
    ds_read_b64 v[12:13], v3 offset:2048
    ds_read_b64 v[14:15], v4 offset:2048
    ds_read_b128 v[24:27], v2 offset:0
    ds_read_b128 v[28:31], v2 offset:1024
    ds_read_b128 v[32:35], v2 offset:2048
    ds_read_b128 v[36:39], v2 offset:3072
    ds_read_b128 v[40:43], v2 offset:4096
    ds_read_b128 v[44:47], v2 offset:5120
    ds_read_b128 v[48:51], v2 offset:6144
    s_cmp_ge_u32 s53, 8
    s_cbranch_scc1 p2c1_dB
    buffer_store_dwordx4 v[64:67], v5, s[44:47], s74 offen sc1
    buffer_store_dwordx4 v[68:71], v5, s[44:47], s75 offen sc1
    s_branch p2c1_dE
p2c1_dB:
    buffer_store_dwordx4 v[64:67], v5, s[44:47], s74 offen offset:0 sc1
    buffer_store_dwordx4 v[68:71], v5, s[44:47], s74 offen offset:1024 sc1
    buffer_store_dwordx4 v[72:75], v5, s[44:47], s74 offen offset:2048 sc1
    buffer_store_dwordx2 v[76:77], v6, s[44:47], s74 offen offset:3072 sc1
    buffer_store_dwordx4 v[80:83], v5, s[44:47], s75 offen offset:0 sc1
    buffer_store_dwordx4 v[84:87], v5, s[44:47], s75 offen offset:1024 sc1
    buffer_store_dwordx4 v[88:91], v5, s[44:47], s75 offen offset:2048 sc1
    buffer_store_dwordx2 v[92:93], v6, s[44:47], s75 offen offset:3072 sc1
p2c1_dE:
p2c1_loop:
    s_waitcnt lgkmcnt(7)
    s_waitcnt lgkmcnt(6)
    v_mfma_f32_16x16x32_bf16 v[96:99], v[24:27], v[8:11], v[96:99]
    v_mfma_f32_16x16x32_bf16 v[100:103], v[24:27], v[12:15], v[100:103]
    s_waitcnt lgkmcnt(5)
    v_mfma_f32_16x16x32_bf16 v[104:107], v[28:31], v[8:11], v[104:107]
    v_mfma_f32_16x16x32_bf16 v[108:111], v[28:31], v[12:15], v[108:111]
    s_waitcnt lgkmcnt(4)
    v_mfma_f32_16x16x32_bf16 v[112:115], v[32:35], v[8:11], v[112:115]
    v_mfma_f32_16x16x32_bf16 v[116:119], v[32:35], v[12:15], v[116:119]
    s_barrier
    s_add_u32 s66, s66, 1
    s_cmp_eq_u32 s66, 5
    s_cselect_b32 s67, -65536, s70
    s_cselect_b32 s68, -57344, s71
    s_cselect_b32 s66, 0, s66
    v_add_u32 v3, s67, v3
    v_add_u32 v4, s67, v4
    v_add_u32 v2, s68, v2
    s_cmp_lg_u32 s69, 2
    s_cbranch_scc1 p2c1_nh2
    buffer_load_dwordx2 v[152:153], v156, s[44:47], s76 offen sc1
    buffer_load_dwordx2 v[154:155], v157, s[44:47], s84 offen sc1
p2c1_nh2:
    s_waitcnt lgkmcnt(3)
    v_mfma_f32_16x16x32_bf16 v[120:123], v[36:39], v[8:11], v[120:123]
    ds_read_b64 v[16:17], v3 offset:0
    ds_read_b64 v[18:19], v4 offset:0
    v_mfma_f32_16x16x32_bf16 v[124:127], v[36:39], v[12:15], v[124:127]
    ds_read_b64 v[20:21], v3 offset:2048
    ds_read_b64 v[22:23], v4 offset:2048
    s_waitcnt lgkmcnt(6)
    v_mfma_f32_16x16x32_bf16 v[128:131], v[40:43], v[8:11], v[128:131]
    ds_read_b128 v[24:27], v2 offset:0
    ds_read_b128 v[28:31], v2 offset:1024
    v_mfma_f32_16x16x32_bf16 v[132:135], v[40:43], v[12:15], v[132:135]
    ds_read_b128 v[32:35], v2 offset:2048
    ds_read_b128 v[36:39], v2 offset:3072
    s_waitcnt lgkmcnt(9)
    v_mfma_f32_16x16x32_bf16 v[136:139], v[44:47], v[8:11], v[136:139]
    ds_read_b128 v[40:43], v2 offset:4096
    v_mfma_f32_16x16x32_bf16 v[140:143], v[44:47], v[12:15], v[140:143]
    s_waitcnt lgkmcnt(9)
    v_mfma_f32_16x16x32_bf16 v[144:147], v[48:51], v[8:11], v[144:147]
    ds_read_b128 v[44:47], v2 offset:5120
    v_mfma_f32_16x16x32_bf16 v[148:151], v[48:51], v[12:15], v[148:151]
    ds_read_b128 v[48:51], v2 offset:6144
    s_waitcnt lgkmcnt(7)
    s_waitcnt lgkmcnt(6)
    v_mfma_f32_16x16x32_bf16 v[96:99], v[24:27], v[16:19], v[96:99]
    v_mfma_f32_16x16x32_bf16 v[100:103], v[24:27], v[20:23], v[100:103]
    s_waitcnt lgkmcnt(5)
    v_mfma_f32_16x16x32_bf16 v[104:107], v[28:31], v[16:19], v[104:107]
    v_mfma_f32_16x16x32_bf16 v[108:111], v[28:31], v[20:23], v[108:111]
    s_waitcnt lgkmcnt(4)
    v_mfma_f32_16x16x32_bf16 v[112:115], v[32:35], v[16:19], v[112:115]
    v_mfma_f32_16x16x32_bf16 v[116:119], v[32:35], v[20:23], v[116:119]
    s_barrier
    s_add_u32 s66, s66, 1
    s_cmp_eq_u32 s66, 5
    s_cselect_b32 s67, -65536, s70
    s_cselect_b32 s68, -57344, s71
    s_cselect_b32 s66, 0, s66
    v_add_u32 v3, s67, v3
    v_add_u32 v4, s67, v4
    v_add_u32 v2, s68, v2
    s_cmp_lg_u32 s69, 5
    s_cbranch_scc1 p2c1_nh1
    s_waitcnt vmcnt(0)
    v_mov_b32 v52, s60
    v_mov_b32 v53, s61
    v_mov_b32 v54, 0
    s_mov_b64 exec, 1
    buffer_store_dwordx2 v[52:53], v54, s[44:47], s31 offen sc1
    s_mov_b64 exec, -1
p2c1_nh1:
    s_cmp_lg_u32 s69, 1
    s_cbranch_scc1 p2c1_nh3
    s_waitcnt vmcnt(0)
    v_cmp_eq_u32 vcc, s60, v152
    v_cmp_eq_u32 s[90:91], s61, v153
    s_and_b64 vcc, vcc, s[90:91]
    s_cmp_eq_u64 vcc, -1
    s_cbranch_scc1 p2c1z_fok
    s_mov_b32 s55, 40000
p2c1z_pl:
    buffer_load_dwordx2 v[152:153], v156, s[44:47], s76 offen sc1
    s_waitcnt vmcnt(0)
    v_cmp_eq_u32 vcc, s60, v152
    v_cmp_eq_u32 s[90:91], s61, v153
    s_and_b64 vcc, vcc, s[90:91]
    s_cmp_eq_u64 vcc, -1
    s_cbranch_scc1 p2c1z_pok
    s_sub_u32 s55, s55, 1
    s_cmp_lg_u32 s55, 0
    s_cbranch_scc1 p2c1z_pl
p2c1z_pok:
p2c1z_fok:
    buffer_load_dwordx4 v[52:55], v5, s[44:47], s79 offen offset:0 sc1
    buffer_load_dwordx4 v[56:59], v5, s[44:47], s79 offen offset:1024 sc1
    buffer_load_dwordx4 v[60:63], v5, s[44:47], s79 offen offset:2048 sc1
    buffer_load_dwordx2 v[64:65], v6, s[44:47], s79 offen offset:3072 sc1
p2c1_nh3:
    s_waitcnt lgkmcnt(3)
    v_mfma_f32_16x16x32_bf16 v[120:123], v[36:39], v[16:19], v[120:123]
    ds_read_b64 v[8:9], v3 offset:0
    ds_read_b64 v[10:11], v4 offset:0
    v_mfma_f32_16x16x32_bf16 v[124:127], v[36:39], v[20:23], v[124:127]
    ds_read_b64 v[12:13], v3 offset:2048
    ds_read_b64 v[14:15], v4 offset:2048
    s_waitcnt lgkmcnt(6)
    v_mfma_f32_16x16x32_bf16 v[128:131], v[40:43], v[16:19], v[128:131]
    ds_read_b128 v[24:27], v2 offset:0
    ds_read_b128 v[28:31], v2 offset:1024
    v_mfma_f32_16x16x32_bf16 v[132:135], v[40:43], v[20:23], v[132:135]
    ds_read_b128 v[32:35], v2 offset:2048
    ds_read_b128 v[36:39], v2 offset:3072
    s_waitcnt lgkmcnt(9)
    v_mfma_f32_16x16x32_bf16 v[136:139], v[44:47], v[16:19], v[136:139]
    ds_read_b128 v[40:43], v2 offset:4096
    v_mfma_f32_16x16x32_bf16 v[140:143], v[44:47], v[20:23], v[140:143]
    s_waitcnt lgkmcnt(9)
    v_mfma_f32_16x16x32_bf16 v[144:147], v[48:51], v[16:19], v[144:147]
    ds_read_b128 v[44:47], v2 offset:5120
    v_mfma_f32_16x16x32_bf16 v[148:151], v[48:51], v[20:23], v[148:151]
    ds_read_b128 v[48:51], v2 offset:6144
    s_sub_u32 s69, s69, 1
    s_cmp_lg_u32 s69, 0
    s_cbranch_scc1 p2c1_loop
    s_waitcnt lgkmcnt(7)
    s_waitcnt lgkmcnt(6)
    v_mfma_f32_16x16x32_bf16 v[96:99], v[24:27], v[8:11], v[96:99]
    v_mfma_f32_16x16x32_bf16 v[100:103], v[24:27], v[12:15], v[100:103]
    s_waitcnt lgkmcnt(5)
    v_mfma_f32_16x16x32_bf16 v[104:107], v[28:31], v[8:11], v[104:107]
    v_mfma_f32_16x16x32_bf16 v[108:111], v[28:31], v[12:15], v[108:111]
    s_waitcnt lgkmcnt(4)
    v_mfma_f32_16x16x32_bf16 v[112:115], v[32:35], v[8:11], v[112:115]
    v_mfma_f32_16x16x32_bf16 v[116:119], v[32:35], v[12:15], v[116:119]
    s_waitcnt lgkmcnt(0)
    s_barrier
    s_add_u32 s66, s66, 1
    s_cmp_eq_u32 s66, 5
    s_cselect_b32 s67, -65536, s70
    s_cselect_b32 s68, -57344, s71
    s_cselect_b32 s66, 0, s66
    v_add_u32 v3, s67, v3
    v_add_u32 v4, s67, v4
    v_add_u32 v2, s68, v2
    v_mfma_f32_16x16x32_bf16 v[120:123], v[36:39], v[8:11], v[120:123]
    ds_read_b64 v[16:17], v3 offset:0
    ds_read_b64 v[18:19], v4 offset:0
    v_mfma_f32_16x16x32_bf16 v[124:127], v[36:39], v[12:15], v[124:127]
    ds_read_b64 v[20:21], v3 offset:2048
    ds_read_b64 v[22:23], v4 offset:2048
    v_mfma_f32_16x16x32_bf16 v[128:131], v[40:43], v[8:11], v[128:131]
    ds_read_b128 v[24:27], v2 offset:0
    ds_read_b128 v[28:31], v2 offset:1024
    v_mfma_f32_16x16x32_bf16 v[132:135], v[40:43], v[12:15], v[132:135]
    ds_read_b128 v[32:35], v2 offset:2048
    ds_read_b128 v[36:39], v2 offset:3072
    v_mfma_f32_16x16x32_bf16 v[136:139], v[44:47], v[8:11], v[136:139]
    ds_read_b128 v[40:43], v2 offset:4096
    v_mfma_f32_16x16x32_bf16 v[140:143], v[44:47], v[12:15], v[140:143]
    v_mfma_f32_16x16x32_bf16 v[144:147], v[48:51], v[8:11], v[144:147]
    ds_read_b128 v[44:47], v2 offset:5120
    v_mfma_f32_16x16x32_bf16 v[148:151], v[48:51], v[12:15], v[148:151]
    ds_read_b128 v[48:51], v2 offset:6144
    s_waitcnt lgkmcnt(7)
    s_waitcnt lgkmcnt(6)
    v_mfma_f32_16x16x32_bf16 v[96:99], v[24:27], v[16:19], v[96:99]
    v_mfma_f32_16x16x32_bf16 v[100:103], v[24:27], v[20:23], v[100:103]
    s_waitcnt lgkmcnt(5)
    v_mfma_f32_16x16x32_bf16 v[104:107], v[28:31], v[16:19], v[104:107]
    v_mfma_f32_16x16x32_bf16 v[108:111], v[28:31], v[20:23], v[108:111]
    s_waitcnt lgkmcnt(4)
    v_mfma_f32_16x16x32_bf16 v[112:115], v[32:35], v[16:19], v[112:115]
    v_mfma_f32_16x16x32_bf16 v[116:119], v[32:35], v[20:23], v[116:119]
    s_waitcnt lgkmcnt(3)
    v_mfma_f32_16x16x32_bf16 v[120:123], v[36:39], v[16:19], v[120:123]
    v_mfma_f32_16x16x32_bf16 v[124:127], v[36:39], v[20:23], v[124:127]
    s_waitcnt lgkmcnt(2)
    v_mfma_f32_16x16x32_bf16 v[128:131], v[40:43], v[16:19], v[128:131]
    v_mfma_f32_16x16x32_bf16 v[132:135], v[40:43], v[20:23], v[132:135]
    s_waitcnt lgkmcnt(1)
    v_mfma_f32_16x16x32_bf16 v[136:139], v[44:47], v[16:19], v[136:139]
    v_mfma_f32_16x16x32_bf16 v[140:143], v[44:47], v[20:23], v[140:143]
    s_waitcnt lgkmcnt(0)
    v_mfma_f32_16x16x32_bf16 v[144:147], v[48:51], v[16:19], v[144:147]
    v_mfma_f32_16x16x32_bf16 v[148:151], v[48:51], v[20:23], v[148:151]
    s_waitcnt lgkmcnt(0)
    s_mul_i32 s66, s63, 7168
    s_add_u32 s67, s66, 45056
    s_add_u32 s68, s66, 16384
    v_add_u32 v2, s67, v5
    v_add_u32 v3, s68, v5
    ds_write_b128 v2, v[96:99] offset:0
    ds_write_b128 v2, v[104:107] offset:1024
    ds_write_b128 v2, v[112:115] offset:2048
    ds_write_b128 v2, v[120:123] offset:3072
    ds_write_b128 v2, v[128:131] offset:4096
    ds_write_b128 v2, v[136:139] offset:5120
    ds_write_b128 v2, v[144:147] offset:6144
    s_waitcnt lgkmcnt(0)
    s_barrier
    ds_read_b128 v[96:99], v3 offset:0
    ds_read_b128 v[104:107], v3 offset:1024
    ds_read_b128 v[112:115], v3 offset:2048
    ds_read_b128 v[120:123], v3 offset:3072
    ds_read_b128 v[128:131], v3 offset:4096
    ds_read_b128 v[136:139], v3 offset:5120
    ds_read_b128 v[144:147], v3 offset:6144
    s_waitcnt lgkmcnt(0)
    s_barrier
    s_waitcnt vmcnt(0)
    v_pk_add_f32 v[100:101], v[100:101], v[96:97]
    v_pk_add_f32 v[102:103], v[102:103], v[98:99]
    v_lshlrev_b32 v8, 16, v52
    v_and_b32 v9, 0xffff0000, v52
    v_lshlrev_b32 v10, 16, v53
    v_and_b32 v11, 0xffff0000, v53
    v_pk_mul_f32 v[100:101], v[100:101], v[8:9]
    v_pk_mul_f32 v[102:103], v[102:103], v[10:11]
    v_cvt_pk_bf16_f32 v40, v100, v101
    v_cvt_pk_bf16_f32 v41, v102, v103
    v_pk_add_f32 v[108:109], v[108:109], v[104:105]
    v_pk_add_f32 v[110:111], v[110:111], v[106:107]
    v_lshlrev_b32 v12, 16, v54
    v_and_b32 v13, 0xffff0000, v54
    v_lshlrev_b32 v14, 16, v55
    v_and_b32 v15, 0xffff0000, v55
    v_pk_mul_f32 v[108:109], v[108:109], v[12:13]
    v_pk_mul_f32 v[110:111], v[110:111], v[14:15]
    v_cvt_pk_bf16_f32 v42, v108, v109
    v_cvt_pk_bf16_f32 v43, v110, v111
    buffer_store_dwordx4 v[40:43], v5, s[44:47], s81 offen offset:0 sc1
    v_pk_add_f32 v[116:117], v[116:117], v[112:113]
    v_pk_add_f32 v[118:119], v[118:119], v[114:115]
    v_lshlrev_b32 v16, 16, v56
    v_and_b32 v17, 0xffff0000, v56
    v_lshlrev_b32 v18, 16, v57
    v_and_b32 v19, 0xffff0000, v57
    v_pk_mul_f32 v[116:117], v[116:117], v[16:17]
    v_pk_mul_f32 v[118:119], v[118:119], v[18:19]
    v_cvt_pk_bf16_f32 v44, v116, v117
    v_cvt_pk_bf16_f32 v45, v118, v119
    v_pk_add_f32 v[124:125], v[124:125], v[120:121]
    v_pk_add_f32 v[126:127], v[126:127], v[122:123]
    v_lshlrev_b32 v20, 16, v58
    v_and_b32 v21, 0xffff0000, v58
    v_lshlrev_b32 v22, 16, v59
    v_and_b32 v23, 0xffff0000, v59
    v_pk_mul_f32 v[124:125], v[124:125], v[20:21]
    v_pk_mul_f32 v[126:127], v[126:127], v[22:23]
    v_cvt_pk_bf16_f32 v46, v124, v125
    v_cvt_pk_bf16_f32 v47, v126, v127
    buffer_store_dwordx4 v[44:47], v5, s[44:47], s81 offen offset:1024 sc1
    v_pk_add_f32 v[132:133], v[132:133], v[128:129]
    v_pk_add_f32 v[134:135], v[134:135], v[130:131]
    v_lshlrev_b32 v24, 16, v60
    v_and_b32 v25, 0xffff0000, v60
    v_lshlrev_b32 v26, 16, v61
    v_and_b32 v27, 0xffff0000, v61
    v_pk_mul_f32 v[132:133], v[132:133], v[24:25]
    v_pk_mul_f32 v[134:135], v[134:135], v[26:27]
    v_cvt_pk_bf16_f32 v48, v132, v133
    v_cvt_pk_bf16_f32 v49, v134, v135
    v_pk_add_f32 v[140:141], v[140:141], v[136:137]
    v_pk_add_f32 v[142:143], v[142:143], v[138:139]
    v_lshlrev_b32 v28, 16, v62
    v_and_b32 v29, 0xffff0000, v62
    v_lshlrev_b32 v30, 16, v63
    v_and_b32 v31, 0xffff0000, v63
    v_pk_mul_f32 v[140:141], v[140:141], v[28:29]
    v_pk_mul_f32 v[142:143], v[142:143], v[30:31]
    v_cvt_pk_bf16_f32 v50, v140, v141
    v_cvt_pk_bf16_f32 v51, v142, v143
    buffer_store_dwordx4 v[48:51], v5, s[44:47], s81 offen offset:2048 sc1
    v_pk_add_f32 v[148:149], v[148:149], v[144:145]
    v_pk_add_f32 v[150:151], v[150:151], v[146:147]
    v_lshlrev_b32 v32, 16, v64
    v_and_b32 v33, 0xffff0000, v64
    v_lshlrev_b32 v34, 16, v65
    v_and_b32 v35, 0xffff0000, v65
    v_pk_mul_f32 v[148:149], v[148:149], v[32:33]
    v_pk_mul_f32 v[150:151], v[150:151], v[34:35]
    v_cvt_pk_bf16_f32 v66, v148, v149
    v_cvt_pk_bf16_f32 v67, v150, v151
    buffer_store_dwordx2 v[66:67], v6, s[44:47], s81 offen offset:3072 sc1
f_p3:
    s_cmp_ge_u32 s30, 7
    s_cbranch_scc1 op_skip
    s_waitcnt vmcnt(4)
    v_cmp_eq_u32 vcc, s60, v154
    v_cmp_eq_u32 s[90:91], s61, v155
    s_and_b64 vcc, vcc, s[90:91]
    s_cmp_eq_u64 vcc, -1
    s_cbranch_scc1 opo_fok
    s_mov_b32 s55, 40000
opo_pl:
    buffer_load_dwordx2 v[154:155], v157, s[44:47], s84 offen sc1
    s_waitcnt vmcnt(0)
    v_cmp_eq_u32 vcc, s60, v154
    v_cmp_eq_u32 s[90:91], s61, v155
    s_and_b64 vcc, vcc, s[90:91]
    s_cmp_eq_u64 vcc, -1
    s_cbranch_scc1 opo_pok
    s_sub_u32 s55, s55, 1
    s_cmp_lg_u32 s55, 0
    s_cbranch_scc1 opo_pl
opo_pok:
opo_fok:
    buffer_load_dwordx4 v[8:11], v5, s[44:47], s85 offen offset:0 sc1
    buffer_load_dwordx4 v[12:15], v5, s[44:47], s86 offen offset:0 sc1
    buffer_load_dwordx4 v[16:19], v5, s[44:47], s85 offen offset:1024 sc1
    buffer_load_dwordx4 v[20:23], v5, s[44:47], s86 offen offset:1024 sc1
    buffer_load_dwordx4 v[24:27], v5, s[44:47], s85 offen offset:2048 sc1
    buffer_load_dwordx4 v[28:31], v5, s[44:47], s86 offen offset:2048 sc1
    buffer_load_dwordx4 v[32:35], v5, s[44:47], s85 offen offset:3072 sc1
    buffer_load_dwordx4 v[36:39], v5, s[44:47], s86 offen offset:3072 sc1
    s_waitcnt vmcnt(8)
    v_mov_b32 v104, s60
    v_mov_b32 v105, s61
    v_mov_b32 v106, 0
    s_mov_b64 exec, 1
    buffer_store_dwordx2 v[104:105], v106, s[44:47], s77 offen sc1
    s_mov_b64 exec, -1
    s_barrier
    s_lshr_b32 s67, s3, 1
    s_mul_i32 s72, s67, 14336
    s_add_u32 s72, s72, 105472
    v_and_b32 v104, 15, v0
    v_lshrrev_b32 v105, 4, v0
    v_lshrrev_b32 v106, 2, v104
    v_lshl_add_u32 v106, v105, 2, v106
    v_lshlrev_b32 v106, 7, v106
    v_and_b32 v107, 3, v104
    v_lshl_add_u32 v106, v107, 3, v106
    v_add_u32 v106, s72, v106
    v_and_b32 v105, 1, v105
    v_lshlrev_b32 v105, 1, v105
    v_lshrrev_b32 v107, 3, v104
    v_add_u32 v105, v105, v107
    v_xor_b32 v107, 0, v105
    v_lshl_add_u32 v100, v107, 5, v106
    v_xor_b32 v107, 1, v105
    v_lshl_add_u32 v101, v107, 5, v106
    v_xor_b32 v107, 2, v105
    v_lshl_add_u32 v102, v107, 5, v106
    v_xor_b32 v107, 3, v105
    v_lshl_add_u32 v103, v107, 5, v106
    ds_read_b64_tr_b16 v[68:69], v100 offset:0
    ds_read_b64_tr_b16 v[70:71], v100 offset:2048
    ds_read_b64_tr_b16 v[72:73], v101 offset:0
    ds_read_b64_tr_b16 v[74:75], v101 offset:2048
    ds_read_b64_tr_b16 v[76:77], v102 offset:0
    ds_read_b64_tr_b16 v[78:79], v102 offset:2048
    ds_read_b64_tr_b16 v[80:81], v103 offset:0
    ds_read_b64_tr_b16 v[82:83], v103 offset:2048
    ds_read_b64_tr_b16 v[84:85], v102 offset:3584
    ds_read_b64_tr_b16 v[86:87], v102 offset:5632
    ds_read_b64_tr_b16 v[88:89], v103 offset:3584
    ds_read_b64_tr_b16 v[90:91], v103 offset:5632
    ds_read_b64_tr_b16 v[92:93], v100 offset:3584
    ds_read_b64_tr_b16 v[94:95], v100 offset:5632
    ds_read_b64_tr_b16 v[96:97], v101 offset:3584
    ds_read_b64_tr_b16 v[98:99], v101 offset:5632
    s_waitcnt vmcnt(1)
    s_waitcnt lgkmcnt(8)
    v_mfma_f32_16x16x32_bf16 v[132:135], v[68:71], v[8:11], 0
    v_mfma_f32_16x16x32_bf16 v[136:139], v[68:71], v[12:15], 0
    v_mfma_f32_16x16x32_bf16 v[140:143], v[72:75], v[8:11], 0
    v_mfma_f32_16x16x32_bf16 v[144:147], v[72:75], v[12:15], 0
    v_mfma_f32_16x16x32_bf16 v[148:151], v[76:79], v[8:11], 0
    v_mfma_f32_16x16x32_bf16 v[152:155], v[76:79], v[12:15], 0
    v_mfma_f32_16x16x32_bf16 v[156:159], v[80:83], v[8:11], 0
    v_mfma_f32_16x16x32_bf16 v[160:163], v[80:83], v[12:15], 0
    ds_read_b64_tr_b16 v[68:69], v100 offset:7168
    ds_read_b64_tr_b16 v[70:71], v100 offset:9216
    ds_read_b64_tr_b16 v[72:73], v101 offset:7168
    ds_read_b64_tr_b16 v[74:75], v101 offset:9216
    ds_read_b64_tr_b16 v[76:77], v102 offset:7168
    ds_read_b64_tr_b16 v[78:79], v102 offset:9216
    ds_read_b64_tr_b16 v[80:81], v103 offset:7168
    ds_read_b64_tr_b16 v[82:83], v103 offset:9216
    s_waitcnt lgkmcnt(8)
    v_mfma_f32_16x16x32_bf16 v[132:135], v[84:87], v[16:19], v[132:135]
    v_mfma_f32_16x16x32_bf16 v[136:139], v[84:87], v[20:23], v[136:139]
    v_mfma_f32_16x16x32_bf16 v[140:143], v[88:91], v[16:19], v[140:143]
    v_mfma_f32_16x16x32_bf16 v[144:147], v[88:91], v[20:23], v[144:147]
    v_mfma_f32_16x16x32_bf16 v[148:151], v[92:95], v[16:19], v[148:151]
    v_mfma_f32_16x16x32_bf16 v[152:155], v[92:95], v[20:23], v[152:155]
    v_mfma_f32_16x16x32_bf16 v[156:159], v[96:99], v[16:19], v[156:159]
    v_mfma_f32_16x16x32_bf16 v[160:163], v[96:99], v[20:23], v[160:163]
    ds_read_b64_tr_b16 v[84:85], v102 offset:10752
    ds_read_b64_tr_b16 v[86:87], v102 offset:12800
    ds_read_b64_tr_b16 v[88:89], v103 offset:10752
    ds_read_b64_tr_b16 v[90:91], v103 offset:12800
    ds_read_b64_tr_b16 v[92:93], v100 offset:10752
    ds_read_b64_tr_b16 v[94:95], v100 offset:12800
    ds_read_b64_tr_b16 v[96:97], v101 offset:10752
    ds_read_b64_tr_b16 v[98:99], v101 offset:12800
    s_waitcnt lgkmcnt(8)
    v_mfma_f32_16x16x32_bf16 v[132:135], v[68:71], v[24:27], v[132:135]
    v_mfma_f32_16x16x32_bf16 v[136:139], v[68:71], v[28:31], v[136:139]
    v_mfma_f32_16x16x32_bf16 v[140:143], v[72:75], v[24:27], v[140:143]
    v_mfma_f32_16x16x32_bf16 v[144:147], v[72:75], v[28:31], v[144:147]
    v_mfma_f32_16x16x32_bf16 v[148:151], v[76:79], v[24:27], v[148:151]
    v_mfma_f32_16x16x32_bf16 v[152:155], v[76:79], v[28:31], v[152:155]
    v_mfma_f32_16x16x32_bf16 v[156:159], v[80:83], v[24:27], v[156:159]
    v_mfma_f32_16x16x32_bf16 v[160:163], v[80:83], v[28:31], v[160:163]
    s_waitcnt lgkmcnt(0)
    v_mfma_f32_16x16x32_bf16 v[132:135], v[84:87], v[32:35], v[132:135]
    v_mfma_f32_16x16x32_bf16 v[136:139], v[84:87], v[36:39], v[136:139]
    v_mfma_f32_16x16x32_bf16 v[140:143], v[88:91], v[32:35], v[140:143]
    v_mfma_f32_16x16x32_bf16 v[144:147], v[88:91], v[36:39], v[144:147]
    v_mfma_f32_16x16x32_bf16 v[148:151], v[92:95], v[32:35], v[148:151]
    v_mfma_f32_16x16x32_bf16 v[152:155], v[92:95], v[36:39], v[152:155]
    v_mfma_f32_16x16x32_bf16 v[156:159], v[96:99], v[32:35], v[156:159]
    v_mfma_f32_16x16x32_bf16 v[160:163], v[96:99], v[36:39], v[160:163]
    s_waitcnt lgkmcnt(0)
    s_barrier
    s_branch op_done
op_skip:
    s_waitcnt vmcnt(0)
    v_mov_b32 v104, s60
    v_mov_b32 v105, s61
    v_mov_b32 v106, 0
    s_mov_b64 exec, 1
    buffer_store_dwordx2 v[104:105], v106, s[44:47], s77 offen sc1
    s_mov_b64 exec, -1
op_done:
    s_cmp_ge_u32 s30, 7
    s_cbranch_scc1 p3c_skip
    s_and_b32 s66, s3, 1
    s_lshr_b32 s67, s3, 1
    s_lshl_b32 s68, s7, 2
    s_lshl_b32 s69, s66, 1
    s_add_u32 s68, s68, s69
    s_mul_i32 s70, s68, 28672
    s_mul_i32 s71, s67, 7168
    s_add_u32 s70, s70, s71
    s_add_u32 s70, s70, 12582912
    s_add_u32 s71, s70, 28672
    s_add_u32 s72, s70, 3670016
    s_add_u32 s73, s71, 3670016
    s_mul_i32 s74, s67, 28672
    v_and_b32 v100, 15, v0
    v_lshrrev_b32 v101, 4, v0
    v_lshrrev_b32 v102, 2, v100
    v_lshl_add_u32 v102, v101, 2, v102
    v_lshlrev_b32 v102, 7, v102
    v_and_b32 v103, 3, v100
    v_lshl_add_u32 v102, v103, 3, v102
    v_add_u32 v102, s74, v102
    v_and_b32 v101, 1, v101
    v_lshlrev_b32 v101, 1, v101
    v_lshrrev_b32 v103, 3, v100
    v_add_u32 v101, v101, v103
    v_xor_b32 v103, 0, v101
    v_lshl_add_u32 v2, v103, 5, v102
    v_xor_b32 v103, 1, v101
    v_lshl_add_u32 v3, v103, 5, v102
    v_xor_b32 v103, 2, v101
    v_lshl_add_u32 v4, v103, 5, v102
    v_xor_b32 v103, 3, v101
    v_lshl_add_u32 v7, v103, 5, v102
    s_mov_b32 s40, s24
    s_mov_b32 s41, s25
    s_mov_b32 s42, 0x1c0000
    s_mov_b32 s43, 0x20000
    v_lshrrev_b32 v97, 3, v0
    s_lshl_b32 s75, s3, 3
    v_add_u32 v97, s75, v97
    v_and_b32 v98, 7, v0
    v_mul_u32_u24 v96, 896, v97
    v_lshl_add_u32 v96, v98, 4, v96
    s_mul_i32 s80, s7, 57344
    s_lshl_b32 s75, s30, 7
    s_add_u32 s80, s80, s75
    buffer_load_dwordx4 v[92:95], v96, s[32:35], s80 offen
    v_mul_u32_u24 v97, 272, v97
    v_lshl_add_u32 v97, v98, 5, v97
    s_barrier
    s_add_u32 s76, s70, 3584
    s_add_u32 s77, s71, 3584
    s_add_u32 s78, s72, 3584
    s_add_u32 s79, s73, 3584
    buffer_load_dwordx4 v[8:11], v5, s[44:47], s70 offen offset:0
    buffer_load_dwordx4 v[12:15], v5, s[44:47], s71 offen offset:0
    buffer_load_dwordx4 v[16:19], v5, s[44:47], s72 offen offset:0
    buffer_load_dwordx4 v[20:23], v5, s[44:47], s73 offen offset:0
    buffer_load_dwordx4 v[24:27], v5, s[44:47], s70 offen offset:1024
    buffer_load_dwordx4 v[28:31], v5, s[44:47], s71 offen offset:1024
    buffer_load_dwordx4 v[32:35], v5, s[44:47], s72 offen offset:1024
    buffer_load_dwordx4 v[36:39], v5, s[44:47], s73 offen offset:1024
    buffer_load_dwordx4 v[40:43], v5, s[44:47], s70 offen offset:2048
    buffer_load_dwordx4 v[44:47], v5, s[44:47], s71 offen offset:2048
    buffer_load_dwordx4 v[48:51], v5, s[44:47], s72 offen offset:2048
    buffer_load_dwordx4 v[52:55], v5, s[44:47], s73 offen offset:2048
    buffer_load_dwordx4 v[56:59], v5, s[44:47], s76 offen offset:0
    buffer_load_dwordx4 v[60:63], v5, s[44:47], s77 offen offset:0
    buffer_load_dwordx4 v[64:67], v5, s[44:47], s78 offen offset:0
    buffer_load_dwordx4 v[68:71], v5, s[44:47], s79 offen offset:0
    buffer_load_dwordx4 v[72:75], v5, s[44:47], s76 offen offset:1024
    buffer_load_dwordx4 v[76:79], v5, s[44:47], s77 offen offset:1024
    buffer_load_dwordx4 v[80:83], v5, s[44:47], s78 offen offset:1024
    buffer_load_dwordx4 v[84:87], v5, s[44:47], s79 offen offset:1024
    buffer_load_dwordx4 v[88:91], v5, s[44:47], s76 offen offset:2048
    ds_read_b64_tr_b16 v[100:101], v2 offset:0
    ds_read_b64_tr_b16 v[102:103], v2 offset:2048
    ds_read_b64_tr_b16 v[104:105], v3 offset:0
    ds_read_b64_tr_b16 v[106:107], v3 offset:2048
    ds_read_b64_tr_b16 v[108:109], v4 offset:0
    ds_read_b64_tr_b16 v[110:111], v4 offset:2048
    ds_read_b64_tr_b16 v[112:113], v7 offset:0
    ds_read_b64_tr_b16 v[114:115], v7 offset:2048
    s_waitcnt lgkmcnt(0)
    s_waitcnt vmcnt(20)
    v_mfma_f32_16x16x32_bf16 v[132:135], v[100:103], v[8:11], v[132:135]
    ds_read_b64_tr_b16 v[116:117], v2 offset:4096
    v_mfma_f32_16x16x32_bf16 v[140:143], v[104:107], v[8:11], v[140:143]
    ds_read_b64_tr_b16 v[118:119], v2 offset:6144
    v_mfma_f32_16x16x32_bf16 v[148:151], v[108:111], v[8:11], v[148:151]
    ds_read_b64_tr_b16 v[120:121], v3 offset:4096
    v_mfma_f32_16x16x32_bf16 v[156:159], v[112:115], v[8:11], v[156:159]
    ds_read_b64_tr_b16 v[122:123], v3 offset:6144
    s_waitcnt vmcnt(19)
    v_mfma_f32_16x16x32_bf16 v[136:139], v[100:103], v[12:15], v[136:139]
    ds_read_b64_tr_b16 v[124:125], v4 offset:4096
    v_mfma_f32_16x16x32_bf16 v[144:147], v[104:107], v[12:15], v[144:147]
    ds_read_b64_tr_b16 v[126:127], v4 offset:6144
    v_mfma_f32_16x16x32_bf16 v[152:155], v[108:111], v[12:15], v[152:155]
    ds_read_b64_tr_b16 v[128:129], v7 offset:4096
    v_mfma_f32_16x16x32_bf16 v[160:163], v[112:115], v[12:15], v[160:163]
    ds_read_b64_tr_b16 v[130:131], v7 offset:6144
    s_waitcnt vmcnt(18)
    v_mfma_f32_16x16x32_bf16 v[132:135], v[100:103], v[16:19], v[132:135]
    v_mfma_f32_16x16x32_bf16 v[140:143], v[104:107], v[16:19], v[140:143]
    v_mfma_f32_16x16x32_bf16 v[148:151], v[108:111], v[16:19], v[148:151]
    v_mfma_f32_16x16x32_bf16 v[156:159], v[112:115], v[16:19], v[156:159]
    s_waitcnt vmcnt(17)
    v_mfma_f32_16x16x32_bf16 v[136:139], v[100:103], v[20:23], v[136:139]
    v_mfma_f32_16x16x32_bf16 v[144:147], v[104:107], v[20:23], v[144:147]
    v_mfma_f32_16x16x32_bf16 v[152:155], v[108:111], v[20:23], v[152:155]
    v_mfma_f32_16x16x32_bf16 v[160:163], v[112:115], v[20:23], v[160:163]
    buffer_load_dwordx4 v[8:11], v5, s[44:47], s77 offen offset:2048
    buffer_load_dwordx4 v[12:15], v5, s[44:47], s78 offen offset:2048
    buffer_load_dwordx4 v[16:19], v5, s[44:47], s79 offen offset:2048
    buffer_load_dwordx2 v[20:21], v6, s[44:47], s70 offen offset:3072
    buffer_load_dwordx2 v[22:23], v6, s[44:47], s76 offen offset:3072
    s_waitcnt lgkmcnt(0)
    s_waitcnt vmcnt(21)
    v_mfma_f32_16x16x32_bf16 v[132:135], v[116:119], v[24:27], v[132:135]
    ds_read_b64_tr_b16 v[100:101], v2 offset:8192
    v_mfma_f32_16x16x32_bf16 v[140:143], v[120:123], v[24:27], v[140:143]
    ds_read_b64_tr_b16 v[102:103], v2 offset:10240
    v_mfma_f32_16x16x32_bf16 v[148:151], v[124:127], v[24:27], v[148:151]
    ds_read_b64_tr_b16 v[104:105], v3 offset:8192
    v_mfma_f32_16x16x32_bf16 v[156:159], v[128:131], v[24:27], v[156:159]
    ds_read_b64_tr_b16 v[106:107], v3 offset:10240
    s_waitcnt vmcnt(20)
    v_mfma_f32_16x16x32_bf16 v[136:139], v[116:119], v[28:31], v[136:139]
    ds_read_b64_tr_b16 v[108:109], v4 offset:8192
    v_mfma_f32_16x16x32_bf16 v[144:147], v[120:123], v[28:31], v[144:147]
    ds_read_b64_tr_b16 v[110:111], v4 offset:10240
    v_mfma_f32_16x16x32_bf16 v[152:155], v[124:127], v[28:31], v[152:155]
    ds_read_b64_tr_b16 v[112:113], v7 offset:8192
    v_mfma_f32_16x16x32_bf16 v[160:163], v[128:131], v[28:31], v[160:163]
    ds_read_b64_tr_b16 v[114:115], v7 offset:10240
    s_waitcnt vmcnt(19)
    v_mfma_f32_16x16x32_bf16 v[132:135], v[116:119], v[32:35], v[132:135]
    v_mfma_f32_16x16x32_bf16 v[140:143], v[120:123], v[32:35], v[140:143]
    v_mfma_f32_16x16x32_bf16 v[148:151], v[124:127], v[32:35], v[148:151]
    v_mfma_f32_16x16x32_bf16 v[156:159], v[128:131], v[32:35], v[156:159]
    s_waitcnt vmcnt(18)
    v_mfma_f32_16x16x32_bf16 v[136:139], v[116:119], v[36:39], v[136:139]
    v_mfma_f32_16x16x32_bf16 v[144:147], v[120:123], v[36:39], v[144:147]
    v_mfma_f32_16x16x32_bf16 v[152:155], v[124:127], v[36:39], v[152:155]
    v_mfma_f32_16x16x32_bf16 v[160:163], v[128:131], v[36:39], v[160:163]
    buffer_load_dwordx2 v[24:25], v6, s[44:47], s71 offen offset:3072
    buffer_load_dwordx2 v[26:27], v6, s[44:47], s77 offen offset:3072
    buffer_load_dwordx2 v[28:29], v6, s[44:47], s72 offen offset:3072
    buffer_load_dwordx2 v[30:31], v6, s[44:47], s78 offen offset:3072
    buffer_load_dwordx2 v[32:33], v6, s[44:47], s73 offen offset:3072
    buffer_load_dwordx2 v[34:35], v6, s[44:47], s79 offen offset:3072
    s_waitcnt lgkmcnt(0)
    s_waitcnt vmcnt(23)
    v_mfma_f32_16x16x32_bf16 v[132:135], v[100:103], v[40:43], v[132:135]
    ds_read_b64_tr_b16 v[116:117], v2 offset:14336
    v_mfma_f32_16x16x32_bf16 v[140:143], v[104:107], v[40:43], v[140:143]
    ds_read_b64_tr_b16 v[118:119], v2 offset:16384
    v_mfma_f32_16x16x32_bf16 v[148:151], v[108:111], v[40:43], v[148:151]
    ds_read_b64_tr_b16 v[120:121], v3 offset:14336
    v_mfma_f32_16x16x32_bf16 v[156:159], v[112:115], v[40:43], v[156:159]
    ds_read_b64_tr_b16 v[122:123], v3 offset:16384
    s_waitcnt vmcnt(22)
    v_mfma_f32_16x16x32_bf16 v[136:139], v[100:103], v[44:47], v[136:139]
    ds_read_b64_tr_b16 v[124:125], v4 offset:14336
    v_mfma_f32_16x16x32_bf16 v[144:147], v[104:107], v[44:47], v[144:147]
    ds_read_b64_tr_b16 v[126:127], v4 offset:16384
    v_mfma_f32_16x16x32_bf16 v[152:155], v[108:111], v[44:47], v[152:155]
    ds_read_b64_tr_b16 v[128:129], v7 offset:14336
    v_mfma_f32_16x16x32_bf16 v[160:163], v[112:115], v[44:47], v[160:163]
    ds_read_b64_tr_b16 v[130:131], v7 offset:16384
    s_waitcnt vmcnt(21)
    v_mfma_f32_16x16x32_bf16 v[132:135], v[100:103], v[48:51], v[132:135]
    v_mfma_f32_16x16x32_bf16 v[140:143], v[104:107], v[48:51], v[140:143]
    v_mfma_f32_16x16x32_bf16 v[148:151], v[108:111], v[48:51], v[148:151]
    v_mfma_f32_16x16x32_bf16 v[156:159], v[112:115], v[48:51], v[156:159]
    s_waitcnt vmcnt(20)
    v_mfma_f32_16x16x32_bf16 v[136:139], v[100:103], v[52:55], v[136:139]
    v_mfma_f32_16x16x32_bf16 v[144:147], v[104:107], v[52:55], v[144:147]
    v_mfma_f32_16x16x32_bf16 v[152:155], v[108:111], v[52:55], v[152:155]
    v_mfma_f32_16x16x32_bf16 v[160:163], v[112:115], v[52:55], v[160:163]
    s_waitcnt lgkmcnt(0)
    s_waitcnt vmcnt(19)
    v_mfma_f32_16x16x32_bf16 v[132:135], v[116:119], v[56:59], v[132:135]
    ds_read_b64_tr_b16 v[100:101], v2 offset:18432
    v_mfma_f32_16x16x32_bf16 v[140:143], v[120:123], v[56:59], v[140:143]
    ds_read_b64_tr_b16 v[102:103], v2 offset:20480
    v_mfma_f32_16x16x32_bf16 v[148:151], v[124:127], v[56:59], v[148:151]
    ds_read_b64_tr_b16 v[104:105], v3 offset:18432
    v_mfma_f32_16x16x32_bf16 v[156:159], v[128:131], v[56:59], v[156:159]
    ds_read_b64_tr_b16 v[106:107], v3 offset:20480
    s_waitcnt vmcnt(18)
    v_mfma_f32_16x16x32_bf16 v[136:139], v[116:119], v[60:63], v[136:139]
    ds_read_b64_tr_b16 v[108:109], v4 offset:18432
    v_mfma_f32_16x16x32_bf16 v[144:147], v[120:123], v[60:63], v[144:147]
    ds_read_b64_tr_b16 v[110:111], v4 offset:20480
    v_mfma_f32_16x16x32_bf16 v[152:155], v[124:127], v[60:63], v[152:155]
    ds_read_b64_tr_b16 v[112:113], v7 offset:18432
    v_mfma_f32_16x16x32_bf16 v[160:163], v[128:131], v[60:63], v[160:163]
    ds_read_b64_tr_b16 v[114:115], v7 offset:20480
    s_waitcnt vmcnt(17)
    v_mfma_f32_16x16x32_bf16 v[132:135], v[116:119], v[64:67], v[132:135]
    v_mfma_f32_16x16x32_bf16 v[140:143], v[120:123], v[64:67], v[140:143]
    v_mfma_f32_16x16x32_bf16 v[148:151], v[124:127], v[64:67], v[148:151]
    v_mfma_f32_16x16x32_bf16 v[156:159], v[128:131], v[64:67], v[156:159]
    s_waitcnt vmcnt(16)
    v_mfma_f32_16x16x32_bf16 v[136:139], v[116:119], v[68:71], v[136:139]
    v_mfma_f32_16x16x32_bf16 v[144:147], v[120:123], v[68:71], v[144:147]
    v_mfma_f32_16x16x32_bf16 v[152:155], v[124:127], v[68:71], v[152:155]
    v_mfma_f32_16x16x32_bf16 v[160:163], v[128:131], v[68:71], v[160:163]
    s_waitcnt lgkmcnt(0)
    s_waitcnt vmcnt(15)
    v_mfma_f32_16x16x32_bf16 v[132:135], v[100:103], v[72:75], v[132:135]
    ds_read_b64_tr_b16 v[116:117], v2 offset:22528
    v_mfma_f32_16x16x32_bf16 v[140:143], v[104:107], v[72:75], v[140:143]
    ds_read_b64_tr_b16 v[118:119], v2 offset:24576
    v_mfma_f32_16x16x32_bf16 v[148:151], v[108:111], v[72:75], v[148:151]
    ds_read_b64_tr_b16 v[120:121], v3 offset:22528
    v_mfma_f32_16x16x32_bf16 v[156:159], v[112:115], v[72:75], v[156:159]
    ds_read_b64_tr_b16 v[122:123], v3 offset:24576
    s_waitcnt vmcnt(14)
    v_mfma_f32_16x16x32_bf16 v[136:139], v[100:103], v[76:79], v[136:139]
    ds_read_b64_tr_b16 v[124:125], v4 offset:22528
    v_mfma_f32_16x16x32_bf16 v[144:147], v[104:107], v[76:79], v[144:147]
    ds_read_b64_tr_b16 v[126:127], v4 offset:24576
    v_mfma_f32_16x16x32_bf16 v[152:155], v[108:111], v[76:79], v[152:155]
    ds_read_b64_tr_b16 v[128:129], v7 offset:22528
    v_mfma_f32_16x16x32_bf16 v[160:163], v[112:115], v[76:79], v[160:163]
    ds_read_b64_tr_b16 v[130:131], v7 offset:24576
    s_waitcnt vmcnt(13)
    v_mfma_f32_16x16x32_bf16 v[132:135], v[100:103], v[80:83], v[132:135]
    v_mfma_f32_16x16x32_bf16 v[140:143], v[104:107], v[80:83], v[140:143]
    v_mfma_f32_16x16x32_bf16 v[148:151], v[108:111], v[80:83], v[148:151]
    v_mfma_f32_16x16x32_bf16 v[156:159], v[112:115], v[80:83], v[156:159]
    s_waitcnt vmcnt(12)
    v_mfma_f32_16x16x32_bf16 v[136:139], v[100:103], v[84:87], v[136:139]
    v_mfma_f32_16x16x32_bf16 v[144:147], v[104:107], v[84:87], v[144:147]
    v_mfma_f32_16x16x32_bf16 v[152:155], v[108:111], v[84:87], v[152:155]
    v_mfma_f32_16x16x32_bf16 v[160:163], v[112:115], v[84:87], v[160:163]
    s_waitcnt lgkmcnt(0)
    s_waitcnt vmcnt(11)
    v_mfma_f32_16x16x32_bf16 v[132:135], v[116:119], v[88:91], v[132:135]
    ds_read_b64_tr_b16 v[100:101], v2 offset:12288
    v_mfma_f32_16x16x32_bf16 v[140:143], v[120:123], v[88:91], v[140:143]
    ds_read_b64_tr_b16 v[102:103], v2 offset:26624
    v_mfma_f32_16x16x32_bf16 v[148:151], v[124:127], v[88:91], v[148:151]
    ds_read_b64_tr_b16 v[104:105], v3 offset:12288
    v_mfma_f32_16x16x32_bf16 v[156:159], v[128:131], v[88:91], v[156:159]
    ds_read_b64_tr_b16 v[106:107], v3 offset:26624
    s_waitcnt vmcnt(10)
    v_mfma_f32_16x16x32_bf16 v[136:139], v[116:119], v[8:11], v[136:139]
    ds_read_b64_tr_b16 v[108:109], v4 offset:12288
    v_mfma_f32_16x16x32_bf16 v[144:147], v[120:123], v[8:11], v[144:147]
    ds_read_b64_tr_b16 v[110:111], v4 offset:26624
    v_mfma_f32_16x16x32_bf16 v[152:155], v[124:127], v[8:11], v[152:155]
    ds_read_b64_tr_b16 v[112:113], v7 offset:12288
    v_mfma_f32_16x16x32_bf16 v[160:163], v[128:131], v[8:11], v[160:163]
    ds_read_b64_tr_b16 v[114:115], v7 offset:26624
    s_waitcnt vmcnt(9)
    v_mfma_f32_16x16x32_bf16 v[132:135], v[116:119], v[12:15], v[132:135]
    v_mfma_f32_16x16x32_bf16 v[140:143], v[120:123], v[12:15], v[140:143]
    v_mfma_f32_16x16x32_bf16 v[148:151], v[124:127], v[12:15], v[148:151]
    v_mfma_f32_16x16x32_bf16 v[156:159], v[128:131], v[12:15], v[156:159]
    s_waitcnt vmcnt(8)
    v_mfma_f32_16x16x32_bf16 v[136:139], v[116:119], v[16:19], v[136:139]
    v_mfma_f32_16x16x32_bf16 v[144:147], v[120:123], v[16:19], v[144:147]
    v_mfma_f32_16x16x32_bf16 v[152:155], v[124:127], v[16:19], v[152:155]
    v_mfma_f32_16x16x32_bf16 v[160:163], v[128:131], v[16:19], v[160:163]
    s_waitcnt lgkmcnt(0)
    s_waitcnt vmcnt(6)
    v_mfma_f32_16x16x32_bf16 v[132:135], v[100:103], v[20:23], v[132:135]
    v_mfma_f32_16x16x32_bf16 v[140:143], v[104:107], v[20:23], v[140:143]
    v_mfma_f32_16x16x32_bf16 v[148:151], v[108:111], v[20:23], v[148:151]
    v_mfma_f32_16x16x32_bf16 v[156:159], v[112:115], v[20:23], v[156:159]
    s_waitcnt vmcnt(4)
    v_mfma_f32_16x16x32_bf16 v[136:139], v[100:103], v[24:27], v[136:139]
    v_mfma_f32_16x16x32_bf16 v[144:147], v[104:107], v[24:27], v[144:147]
    v_mfma_f32_16x16x32_bf16 v[152:155], v[108:111], v[24:27], v[152:155]
    v_mfma_f32_16x16x32_bf16 v[160:163], v[112:115], v[24:27], v[160:163]
    s_waitcnt vmcnt(2)
    v_mfma_f32_16x16x32_bf16 v[132:135], v[100:103], v[28:31], v[132:135]
    v_mfma_f32_16x16x32_bf16 v[140:143], v[104:107], v[28:31], v[140:143]
    v_mfma_f32_16x16x32_bf16 v[148:151], v[108:111], v[28:31], v[148:151]
    v_mfma_f32_16x16x32_bf16 v[156:159], v[112:115], v[28:31], v[156:159]
    s_waitcnt vmcnt(0)
    v_mfma_f32_16x16x32_bf16 v[136:139], v[100:103], v[32:35], v[136:139]
    v_mfma_f32_16x16x32_bf16 v[144:147], v[104:107], v[32:35], v[144:147]
    v_mfma_f32_16x16x32_bf16 v[152:155], v[108:111], v[32:35], v[152:155]
    v_mfma_f32_16x16x32_bf16 v[160:163], v[112:115], v[32:35], v[160:163]
    v_and_b32 v20, 15, v0
    v_lshrrev_b32 v21, 4, v0
    v_mul_u32_u24 v20, 272, v20
    v_lshl_add_u32 v20, v21, 4, v20
    s_mul_i32 s76, s66, 8704
    s_mul_i32 s77, s67, 17408
    s_add_u32 s76, s76, s77
    v_add_u32 v20, s76, v20
    s_waitcnt lgkmcnt(0)
    s_barrier
    ds_write_b128 v20, v[132:135] offset:0
    ds_write_b128 v20, v[140:143] offset:64
    ds_write_b128 v20, v[148:151] offset:128
    ds_write_b128 v20, v[156:159] offset:192
    ds_write_b128 v20, v[136:139] offset:4352
    ds_write_b128 v20, v[144:147] offset:4416
    ds_write_b128 v20, v[152:155] offset:4480
    ds_write_b128 v20, v[160:163] offset:4544
    s_waitcnt lgkmcnt(0)
    s_barrier
    ds_read_b128 v[32:35], v97 offset:0
    ds_read_b128 v[36:39], v97 offset:16
    ds_read_b128 v[40:43], v97 offset:17408
    ds_read_b128 v[44:47], v97 offset:17424
    ds_read_b128 v[48:51], v97 offset:34816
    ds_read_b128 v[52:55], v97 offset:34832
    ds_read_b128 v[56:59], v97 offset:52224
    ds_read_b128 v[60:63], v97 offset:52240
    v_lshlrev_b32 v24, 16, v92
    v_and_b32 v25, 0xffff0000, v92
    v_lshlrev_b32 v26, 16, v93
    v_and_b32 v27, 0xffff0000, v93
    v_lshlrev_b32 v28, 16, v94
    v_and_b32 v29, 0xffff0000, v94
    v_lshlrev_b32 v30, 16, v95
    v_and_b32 v31, 0xffff0000, v95
    s_waitcnt lgkmcnt(0)
    v_pk_add_f32 v[32:33], v[32:33], v[40:41]
    v_pk_add_f32 v[48:49], v[48:49], v[56:57]
    v_pk_add_f32 v[34:35], v[34:35], v[42:43]
    v_pk_add_f32 v[50:51], v[50:51], v[58:59]
    v_pk_add_f32 v[36:37], v[36:37], v[44:45]
    v_pk_add_f32 v[52:53], v[52:53], v[60:61]
    v_pk_add_f32 v[38:39], v[38:39], v[46:47]
    v_pk_add_f32 v[54:55], v[54:55], v[62:63]
    v_pk_add_f32 v[32:33], v[32:33], v[48:49]
    v_pk_add_f32 v[34:35], v[34:35], v[50:51]
    v_pk_add_f32 v[36:37], v[36:37], v[52:53]
    v_pk_add_f32 v[38:39], v[38:39], v[54:55]
    v_pk_add_f32 v[32:33], v[32:33], v[24:25]
    v_pk_add_f32 v[34:35], v[34:35], v[26:27]
    v_pk_add_f32 v[36:37], v[36:37], v[28:29]
    v_pk_add_f32 v[38:39], v[38:39], v[30:31]
    v_cvt_pk_bf16_f32 v32, v32, v33
    v_cvt_pk_bf16_f32 v33, v34, v35
    v_cvt_pk_bf16_f32 v34, v36, v37
    v_cvt_pk_bf16_f32 v35, v38, v39
    buffer_store_dwordx4 v[32:35], v96, s[40:43], s80 offen
p3c_skip:
    s_endpgm
f_load:
    s_cmp_ge_u32 s53, 8
    s_cbranch_scc1 f_lB
    s_cmp_lg_u32 s3, 8
    s_cbranch_scc1 f_lA1
    s_mul_i32 s68, s54, 112
    v_lshrrev_b32 v20, 4, v0
    v_add_u32 v20, 0, v20
    v_and_b32 v21, 7, v0
    v_xor_b32 v20, v20, v21
    v_and_b32 v20, 7, v20
    v_lshlrev_b32 v20, 4, v20
    v_lshrrev_b32 v21, 3, v0
    s_lshl_b32 s72, s52, 7
    s_add_u32 s72, s72, 0
    v_add_u32 v21, s72, v21
    v_mul_u32_u24 v9, 896, v21
    v_add_u32 v9, v9, v20
    v_subrev_u32 v21, 16, v21
    v_max_i32 v21, 0, v21
    v_mul_u32_u24 v8, 896, v21
    v_add_u32 v8, v8, v20
    v_add_u32 v20, 0, v0
    v_mul_u32_u24 v21, 2731, v20
    v_lshrrev_b32 v21, 16, v21
    v_mul_u32_u24 v22, 24, v21
    v_sub_u32 v22, v20, v22
    v_and_b32 v23, 3, v21
    v_lshrrev_b32 v20, 2, v21
    v_lshl_add_u32 v23, v20, 3, v23
    v_mul_u32_u24 v10, 2688, v23
    v_bfe_u32 v23, v21, 1, 2
    v_lshrrev_b32 v20, 1, v22
    v_xor_b32 v20, v20, v23
    v_lshrrev_b32 v23, 2, v20
    v_mul_u32_u24 v23, 896, v23
    v_add_u32 v10, v10, v23
    v_bfe_u32 v23, v20, 1, 1
    v_mul_u32_u24 v23, 56, v23
    v_add_u32 v10, v10, v23
    v_and_b32 v20, 1, v20
    v_lshl_add_u32 v10, v20, 5, v10
    v_and_b32 v22, 1, v22
    v_lshl_add_u32 v10, v22, 4, v10
    v_add_u32 v10, s68, v10
    s_waitcnt lgkmcnt(0)
    s_mov_b32 s32, s8
    s_mov_b32 s33, s9
    s_mov_b32 s34, 0x1c0000
    s_mov_b32 s35, 0x20000
    s_mov_b32 s36, s10
    s_mov_b32 s37, s11
    s_mov_b32 s38, 0x126000
    s_mov_b32 s39, 0x20000
    s_mov_b32 s44, s28
    s_mov_b32 s45, s29
    s_mov_b32 s46, 0x1600000
    s_mov_b32 s47, 0x20000
    s_mov_b32 m0, 0
    s_mov_b32 s73, 0
    buffer_load_dwordx4 v8, s[32:35], s73 offen lds
    s_mov_b32 m0, 2048
    s_mov_b32 s73, 0
    buffer_load_dwordx4 v9, s[32:35], s73 offen lds
    s_mov_b32 m0, 4096
    s_mov_b32 s73, 14336
    buffer_load_dwordx4 v9, s[32:35], s73 offen lds
    s_mov_b32 m0, 6144
    s_mov_b32 s73, 28672
    buffer_load_dwordx4 v9, s[32:35], s73 offen lds
    s_mov_b32 m0, 8192
    s_mov_b32 s73, 43008
    buffer_load_dwordx4 v9, s[32:35], s73 offen lds
    s_mov_b32 m0, 10240
    s_mov_b32 s73, 57344
    buffer_load_dwordx4 v9, s[32:35], s73 offen lds
    s_mov_b32 m0, 12288
    s_mov_b32 s73, 71680
    buffer_load_dwordx4 v9, s[32:35], s73 offen lds
    s_mov_b32 m0, 14336
    s_mov_b32 s73, 86016
    buffer_load_dwordx4 v9, s[32:35], s73 offen lds
    s_mov_b32 m0, 16384
    s_mov_b32 s73, 100352
    buffer_load_dwordx4 v9, s[32:35], s73 offen lds
    s_mov_b32 m0, 55296
    s_mov_b32 s73, 0
    buffer_load_dwordx4 v10, s[36:39], s73 offen lds
    s_mov_b32 m0, 61440
    s_mov_b32 s73, 10752
    buffer_load_dwordx4 v10, s[36:39], s73 offen lds
    s_mov_b32 m0, 18432
    s_mov_b32 s73, 128
    buffer_load_dwordx4 v8, s[32:35], s73 offen lds
    s_mov_b32 m0, 20480
    s_mov_b32 s73, 128
    buffer_load_dwordx4 v9, s[32:35], s73 offen lds
    s_mov_b32 m0, 22528
    s_mov_b32 s73, 14464
    buffer_load_dwordx4 v9, s[32:35], s73 offen lds
    s_mov_b32 m0, 24576
    s_mov_b32 s73, 28800
    buffer_load_dwordx4 v9, s[32:35], s73 offen lds
    s_mov_b32 m0, 26624
    s_mov_b32 s73, 43136
    buffer_load_dwordx4 v9, s[32:35], s73 offen lds
    s_mov_b32 m0, 28672
    s_mov_b32 s73, 57472
    buffer_load_dwordx4 v9, s[32:35], s73 offen lds
    s_mov_b32 m0, 30720
    s_mov_b32 s73, 71808
    buffer_load_dwordx4 v9, s[32:35], s73 offen lds
    s_mov_b32 m0, 32768
    s_mov_b32 s73, 86144
    buffer_load_dwordx4 v9, s[32:35], s73 offen lds
    s_mov_b32 m0, 34816
    s_mov_b32 s73, 100480
    buffer_load_dwordx4 v9, s[32:35], s73 offen lds
    s_mov_b32 m0, 79872
    s_mov_b32 s73, 172032
    buffer_load_dwordx4 v10, s[36:39], s73 offen lds
    s_mov_b32 m0, 86016
    s_mov_b32 s73, 182784
    buffer_load_dwordx4 v10, s[36:39], s73 offen lds
    s_waitcnt vmcnt(11)
    s_barrier
    s_mov_b32 m0, 36864
    s_mov_b32 s73, 256
    buffer_load_dwordx4 v8, s[32:35], s73 offen lds
    s_mov_b32 m0, 38912
    s_mov_b32 s73, 256
    buffer_load_dwordx4 v9, s[32:35], s73 offen lds
    s_mov_b32 m0, 40960
    s_mov_b32 s73, 14592
    buffer_load_dwordx4 v9, s[32:35], s73 offen lds
    s_mov_b32 m0, 43008
    s_mov_b32 s73, 28928
    buffer_load_dwordx4 v9, s[32:35], s73 offen lds
    s_mov_b32 m0, 45056
    s_mov_b32 s73, 43264
    buffer_load_dwordx4 v9, s[32:35], s73 offen lds
    s_mov_b32 m0, 47104
    s_mov_b32 s73, 57600
    buffer_load_dwordx4 v9, s[32:35], s73 offen lds
    s_mov_b32 m0, 49152
    s_mov_b32 s73, 71936
    buffer_load_dwordx4 v9, s[32:35], s73 offen lds
    s_mov_b32 m0, 51200
    s_mov_b32 s73, 86272
    buffer_load_dwordx4 v9, s[32:35], s73 offen lds
    s_mov_b32 m0, 53248
    s_mov_b32 s73, 100608
    buffer_load_dwordx4 v9, s[32:35], s73 offen lds
    s_mov_b32 m0, 104448
    s_mov_b32 s73, 344064
    buffer_load_dwordx4 v10, s[36:39], s73 offen lds
    s_mov_b32 m0, 110592
    s_mov_b32 s73, 354816
    buffer_load_dwordx4 v10, s[36:39], s73 offen lds
    s_mov_b32 s55, 40000
    s_waitcnt vmcnt(11)
    s_barrier
    v_mov_b32 v24, 155648
    ds_read_b64 v[26:27], v24
    s_waitcnt lgkmcnt(0)
    v_readfirstlane_b32 s60, v26
    v_readfirstlane_b32 s61, v27
    s_mov_b32 m0, 0
    s_mov_b32 s73, 384
    buffer_load_dwordx4 v8, s[32:35], s73 offen lds
    s_mov_b32 m0, 2048
    s_mov_b32 s73, 384
    buffer_load_dwordx4 v9, s[32:35], s73 offen lds
    s_mov_b32 m0, 4096
    s_mov_b32 s73, 14720
    buffer_load_dwordx4 v9, s[32:35], s73 offen lds
    s_mov_b32 m0, 6144
    s_mov_b32 s73, 29056
    buffer_load_dwordx4 v9, s[32:35], s73 offen lds
    s_mov_b32 m0, 8192
    s_mov_b32 s73, 43392
    buffer_load_dwordx4 v9, s[32:35], s73 offen lds
    s_mov_b32 m0, 10240
    s_mov_b32 s73, 57728
    buffer_load_dwordx4 v9, s[32:35], s73 offen lds
    s_mov_b32 m0, 12288
    s_mov_b32 s73, 72064
    buffer_load_dwordx4 v9, s[32:35], s73 offen lds
    s_mov_b32 m0, 14336
    s_mov_b32 s73, 86400
    buffer_load_dwordx4 v9, s[32:35], s73 offen lds
    s_mov_b32 m0, 16384
    s_mov_b32 s73, 100736
    buffer_load_dwordx4 v9, s[32:35], s73 offen lds
    s_mov_b32 m0, 55296
    s_mov_b32 s73, 516096
    buffer_load_dwordx4 v10, s[36:39], s73 offen lds
    s_mov_b32 m0, 61440
    s_mov_b32 s73, 526848
    buffer_load_dwordx4 v10, s[36:39], s73 offen lds
    s_waitcnt vmcnt(11)
    s_barrier
    s_mov_b32 m0, 18432
    s_mov_b32 s73, 512
    buffer_load_dwordx4 v8, s[32:35], s73 offen lds
    s_mov_b32 m0, 20480
    s_mov_b32 s73, 512
    buffer_load_dwordx4 v9, s[32:35], s73 offen lds
    s_mov_b32 m0, 22528
    s_mov_b32 s73, 14848
    buffer_load_dwordx4 v9, s[32:35], s73 offen lds
    s_mov_b32 m0, 24576
    s_mov_b32 s73, 29184
    buffer_load_dwordx4 v9, s[32:35], s73 offen lds
    s_mov_b32 m0, 26624
    s_mov_b32 s73, 43520
    buffer_load_dwordx4 v9, s[32:35], s73 offen lds
    s_mov_b32 m0, 28672
    s_mov_b32 s73, 57856
    buffer_load_dwordx4 v9, s[32:35], s73 offen lds
    s_mov_b32 m0, 30720
    s_mov_b32 s73, 72192
    buffer_load_dwordx4 v9, s[32:35], s73 offen lds
    s_mov_b32 m0, 32768
    s_mov_b32 s73, 86528
    buffer_load_dwordx4 v9, s[32:35], s73 offen lds
    s_mov_b32 m0, 34816
    s_mov_b32 s73, 100864
    buffer_load_dwordx4 v9, s[32:35], s73 offen lds
    s_mov_b32 m0, 79872
    s_mov_b32 s73, 688128
    buffer_load_dwordx4 v10, s[36:39], s73 offen lds
    s_mov_b32 m0, 86016
    s_mov_b32 s73, 698880
    buffer_load_dwordx4 v10, s[36:39], s73 offen lds
    s_waitcnt vmcnt(11)
    s_barrier
    s_mov_b32 m0, 36864
    s_mov_b32 s73, 640
    buffer_load_dwordx4 v8, s[32:35], s73 offen lds
    s_mov_b32 m0, 38912
    s_mov_b32 s73, 640
    buffer_load_dwordx4 v9, s[32:35], s73 offen lds
    s_mov_b32 m0, 40960
    s_mov_b32 s73, 14976
    buffer_load_dwordx4 v9, s[32:35], s73 offen lds
    s_mov_b32 m0, 43008
    s_mov_b32 s73, 29312
    buffer_load_dwordx4 v9, s[32:35], s73 offen lds
    s_mov_b32 m0, 45056
    s_mov_b32 s73, 43648
    buffer_load_dwordx4 v9, s[32:35], s73 offen lds
    s_mov_b32 m0, 47104
    s_mov_b32 s73, 57984
    buffer_load_dwordx4 v9, s[32:35], s73 offen lds
    s_mov_b32 m0, 49152
    s_mov_b32 s73, 72320
    buffer_load_dwordx4 v9, s[32:35], s73 offen lds
    s_mov_b32 m0, 51200
    s_mov_b32 s73, 86656
    buffer_load_dwordx4 v9, s[32:35], s73 offen lds
    s_mov_b32 m0, 53248
    s_mov_b32 s73, 100992
    buffer_load_dwordx4 v9, s[32:35], s73 offen lds
    s_mov_b32 m0, 104448
    s_mov_b32 s73, 860160
    buffer_load_dwordx4 v10, s[36:39], s73 offen lds
    s_mov_b32 m0, 110592
    s_mov_b32 s73, 870912
    buffer_load_dwordx4 v10, s[36:39], s73 offen lds
    s_waitcnt vmcnt(11)
    s_barrier
    s_lshl_b32 s72, s52, 7
    s_add_u32 s72, s72, 0
    v_add_u32 v24, s72, v0
    v_subrev_u32 v24, 16, v24
    v_max_i32 v24, 0, v24
    v_lshlrev_b32 v24, 4, v24
    buffer_load_dwordx4 v[28:31], v24, s[44:47], 0 offen sc1
    s_mov_b32 m0, 0
    s_mov_b32 s73, 768
    buffer_load_dwordx4 v8, s[32:35], s73 offen lds
    s_mov_b32 m0, 2048
    s_mov_b32 s73, 768
    buffer_load_dwordx4 v9, s[32:35], s73 offen lds
    s_mov_b32 m0, 4096
    s_mov_b32 s73, 15104
    buffer_load_dwordx4 v9, s[32:35], s73 offen lds
    s_mov_b32 m0, 6144
    s_mov_b32 s73, 29440
    buffer_load_dwordx4 v9, s[32:35], s73 offen lds
    s_mov_b32 m0, 8192
    s_mov_b32 s73, 43776
    buffer_load_dwordx4 v9, s[32:35], s73 offen lds
    s_mov_b32 m0, 10240
    s_mov_b32 s73, 58112
    buffer_load_dwordx4 v9, s[32:35], s73 offen lds
    s_mov_b32 m0, 12288
    s_mov_b32 s73, 72448
    buffer_load_dwordx4 v9, s[32:35], s73 offen lds
    s_mov_b32 m0, 14336
    s_mov_b32 s73, 86784
    buffer_load_dwordx4 v9, s[32:35], s73 offen lds
    s_mov_b32 m0, 16384
    s_mov_b32 s73, 101120
    buffer_load_dwordx4 v9, s[32:35], s73 offen lds
    s_mov_b32 m0, 55296
    s_mov_b32 s73, 1032192
    buffer_load_dwordx4 v10, s[36:39], s73 offen lds
    s_mov_b32 m0, 61440
    s_mov_b32 s73, 1042944
    buffer_load_dwordx4 v10, s[36:39], s73 offen lds
    s_waitcnt vmcnt(11)
    v_cmp_eq_u32 vcc, s60, v30
    v_cmp_eq_u32 s[74:75], s61, v31
    s_and_b64 vcc, vcc, s[74:75]
    s_mov_b64 s[76:77], vcc
    s_cmp_eq_u64 s[76:77], -1
    s_cbranch_scc0 p1Al0_retry
p1Al0_tok:
    v_lshlrev_b32 v24, 2, v0
    v_add_u32 v24, 153600, v24
    ds_write_b32 v24, v28
    ds_write_b32 v24, v29 offset:576
    s_waitcnt lgkmcnt(0)
    s_barrier
    s_waitcnt vmcnt(0)
    s_barrier
    s_barrier
    s_branch p1Al0_done
p1Al0_retry:
    s_sub_u32 s55, s55, 1
    s_cmp_eq_u32 s55, 0
    s_cbranch_scc1 p1Al0_tok
    s_lshl_b32 s72, s52, 7
    s_add_u32 s72, s72, 0
    v_add_u32 v24, s72, v0
    v_subrev_u32 v24, 16, v24
    v_max_i32 v24, 0, v24
    v_lshlrev_b32 v24, 4, v24
    buffer_load_dwordx4 v[28:31], v24, s[44:47], 0 offen sc1
    s_waitcnt vmcnt(0)
    v_cmp_eq_u32 vcc, s60, v30
    v_cmp_eq_u32 s[74:75], s61, v31
    s_and_b64 vcc, vcc, s[74:75]
    s_mov_b64 s[76:77], vcc
    s_cmp_eq_u64 s[76:77], -1
    s_cbranch_scc0 p1Al0_retry
    s_branch p1Al0_tok
p1Al0_done:
    s_branch f_lr0
f_lA1:
    s_cmp_lg_u32 s3, 9
    s_cbranch_scc1 f_lA2
    s_mul_i32 s68, s54, 112
    v_lshrrev_b32 v20, 4, v0
    v_add_u32 v20, 4, v20
    v_and_b32 v21, 7, v0
    v_xor_b32 v20, v20, v21
    v_and_b32 v20, 7, v20
    v_lshlrev_b32 v20, 4, v20
    v_lshrrev_b32 v21, 3, v0
    s_lshl_b32 s72, s52, 7
    s_add_u32 s72, s72, 8
    v_add_u32 v21, s72, v21
    v_mul_u32_u24 v9, 896, v21
    v_add_u32 v9, v9, v20
    v_subrev_u32 v21, 16, v21
    v_max_i32 v21, 0, v21
    v_mul_u32_u24 v8, 896, v21
    v_add_u32 v8, v8, v20
    v_add_u32 v20, 64, v0
    v_mul_u32_u24 v21, 2731, v20
    v_lshrrev_b32 v21, 16, v21
    v_mul_u32_u24 v22, 24, v21
    v_sub_u32 v22, v20, v22
    v_and_b32 v23, 3, v21
    v_lshrrev_b32 v20, 2, v21
    v_lshl_add_u32 v23, v20, 3, v23
    v_mul_u32_u24 v10, 2688, v23
    v_bfe_u32 v23, v21, 1, 2
    v_lshrrev_b32 v20, 1, v22
    v_xor_b32 v20, v20, v23
    v_lshrrev_b32 v23, 2, v20
    v_mul_u32_u24 v23, 896, v23
    v_add_u32 v10, v10, v23
    v_bfe_u32 v23, v20, 1, 1
    v_mul_u32_u24 v23, 56, v23
    v_add_u32 v10, v10, v23
    v_and_b32 v20, 1, v20
    v_lshl_add_u32 v10, v20, 5, v10
    v_and_b32 v22, 1, v22
    v_lshl_add_u32 v10, v22, 4, v10
    v_add_u32 v10, s68, v10
    s_waitcnt lgkmcnt(0)
    s_mov_b32 s32, s8
    s_mov_b32 s33, s9
    s_mov_b32 s34, 0x1c0000
    s_mov_b32 s35, 0x20000
    s_mov_b32 s36, s10
    s_mov_b32 s37, s11
    s_mov_b32 s38, 0x126000
    s_mov_b32 s39, 0x20000
    s_mov_b32 s44, s28
    s_mov_b32 s45, s29
    s_mov_b32 s46, 0x1600000
    s_mov_b32 s47, 0x20000
    s_mov_b32 m0, 1024
    s_mov_b32 s73, 0
    buffer_load_dwordx4 v8, s[32:35], s73 offen lds
    s_mov_b32 m0, 3072
    s_mov_b32 s73, 0
    buffer_load_dwordx4 v9, s[32:35], s73 offen lds
    s_mov_b32 m0, 5120
    s_mov_b32 s73, 14336
    buffer_load_dwordx4 v9, s[32:35], s73 offen lds
    s_mov_b32 m0, 7168
    s_mov_b32 s73, 28672
    buffer_load_dwordx4 v9, s[32:35], s73 offen lds
    s_mov_b32 m0, 9216
    s_mov_b32 s73, 43008
    buffer_load_dwordx4 v9, s[32:35], s73 offen lds
    s_mov_b32 m0, 11264
    s_mov_b32 s73, 57344
    buffer_load_dwordx4 v9, s[32:35], s73 offen lds
    s_mov_b32 m0, 13312
    s_mov_b32 s73, 71680
    buffer_load_dwordx4 v9, s[32:35], s73 offen lds
    s_mov_b32 m0, 15360
    s_mov_b32 s73, 86016
    buffer_load_dwordx4 v9, s[32:35], s73 offen lds
    s_mov_b32 m0, 17408
    s_mov_b32 s73, 100352
    buffer_load_dwordx4 v9, s[32:35], s73 offen lds
    s_mov_b32 m0, 56320
    s_mov_b32 s73, 0
    buffer_load_dwordx4 v10, s[36:39], s73 offen lds
    s_mov_b32 m0, 62464
    s_mov_b32 s73, 10752
    buffer_load_dwordx4 v10, s[36:39], s73 offen lds
    s_mov_b32 m0, 19456
    s_mov_b32 s73, 128
    buffer_load_dwordx4 v8, s[32:35], s73 offen lds
    s_mov_b32 m0, 21504
    s_mov_b32 s73, 128
    buffer_load_dwordx4 v9, s[32:35], s73 offen lds
    s_mov_b32 m0, 23552
    s_mov_b32 s73, 14464
    buffer_load_dwordx4 v9, s[32:35], s73 offen lds
    s_mov_b32 m0, 25600
    s_mov_b32 s73, 28800
    buffer_load_dwordx4 v9, s[32:35], s73 offen lds
    s_mov_b32 m0, 27648
    s_mov_b32 s73, 43136
    buffer_load_dwordx4 v9, s[32:35], s73 offen lds
    s_mov_b32 m0, 29696
    s_mov_b32 s73, 57472
    buffer_load_dwordx4 v9, s[32:35], s73 offen lds
    s_mov_b32 m0, 31744
    s_mov_b32 s73, 71808
    buffer_load_dwordx4 v9, s[32:35], s73 offen lds
    s_mov_b32 m0, 33792
    s_mov_b32 s73, 86144
    buffer_load_dwordx4 v9, s[32:35], s73 offen lds
    s_mov_b32 m0, 35840
    s_mov_b32 s73, 100480
    buffer_load_dwordx4 v9, s[32:35], s73 offen lds
    s_mov_b32 m0, 80896
    s_mov_b32 s73, 172032
    buffer_load_dwordx4 v10, s[36:39], s73 offen lds
    s_mov_b32 m0, 87040
    s_mov_b32 s73, 182784
    buffer_load_dwordx4 v10, s[36:39], s73 offen lds
    s_waitcnt vmcnt(11)
    s_barrier
    s_mov_b32 m0, 37888
    s_mov_b32 s73, 256
    buffer_load_dwordx4 v8, s[32:35], s73 offen lds
    s_mov_b32 m0, 39936
    s_mov_b32 s73, 256
    buffer_load_dwordx4 v9, s[32:35], s73 offen lds
    s_mov_b32 m0, 41984
    s_mov_b32 s73, 14592
    buffer_load_dwordx4 v9, s[32:35], s73 offen lds
    s_mov_b32 m0, 44032
    s_mov_b32 s73, 28928
    buffer_load_dwordx4 v9, s[32:35], s73 offen lds
    s_mov_b32 m0, 46080
    s_mov_b32 s73, 43264
    buffer_load_dwordx4 v9, s[32:35], s73 offen lds
    s_mov_b32 m0, 48128
    s_mov_b32 s73, 57600
    buffer_load_dwordx4 v9, s[32:35], s73 offen lds
    s_mov_b32 m0, 50176
    s_mov_b32 s73, 71936
    buffer_load_dwordx4 v9, s[32:35], s73 offen lds
    s_mov_b32 m0, 52224
    s_mov_b32 s73, 86272
    buffer_load_dwordx4 v9, s[32:35], s73 offen lds
    s_mov_b32 m0, 54272
    s_mov_b32 s73, 100608
    buffer_load_dwordx4 v9, s[32:35], s73 offen lds
    s_mov_b32 m0, 105472
    s_mov_b32 s73, 344064
    buffer_load_dwordx4 v10, s[36:39], s73 offen lds
    s_mov_b32 m0, 111616
    s_mov_b32 s73, 354816
    buffer_load_dwordx4 v10, s[36:39], s73 offen lds
    s_mov_b32 s55, 40000
    s_waitcnt vmcnt(11)
    s_barrier
    v_mov_b32 v24, 155648
    ds_read_b64 v[26:27], v24
    s_waitcnt lgkmcnt(0)
    v_readfirstlane_b32 s60, v26
    v_readfirstlane_b32 s61, v27
    s_mov_b32 m0, 1024
    s_mov_b32 s73, 384
    buffer_load_dwordx4 v8, s[32:35], s73 offen lds
    s_mov_b32 m0, 3072
    s_mov_b32 s73, 384
    buffer_load_dwordx4 v9, s[32:35], s73 offen lds
    s_mov_b32 m0, 5120
    s_mov_b32 s73, 14720
    buffer_load_dwordx4 v9, s[32:35], s73 offen lds
    s_mov_b32 m0, 7168
    s_mov_b32 s73, 29056
    buffer_load_dwordx4 v9, s[32:35], s73 offen lds
    s_mov_b32 m0, 9216
    s_mov_b32 s73, 43392
    buffer_load_dwordx4 v9, s[32:35], s73 offen lds
    s_mov_b32 m0, 11264
    s_mov_b32 s73, 57728
    buffer_load_dwordx4 v9, s[32:35], s73 offen lds
    s_mov_b32 m0, 13312
    s_mov_b32 s73, 72064
    buffer_load_dwordx4 v9, s[32:35], s73 offen lds
    s_mov_b32 m0, 15360
    s_mov_b32 s73, 86400
    buffer_load_dwordx4 v9, s[32:35], s73 offen lds
    s_mov_b32 m0, 17408
    s_mov_b32 s73, 100736
    buffer_load_dwordx4 v9, s[32:35], s73 offen lds
    s_mov_b32 m0, 56320
    s_mov_b32 s73, 516096
    buffer_load_dwordx4 v10, s[36:39], s73 offen lds
    s_mov_b32 m0, 62464
    s_mov_b32 s73, 526848
    buffer_load_dwordx4 v10, s[36:39], s73 offen lds
    s_waitcnt vmcnt(11)
    s_barrier
    s_mov_b32 m0, 19456
    s_mov_b32 s73, 512
    buffer_load_dwordx4 v8, s[32:35], s73 offen lds
    s_mov_b32 m0, 21504
    s_mov_b32 s73, 512
    buffer_load_dwordx4 v9, s[32:35], s73 offen lds
    s_mov_b32 m0, 23552
    s_mov_b32 s73, 14848
    buffer_load_dwordx4 v9, s[32:35], s73 offen lds
    s_mov_b32 m0, 25600
    s_mov_b32 s73, 29184
    buffer_load_dwordx4 v9, s[32:35], s73 offen lds
    s_mov_b32 m0, 27648
    s_mov_b32 s73, 43520
    buffer_load_dwordx4 v9, s[32:35], s73 offen lds
    s_mov_b32 m0, 29696
    s_mov_b32 s73, 57856
    buffer_load_dwordx4 v9, s[32:35], s73 offen lds
    s_mov_b32 m0, 31744
    s_mov_b32 s73, 72192
    buffer_load_dwordx4 v9, s[32:35], s73 offen lds
    s_mov_b32 m0, 33792
    s_mov_b32 s73, 86528
    buffer_load_dwordx4 v9, s[32:35], s73 offen lds
    s_mov_b32 m0, 35840
    s_mov_b32 s73, 100864
    buffer_load_dwordx4 v9, s[32:35], s73 offen lds
    s_mov_b32 m0, 80896
    s_mov_b32 s73, 688128
    buffer_load_dwordx4 v10, s[36:39], s73 offen lds
    s_mov_b32 m0, 87040
    s_mov_b32 s73, 698880
    buffer_load_dwordx4 v10, s[36:39], s73 offen lds
    s_waitcnt vmcnt(11)
    s_barrier
    s_mov_b32 m0, 37888
    s_mov_b32 s73, 640
    buffer_load_dwordx4 v8, s[32:35], s73 offen lds
    s_mov_b32 m0, 39936
    s_mov_b32 s73, 640
    buffer_load_dwordx4 v9, s[32:35], s73 offen lds
    s_mov_b32 m0, 41984
    s_mov_b32 s73, 14976
    buffer_load_dwordx4 v9, s[32:35], s73 offen lds
    s_mov_b32 m0, 44032
    s_mov_b32 s73, 29312
    buffer_load_dwordx4 v9, s[32:35], s73 offen lds
    s_mov_b32 m0, 46080
    s_mov_b32 s73, 43648
    buffer_load_dwordx4 v9, s[32:35], s73 offen lds
    s_mov_b32 m0, 48128
    s_mov_b32 s73, 57984
    buffer_load_dwordx4 v9, s[32:35], s73 offen lds
    s_mov_b32 m0, 50176
    s_mov_b32 s73, 72320
    buffer_load_dwordx4 v9, s[32:35], s73 offen lds
    s_mov_b32 m0, 52224
    s_mov_b32 s73, 86656
    buffer_load_dwordx4 v9, s[32:35], s73 offen lds
    s_mov_b32 m0, 54272
    s_mov_b32 s73, 100992
    buffer_load_dwordx4 v9, s[32:35], s73 offen lds
    s_mov_b32 m0, 105472
    s_mov_b32 s73, 860160
    buffer_load_dwordx4 v10, s[36:39], s73 offen lds
    s_mov_b32 m0, 111616
    s_mov_b32 s73, 870912
    buffer_load_dwordx4 v10, s[36:39], s73 offen lds
    s_waitcnt vmcnt(11)
    s_barrier
    s_lshl_b32 s72, s52, 7
    s_add_u32 s72, s72, 64
    v_add_u32 v24, s72, v0
    v_subrev_u32 v24, 16, v24
    v_max_i32 v24, 0, v24
    v_lshlrev_b32 v24, 4, v24
    buffer_load_dwordx4 v[28:31], v24, s[44:47], 0 offen sc1
    s_mov_b32 m0, 1024
    s_mov_b32 s73, 768
    buffer_load_dwordx4 v8, s[32:35], s73 offen lds
    s_mov_b32 m0, 3072
    s_mov_b32 s73, 768
    buffer_load_dwordx4 v9, s[32:35], s73 offen lds
    s_mov_b32 m0, 5120
    s_mov_b32 s73, 15104
    buffer_load_dwordx4 v9, s[32:35], s73 offen lds
    s_mov_b32 m0, 7168
    s_mov_b32 s73, 29440
    buffer_load_dwordx4 v9, s[32:35], s73 offen lds
    s_mov_b32 m0, 9216
    s_mov_b32 s73, 43776
    buffer_load_dwordx4 v9, s[32:35], s73 offen lds
    s_mov_b32 m0, 11264
    s_mov_b32 s73, 58112
    buffer_load_dwordx4 v9, s[32:35], s73 offen lds
    s_mov_b32 m0, 13312
    s_mov_b32 s73, 72448
    buffer_load_dwordx4 v9, s[32:35], s73 offen lds
    s_mov_b32 m0, 15360
    s_mov_b32 s73, 86784
    buffer_load_dwordx4 v9, s[32:35], s73 offen lds
    s_mov_b32 m0, 17408
    s_mov_b32 s73, 101120
    buffer_load_dwordx4 v9, s[32:35], s73 offen lds
    s_mov_b32 m0, 56320
    s_mov_b32 s73, 1032192
    buffer_load_dwordx4 v10, s[36:39], s73 offen lds
    s_mov_b32 m0, 62464
    s_mov_b32 s73, 1042944
    buffer_load_dwordx4 v10, s[36:39], s73 offen lds
    s_waitcnt vmcnt(11)
    v_cmp_eq_u32 vcc, s60, v30
    v_cmp_eq_u32 s[74:75], s61, v31
    s_and_b64 vcc, vcc, s[74:75]
    s_mov_b64 s[76:77], vcc
    s_cmp_eq_u64 s[76:77], -1
    s_cbranch_scc0 p1Al1_retry
p1Al1_tok:
    v_lshlrev_b32 v24, 2, v0
    v_add_u32 v24, 153856, v24
    ds_write_b32 v24, v28
    ds_write_b32 v24, v29 offset:576
    s_waitcnt lgkmcnt(0)
    s_barrier
    s_waitcnt vmcnt(0)
    s_barrier
    s_barrier
    s_branch p1Al1_done
p1Al1_retry:
    s_sub_u32 s55, s55, 1
    s_cmp_eq_u32 s55, 0
    s_cbranch_scc1 p1Al1_tok
    s_lshl_b32 s72, s52, 7
    s_add_u32 s72, s72, 64
    v_add_u32 v24, s72, v0
    v_subrev_u32 v24, 16, v24
    v_max_i32 v24, 0, v24
    v_lshlrev_b32 v24, 4, v24
    buffer_load_dwordx4 v[28:31], v24, s[44:47], 0 offen sc1
    s_waitcnt vmcnt(0)
    v_cmp_eq_u32 vcc, s60, v30
    v_cmp_eq_u32 s[74:75], s61, v31
    s_and_b64 vcc, vcc, s[74:75]
    s_mov_b64 s[76:77], vcc
    s_cmp_eq_u64 s[76:77], -1
    s_cbranch_scc0 p1Al1_retry
    s_branch p1Al1_tok
p1Al1_done:
    s_branch f_lr1
f_lA2:
    s_cmp_lg_u32 s3, 10
    s_cbranch_scc1 f_lA3
    s_mul_i32 s68, s54, 112
    v_add_u32 v20, 128, v0
    v_mul_u32_u24 v21, 2731, v20
    v_lshrrev_b32 v21, 16, v21
    v_mul_u32_u24 v22, 24, v21
    v_sub_u32 v22, v20, v22
    v_and_b32 v23, 3, v21
    v_lshrrev_b32 v20, 2, v21
    v_lshl_add_u32 v23, v20, 3, v23
    v_mul_u32_u24 v8, 2688, v23
    v_bfe_u32 v23, v21, 1, 2
    v_lshrrev_b32 v20, 1, v22
    v_xor_b32 v20, v20, v23
    v_lshrrev_b32 v23, 2, v20
    v_mul_u32_u24 v23, 896, v23
    v_add_u32 v8, v8, v23
    v_bfe_u32 v23, v20, 1, 1
    v_mul_u32_u24 v23, 56, v23
    v_add_u32 v8, v8, v23
    v_and_b32 v20, 1, v20
    v_lshl_add_u32 v8, v20, 5, v8
    v_and_b32 v22, 1, v22
    v_lshl_add_u32 v8, v22, 4, v8
    v_add_u32 v8, s68, v8
    v_add_u32 v20, 192, v0
    v_mul_u32_u24 v21, 2731, v20
    v_lshrrev_b32 v21, 16, v21
    v_mul_u32_u24 v22, 24, v21
    v_sub_u32 v22, v20, v22
    v_and_b32 v23, 3, v21
    v_lshrrev_b32 v20, 2, v21
    v_lshl_add_u32 v23, v20, 3, v23
    v_mul_u32_u24 v9, 2688, v23
    v_bfe_u32 v23, v21, 1, 2
    v_lshrrev_b32 v20, 1, v22
    v_xor_b32 v20, v20, v23
    v_lshrrev_b32 v23, 2, v20
    v_mul_u32_u24 v23, 896, v23
    v_add_u32 v9, v9, v23
    v_bfe_u32 v23, v20, 1, 1
    v_mul_u32_u24 v23, 56, v23
    v_add_u32 v9, v9, v23
    v_and_b32 v20, 1, v20
    v_lshl_add_u32 v9, v20, 5, v9
    v_and_b32 v22, 1, v22
    v_lshl_add_u32 v9, v22, 4, v9
    v_add_u32 v9, s68, v9
    v_add_u32 v20, 0, v0
    v_mul_u32_u24 v21, 2731, v20
    v_lshrrev_b32 v21, 16, v21
    v_mul_u32_u24 v22, 24, v21
    v_sub_u32 v22, v20, v22
    v_and_b32 v23, 3, v21
    v_lshrrev_b32 v20, 2, v21
    v_lshl_add_u32 v23, v20, 3, v23
    v_mul_u32_u24 v10, 2688, v23
    v_bfe_u32 v23, v21, 1, 2
    v_lshrrev_b32 v20, 1, v22
    v_xor_b32 v20, v20, v23
    v_lshrrev_b32 v23, 2, v20
    v_mul_u32_u24 v23, 896, v23
    v_add_u32 v10, v10, v23
    v_bfe_u32 v23, v20, 1, 1
    v_mul_u32_u24 v23, 56, v23
    v_add_u32 v10, v10, v23
    v_and_b32 v20, 1, v20
    v_lshl_add_u32 v10, v20, 5, v10
    v_and_b32 v22, 1, v22
    v_lshl_add_u32 v10, v22, 4, v10
    v_add_u32 v10, s68, v10
    s_waitcnt lgkmcnt(0)
    s_mov_b32 s32, s8
    s_mov_b32 s33, s9
    s_mov_b32 s34, 0x1c0000
    s_mov_b32 s35, 0x20000
    s_mov_b32 s36, s10
    s_mov_b32 s37, s11
    s_mov_b32 s38, 0x126000
    s_mov_b32 s39, 0x20000
    s_mov_b32 s44, s28
    s_mov_b32 s45, s29
    s_mov_b32 s46, 0x1600000
    s_mov_b32 s47, 0x20000
    s_mov_b32 m0, 57344
    s_mov_b32 s73, 0
    buffer_load_dwordx4 v8, s[36:39], s73 offen lds
    s_mov_b32 m0, 63488
    s_mov_b32 s73, 10752
    buffer_load_dwordx4 v8, s[36:39], s73 offen lds
    s_mov_b32 m0, 69632
    s_mov_b32 s73, 86016
    buffer_load_dwordx4 v8, s[36:39], s73 offen lds
    s_mov_b32 m0, 75776
    s_mov_b32 s73, 96768
    buffer_load_dwordx4 v8, s[36:39], s73 offen lds
    s_mov_b32 m0, 58368
    s_mov_b32 s73, 0
    buffer_load_dwordx4 v9, s[36:39], s73 offen lds
    s_mov_b32 m0, 64512
    s_mov_b32 s73, 10752
    buffer_load_dwordx4 v9, s[36:39], s73 offen lds
    s_mov_b32 m0, 70656
    s_mov_b32 s73, 86016
    buffer_load_dwordx4 v9, s[36:39], s73 offen lds
    s_mov_b32 m0, 76800
    s_mov_b32 s73, 96768
    buffer_load_dwordx4 v9, s[36:39], s73 offen lds
    s_mov_b32 m0, 67584
    s_mov_b32 s73, 86016
    buffer_load_dwordx4 v10, s[36:39], s73 offen lds
    s_mov_b32 m0, 73728
    s_mov_b32 s73, 96768
    buffer_load_dwordx4 v10, s[36:39], s73 offen lds
    s_mov_b32 m0, 81920
    s_mov_b32 s73, 172032
    buffer_load_dwordx4 v8, s[36:39], s73 offen lds
    s_mov_b32 m0, 88064
    s_mov_b32 s73, 182784
    buffer_load_dwordx4 v8, s[36:39], s73 offen lds
    s_mov_b32 m0, 94208
    s_mov_b32 s73, 258048
    buffer_load_dwordx4 v8, s[36:39], s73 offen lds
    s_mov_b32 m0, 100352
    s_mov_b32 s73, 268800
    buffer_load_dwordx4 v8, s[36:39], s73 offen lds
    s_mov_b32 m0, 82944
    s_mov_b32 s73, 172032
    buffer_load_dwordx4 v9, s[36:39], s73 offen lds
    s_mov_b32 m0, 89088
    s_mov_b32 s73, 182784
    buffer_load_dwordx4 v9, s[36:39], s73 offen lds
    s_mov_b32 m0, 95232
    s_mov_b32 s73, 258048
    buffer_load_dwordx4 v9, s[36:39], s73 offen lds
    s_mov_b32 m0, 101376
    s_mov_b32 s73, 268800
    buffer_load_dwordx4 v9, s[36:39], s73 offen lds
    s_mov_b32 m0, 92160
    s_mov_b32 s73, 258048
    buffer_load_dwordx4 v10, s[36:39], s73 offen lds
    s_mov_b32 m0, 98304
    s_mov_b32 s73, 268800
    buffer_load_dwordx4 v10, s[36:39], s73 offen lds
    s_waitcnt vmcnt(10)
    s_barrier
    s_mov_b32 m0, 106496
    s_mov_b32 s73, 344064
    buffer_load_dwordx4 v8, s[36:39], s73 offen lds
    s_mov_b32 m0, 112640
    s_mov_b32 s73, 354816
    buffer_load_dwordx4 v8, s[36:39], s73 offen lds
    s_mov_b32 m0, 118784
    s_mov_b32 s73, 430080
    buffer_load_dwordx4 v8, s[36:39], s73 offen lds
    s_mov_b32 m0, 124928
    s_mov_b32 s73, 440832
    buffer_load_dwordx4 v8, s[36:39], s73 offen lds
    s_mov_b32 m0, 107520
    s_mov_b32 s73, 344064
    buffer_load_dwordx4 v9, s[36:39], s73 offen lds
    s_mov_b32 m0, 113664
    s_mov_b32 s73, 354816
    buffer_load_dwordx4 v9, s[36:39], s73 offen lds
    s_mov_b32 m0, 119808
    s_mov_b32 s73, 430080
    buffer_load_dwordx4 v9, s[36:39], s73 offen lds
    s_mov_b32 m0, 125952
    s_mov_b32 s73, 440832
    buffer_load_dwordx4 v9, s[36:39], s73 offen lds
    s_mov_b32 m0, 116736
    s_mov_b32 s73, 430080
    buffer_load_dwordx4 v10, s[36:39], s73 offen lds
    s_mov_b32 m0, 122880
    s_mov_b32 s73, 440832
    buffer_load_dwordx4 v10, s[36:39], s73 offen lds
    s_mov_b32 s55, 40000
    s_waitcnt vmcnt(10)
    s_barrier
    v_mov_b32 v24, 155648
    ds_read_b64 v[26:27], v24
    s_waitcnt lgkmcnt(0)
    v_readfirstlane_b32 s60, v26
    v_readfirstlane_b32 s61, v27
    s_mov_b32 m0, 57344
    s_mov_b32 s73, 516096
    buffer_load_dwordx4 v8, s[36:39], s73 offen lds
    s_mov_b32 m0, 63488
    s_mov_b32 s73, 526848
    buffer_load_dwordx4 v8, s[36:39], s73 offen lds
    s_mov_b32 m0, 69632
    s_mov_b32 s73, 602112
    buffer_load_dwordx4 v8, s[36:39], s73 offen lds
    s_mov_b32 m0, 75776
    s_mov_b32 s73, 612864
    buffer_load_dwordx4 v8, s[36:39], s73 offen lds
    s_mov_b32 m0, 58368
    s_mov_b32 s73, 516096
    buffer_load_dwordx4 v9, s[36:39], s73 offen lds
    s_mov_b32 m0, 64512
    s_mov_b32 s73, 526848
    buffer_load_dwordx4 v9, s[36:39], s73 offen lds
    s_mov_b32 m0, 70656
    s_mov_b32 s73, 602112
    buffer_load_dwordx4 v9, s[36:39], s73 offen lds
    s_mov_b32 m0, 76800
    s_mov_b32 s73, 612864
    buffer_load_dwordx4 v9, s[36:39], s73 offen lds
    s_mov_b32 m0, 67584
    s_mov_b32 s73, 602112
    buffer_load_dwordx4 v10, s[36:39], s73 offen lds
    s_mov_b32 m0, 73728
    s_mov_b32 s73, 612864
    buffer_load_dwordx4 v10, s[36:39], s73 offen lds
    s_waitcnt vmcnt(10)
    s_barrier
    s_mov_b32 m0, 81920
    s_mov_b32 s73, 688128
    buffer_load_dwordx4 v8, s[36:39], s73 offen lds
    s_mov_b32 m0, 88064
    s_mov_b32 s73, 698880
    buffer_load_dwordx4 v8, s[36:39], s73 offen lds
    s_mov_b32 m0, 94208
    s_mov_b32 s73, 774144
    buffer_load_dwordx4 v8, s[36:39], s73 offen lds
    s_mov_b32 m0, 100352
    s_mov_b32 s73, 784896
    buffer_load_dwordx4 v8, s[36:39], s73 offen lds
    s_mov_b32 m0, 82944
    s_mov_b32 s73, 688128
    buffer_load_dwordx4 v9, s[36:39], s73 offen lds
    s_mov_b32 m0, 89088
    s_mov_b32 s73, 698880
    buffer_load_dwordx4 v9, s[36:39], s73 offen lds
    s_mov_b32 m0, 95232
    s_mov_b32 s73, 774144
    buffer_load_dwordx4 v9, s[36:39], s73 offen lds
    s_mov_b32 m0, 101376
    s_mov_b32 s73, 784896
    buffer_load_dwordx4 v9, s[36:39], s73 offen lds
    s_mov_b32 m0, 92160
    s_mov_b32 s73, 774144
    buffer_load_dwordx4 v10, s[36:39], s73 offen lds
    s_mov_b32 m0, 98304
    s_mov_b32 s73, 784896
    buffer_load_dwordx4 v10, s[36:39], s73 offen lds
    s_waitcnt vmcnt(10)
    s_barrier
    s_mov_b32 m0, 106496
    s_mov_b32 s73, 860160
    buffer_load_dwordx4 v8, s[36:39], s73 offen lds
    s_mov_b32 m0, 112640
    s_mov_b32 s73, 870912
    buffer_load_dwordx4 v8, s[36:39], s73 offen lds
    s_mov_b32 m0, 118784
    s_mov_b32 s73, 946176
    buffer_load_dwordx4 v8, s[36:39], s73 offen lds
    s_mov_b32 m0, 124928
    s_mov_b32 s73, 956928
    buffer_load_dwordx4 v8, s[36:39], s73 offen lds
    s_mov_b32 m0, 107520
    s_mov_b32 s73, 860160
    buffer_load_dwordx4 v9, s[36:39], s73 offen lds
    s_mov_b32 m0, 113664
    s_mov_b32 s73, 870912
    buffer_load_dwordx4 v9, s[36:39], s73 offen lds
    s_mov_b32 m0, 119808
    s_mov_b32 s73, 946176
    buffer_load_dwordx4 v9, s[36:39], s73 offen lds
    s_mov_b32 m0, 125952
    s_mov_b32 s73, 956928
    buffer_load_dwordx4 v9, s[36:39], s73 offen lds
    s_mov_b32 m0, 116736
    s_mov_b32 s73, 946176
    buffer_load_dwordx4 v10, s[36:39], s73 offen lds
    s_mov_b32 m0, 122880
    s_mov_b32 s73, 956928
    buffer_load_dwordx4 v10, s[36:39], s73 offen lds
    s_waitcnt vmcnt(10)
    s_barrier
    s_lshl_b32 s72, s52, 7
    s_add_u32 s72, s72, 128
    v_add_u32 v24, s72, v0
    v_subrev_u32 v24, 16, v24
    v_max_i32 v24, 0, v24
    v_lshlrev_b32 v24, 4, v24
    s_lshl_b32 s72, s52, 7
    s_add_u32 s72, s72, 127
    s_lshl_b32 s72, s72, 4
    v_min_u32 v24, s72, v24
    buffer_load_dwordx4 v[28:31], v24, s[44:47], 0 offen sc1
    v_add_u32 v25, 0, v0
    v_lshrrev_b32 v26, 3, v25
    v_min_u32 v26, 11, v26
    s_mul_i32 s72, s53, 14
    v_add_u32 v26, s72, v26
    v_lshlrev_b32 v26, 9, v26
    v_and_b32 v25, 7, v25
    v_lshl_add_u32 v26, v25, 4, v26
    s_mov_b32 s72, 32768
    buffer_load_dwordx4 v[32:35], v26, s[44:47], s72 offen offset:0 sc1
    buffer_load_dwordx4 v[36:39], v26, s[44:47], s72 offen offset:128 sc1
    buffer_load_dwordx4 v[40:43], v26, s[44:47], s72 offen offset:256 sc1
    buffer_load_dwordx4 v[44:47], v26, s[44:47], s72 offen offset:384 sc1
    s_mov_b32 m0, 57344
    s_mov_b32 s73, 1032192
    buffer_load_dwordx4 v8, s[36:39], s73 offen lds
    s_mov_b32 m0, 63488
    s_mov_b32 s73, 1042944
    buffer_load_dwordx4 v8, s[36:39], s73 offen lds
    s_mov_b32 m0, 69632
    s_mov_b32 s73, 1118208
    buffer_load_dwordx4 v8, s[36:39], s73 offen lds
    s_mov_b32 m0, 75776
    s_mov_b32 s73, 1128960
    buffer_load_dwordx4 v8, s[36:39], s73 offen lds
    s_mov_b32 m0, 58368
    s_mov_b32 s73, 1032192
    buffer_load_dwordx4 v9, s[36:39], s73 offen lds
    s_mov_b32 m0, 64512
    s_mov_b32 s73, 1042944
    buffer_load_dwordx4 v9, s[36:39], s73 offen lds
    s_mov_b32 m0, 70656
    s_mov_b32 s73, 1118208
    buffer_load_dwordx4 v9, s[36:39], s73 offen lds
    s_mov_b32 m0, 76800
    s_mov_b32 s73, 1128960
    buffer_load_dwordx4 v9, s[36:39], s73 offen lds
    s_mov_b32 m0, 67584
    s_mov_b32 s73, 1118208
    buffer_load_dwordx4 v10, s[36:39], s73 offen lds
    s_mov_b32 m0, 73728
    s_mov_b32 s73, 1128960
    buffer_load_dwordx4 v10, s[36:39], s73 offen lds
    s_waitcnt vmcnt(10)
    v_cmp_eq_u32 vcc, s60, v30
    v_cmp_eq_u32 s[74:75], s61, v31
    s_and_b64 vcc, vcc, s[74:75]
    s_mov_b64 s[76:77], vcc
    v_cmp_eq_u32 vcc, s60, v34
    v_cmp_eq_u32 s[74:75], s61, v35
    s_and_b64 vcc, vcc, s[74:75]
    s_and_b64 s[76:77], s[76:77], vcc
    v_cmp_eq_u32 vcc, s60, v38
    v_cmp_eq_u32 s[74:75], s61, v39
    s_and_b64 vcc, vcc, s[74:75]
    s_and_b64 s[76:77], s[76:77], vcc
    v_cmp_eq_u32 vcc, s60, v42
    v_cmp_eq_u32 s[74:75], s61, v43
    s_and_b64 vcc, vcc, s[74:75]
    s_and_b64 s[76:77], s[76:77], vcc
    v_cmp_eq_u32 vcc, s60, v46
    v_cmp_eq_u32 s[74:75], s61, v47
    s_and_b64 vcc, vcc, s[74:75]
    s_and_b64 s[76:77], s[76:77], vcc
    s_cmp_eq_u64 s[76:77], -1
    s_cbranch_scc0 p1Al2_retry
p1Al2_tok:
    v_lshlrev_b32 v24, 2, v0
    v_add_u32 v24, 154112, v24
    s_mov_b64 exec, 0xffff
    ds_write_b32 v24, v28
    ds_write_b32 v24, v29 offset:576
    s_mov_b64 exec, -1
    v_pk_add_f32 v[32:33], v[32:33], v[36:37]
    v_pk_add_f32 v[40:41], v[40:41], v[44:45]
    v_pk_add_f32 v[32:33], v[32:33], v[40:41]
    v_lshlrev_b32 v24, 3, v0
    v_add_u32 v24, 154752, v24
    ds_write_b64 v24, v[32:33]
    s_waitcnt lgkmcnt(0)
    s_barrier
    s_waitcnt vmcnt(0)
    s_barrier
    s_barrier
    s_branch p1Al2_done
p1Al2_retry:
    s_sub_u32 s55, s55, 1
    s_cmp_eq_u32 s55, 0
    s_cbranch_scc1 p1Al2_tok
    s_lshl_b32 s72, s52, 7
    s_add_u32 s72, s72, 128
    v_add_u32 v24, s72, v0
    v_subrev_u32 v24, 16, v24
    v_max_i32 v24, 0, v24
    v_lshlrev_b32 v24, 4, v24
    s_lshl_b32 s72, s52, 7
    s_add_u32 s72, s72, 127
    s_lshl_b32 s72, s72, 4
    v_min_u32 v24, s72, v24
    buffer_load_dwordx4 v[28:31], v24, s[44:47], 0 offen sc1
    v_add_u32 v25, 0, v0
    v_lshrrev_b32 v26, 3, v25
    v_min_u32 v26, 11, v26
    s_mul_i32 s72, s53, 14
    v_add_u32 v26, s72, v26
    v_lshlrev_b32 v26, 9, v26
    v_and_b32 v25, 7, v25
    v_lshl_add_u32 v26, v25, 4, v26
    s_mov_b32 s72, 32768
    buffer_load_dwordx4 v[32:35], v26, s[44:47], s72 offen offset:0 sc1
    buffer_load_dwordx4 v[36:39], v26, s[44:47], s72 offen offset:128 sc1
    buffer_load_dwordx4 v[40:43], v26, s[44:47], s72 offen offset:256 sc1
    buffer_load_dwordx4 v[44:47], v26, s[44:47], s72 offen offset:384 sc1
    s_waitcnt vmcnt(0)
    v_cmp_eq_u32 vcc, s60, v30
    v_cmp_eq_u32 s[74:75], s61, v31
    s_and_b64 vcc, vcc, s[74:75]
    s_mov_b64 s[76:77], vcc
    v_cmp_eq_u32 vcc, s60, v34
    v_cmp_eq_u32 s[74:75], s61, v35
    s_and_b64 vcc, vcc, s[74:75]
    s_and_b64 s[76:77], s[76:77], vcc
    v_cmp_eq_u32 vcc, s60, v38
    v_cmp_eq_u32 s[74:75], s61, v39
    s_and_b64 vcc, vcc, s[74:75]
    s_and_b64 s[76:77], s[76:77], vcc
    v_cmp_eq_u32 vcc, s60, v42
    v_cmp_eq_u32 s[74:75], s61, v43
    s_and_b64 vcc, vcc, s[74:75]
    s_and_b64 s[76:77], s[76:77], vcc
    v_cmp_eq_u32 vcc, s60, v46
    v_cmp_eq_u32 s[74:75], s61, v47
    s_and_b64 vcc, vcc, s[74:75]
    s_and_b64 s[76:77], s[76:77], vcc
    s_cmp_eq_u64 s[76:77], -1
    s_cbranch_scc0 p1Al2_retry
    s_branch p1Al2_tok
p1Al2_done:
    s_branch f_lr2
f_lA3:
    s_mul_i32 s68, s54, 112
    v_add_u32 v20, 256, v0
    v_mul_u32_u24 v21, 2731, v20
    v_lshrrev_b32 v21, 16, v21
    v_mul_u32_u24 v22, 24, v21
    v_sub_u32 v22, v20, v22
    v_and_b32 v23, 3, v21
    v_lshrrev_b32 v20, 2, v21
    v_lshl_add_u32 v23, v20, 3, v23
    v_mul_u32_u24 v8, 2688, v23
    v_bfe_u32 v23, v21, 1, 2
    v_lshrrev_b32 v20, 1, v22
    v_xor_b32 v20, v20, v23
    v_lshrrev_b32 v23, 2, v20
    v_mul_u32_u24 v23, 896, v23
    v_add_u32 v8, v8, v23
    v_bfe_u32 v23, v20, 1, 1
    v_mul_u32_u24 v23, 56, v23
    v_add_u32 v8, v8, v23
    v_and_b32 v20, 1, v20
    v_lshl_add_u32 v8, v20, 5, v8
    v_and_b32 v22, 1, v22
    v_lshl_add_u32 v8, v22, 4, v8
    v_add_u32 v8, s68, v8
    v_add_u32 v20, 320, v0
    v_mul_u32_u24 v21, 2731, v20
    v_lshrrev_b32 v21, 16, v21
    v_mul_u32_u24 v22, 24, v21
    v_sub_u32 v22, v20, v22
    v_and_b32 v23, 3, v21
    v_lshrrev_b32 v20, 2, v21
    v_lshl_add_u32 v23, v20, 3, v23
    v_mul_u32_u24 v9, 2688, v23
    v_bfe_u32 v23, v21, 1, 2
    v_lshrrev_b32 v20, 1, v22
    v_xor_b32 v20, v20, v23
    v_lshrrev_b32 v23, 2, v20
    v_mul_u32_u24 v23, 896, v23
    v_add_u32 v9, v9, v23
    v_bfe_u32 v23, v20, 1, 1
    v_mul_u32_u24 v23, 56, v23
    v_add_u32 v9, v9, v23
    v_and_b32 v20, 1, v20
    v_lshl_add_u32 v9, v20, 5, v9
    v_and_b32 v22, 1, v22
    v_lshl_add_u32 v9, v22, 4, v9
    v_add_u32 v9, s68, v9
    v_add_u32 v20, 64, v0
    v_mul_u32_u24 v21, 2731, v20
    v_lshrrev_b32 v21, 16, v21
    v_mul_u32_u24 v22, 24, v21
    v_sub_u32 v22, v20, v22
    v_and_b32 v23, 3, v21
    v_lshrrev_b32 v20, 2, v21
    v_lshl_add_u32 v23, v20, 3, v23
    v_mul_u32_u24 v10, 2688, v23
    v_bfe_u32 v23, v21, 1, 2
    v_lshrrev_b32 v20, 1, v22
    v_xor_b32 v20, v20, v23
    v_lshrrev_b32 v23, 2, v20
    v_mul_u32_u24 v23, 896, v23
    v_add_u32 v10, v10, v23
    v_bfe_u32 v23, v20, 1, 1
    v_mul_u32_u24 v23, 56, v23
    v_add_u32 v10, v10, v23
    v_and_b32 v20, 1, v20
    v_lshl_add_u32 v10, v20, 5, v10
    v_and_b32 v22, 1, v22
    v_lshl_add_u32 v10, v22, 4, v10
    v_add_u32 v10, s68, v10
    s_waitcnt lgkmcnt(0)
    s_mov_b32 s32, s8
    s_mov_b32 s33, s9
    s_mov_b32 s34, 0x1c0000
    s_mov_b32 s35, 0x20000
    s_mov_b32 s36, s10
    s_mov_b32 s37, s11
    s_mov_b32 s38, 0x126000
    s_mov_b32 s39, 0x20000
    s_mov_b32 s44, s28
    s_mov_b32 s45, s29
    s_mov_b32 s46, 0x1600000
    s_mov_b32 s47, 0x20000
    s_mov_b32 m0, 59392
    s_mov_b32 s73, 0
    buffer_load_dwordx4 v8, s[36:39], s73 offen lds
    s_mov_b32 m0, 65536
    s_mov_b32 s73, 10752
    buffer_load_dwordx4 v8, s[36:39], s73 offen lds
    s_mov_b32 m0, 71680
    s_mov_b32 s73, 86016
    buffer_load_dwordx4 v8, s[36:39], s73 offen lds
    s_mov_b32 m0, 77824
    s_mov_b32 s73, 96768
    buffer_load_dwordx4 v8, s[36:39], s73 offen lds
    s_mov_b32 m0, 60416
    s_mov_b32 s73, 0
    buffer_load_dwordx4 v9, s[36:39], s73 offen lds
    s_mov_b32 m0, 66560
    s_mov_b32 s73, 10752
    buffer_load_dwordx4 v9, s[36:39], s73 offen lds
    s_mov_b32 m0, 72704
    s_mov_b32 s73, 86016
    buffer_load_dwordx4 v9, s[36:39], s73 offen lds
    s_mov_b32 m0, 78848
    s_mov_b32 s73, 96768
    buffer_load_dwordx4 v9, s[36:39], s73 offen lds
    s_mov_b32 m0, 68608
    s_mov_b32 s73, 86016
    buffer_load_dwordx4 v10, s[36:39], s73 offen lds
    s_mov_b32 m0, 74752
    s_mov_b32 s73, 96768
    buffer_load_dwordx4 v10, s[36:39], s73 offen lds
    s_mov_b32 m0, 83968
    s_mov_b32 s73, 172032
    buffer_load_dwordx4 v8, s[36:39], s73 offen lds
    s_mov_b32 m0, 90112
    s_mov_b32 s73, 182784
    buffer_load_dwordx4 v8, s[36:39], s73 offen lds
    s_mov_b32 m0, 96256
    s_mov_b32 s73, 258048
    buffer_load_dwordx4 v8, s[36:39], s73 offen lds
    s_mov_b32 m0, 102400
    s_mov_b32 s73, 268800
    buffer_load_dwordx4 v8, s[36:39], s73 offen lds
    s_mov_b32 m0, 84992
    s_mov_b32 s73, 172032
    buffer_load_dwordx4 v9, s[36:39], s73 offen lds
    s_mov_b32 m0, 91136
    s_mov_b32 s73, 182784
    buffer_load_dwordx4 v9, s[36:39], s73 offen lds
    s_mov_b32 m0, 97280
    s_mov_b32 s73, 258048
    buffer_load_dwordx4 v9, s[36:39], s73 offen lds
    s_mov_b32 m0, 103424
    s_mov_b32 s73, 268800
    buffer_load_dwordx4 v9, s[36:39], s73 offen lds
    s_mov_b32 m0, 93184
    s_mov_b32 s73, 258048
    buffer_load_dwordx4 v10, s[36:39], s73 offen lds
    s_mov_b32 m0, 99328
    s_mov_b32 s73, 268800
    buffer_load_dwordx4 v10, s[36:39], s73 offen lds
    s_waitcnt vmcnt(10)
    s_barrier
    s_mov_b32 s48, s26
    s_mov_b32 s49, s27
    s_mov_b32 s50, 0x100
    s_mov_b32 s51, 0x20000
    v_mov_b32 v25, 0
    s_mov_b64 exec, 1
    buffer_load_dwordx2 v[26:27], v25, s[48:51], 0 offen sc1
    s_mov_b64 exec, -1
    s_mov_b32 m0, 108544
    s_mov_b32 s73, 344064
    buffer_load_dwordx4 v8, s[36:39], s73 offen lds
    s_mov_b32 m0, 114688
    s_mov_b32 s73, 354816
    buffer_load_dwordx4 v8, s[36:39], s73 offen lds
    s_mov_b32 m0, 120832
    s_mov_b32 s73, 430080
    buffer_load_dwordx4 v8, s[36:39], s73 offen lds
    s_mov_b32 m0, 126976
    s_mov_b32 s73, 440832
    buffer_load_dwordx4 v8, s[36:39], s73 offen lds
    s_mov_b32 m0, 109568
    s_mov_b32 s73, 344064
    buffer_load_dwordx4 v9, s[36:39], s73 offen lds
    s_mov_b32 m0, 115712
    s_mov_b32 s73, 354816
    buffer_load_dwordx4 v9, s[36:39], s73 offen lds
    s_mov_b32 m0, 121856
    s_mov_b32 s73, 430080
    buffer_load_dwordx4 v9, s[36:39], s73 offen lds
    s_mov_b32 m0, 128000
    s_mov_b32 s73, 440832
    buffer_load_dwordx4 v9, s[36:39], s73 offen lds
    s_mov_b32 m0, 117760
    s_mov_b32 s73, 430080
    buffer_load_dwordx4 v10, s[36:39], s73 offen lds
    s_mov_b32 m0, 123904
    s_mov_b32 s73, 440832
    buffer_load_dwordx4 v10, s[36:39], s73 offen lds
    s_mov_b32 s55, 40000
    s_waitcnt vmcnt(10)
    s_mov_b32 s74, 40000
p1Al3_npl:
    v_readfirstlane_b32 s75, v26
    s_cmp_lg_u32 s75, 0
    s_cbranch_scc1 p1Al3_nok
    s_sub_u32 s74, s74, 1
    s_cmp_eq_u32 s74, 0
    s_cbranch_scc1 p1Al3_nok
    s_mov_b64 exec, 1
    buffer_load_dwordx2 v[26:27], v25, s[48:51], 0 offen sc1
    s_mov_b64 exec, -1
    s_waitcnt vmcnt(0)
    s_branch p1Al3_npl
p1Al3_nok:
    v_mov_b32 v24, 155648
    s_mov_b64 exec, 1
    ds_write_b64 v24, v[26:27]
    s_mov_b64 exec, -1
    s_waitcnt lgkmcnt(0)
    s_barrier
    v_mov_b32 v24, 155648
    ds_read_b64 v[26:27], v24
    s_waitcnt lgkmcnt(0)
    v_readfirstlane_b32 s60, v26
    v_readfirstlane_b32 s61, v27
    s_mov_b32 m0, 59392
    s_mov_b32 s73, 516096
    buffer_load_dwordx4 v8, s[36:39], s73 offen lds
    s_mov_b32 m0, 65536
    s_mov_b32 s73, 526848
    buffer_load_dwordx4 v8, s[36:39], s73 offen lds
    s_mov_b32 m0, 71680
    s_mov_b32 s73, 602112
    buffer_load_dwordx4 v8, s[36:39], s73 offen lds
    s_mov_b32 m0, 77824
    s_mov_b32 s73, 612864
    buffer_load_dwordx4 v8, s[36:39], s73 offen lds
    s_mov_b32 m0, 60416
    s_mov_b32 s73, 516096
    buffer_load_dwordx4 v9, s[36:39], s73 offen lds
    s_mov_b32 m0, 66560
    s_mov_b32 s73, 526848
    buffer_load_dwordx4 v9, s[36:39], s73 offen lds
    s_mov_b32 m0, 72704
    s_mov_b32 s73, 602112
    buffer_load_dwordx4 v9, s[36:39], s73 offen lds
    s_mov_b32 m0, 78848
    s_mov_b32 s73, 612864
    buffer_load_dwordx4 v9, s[36:39], s73 offen lds
    s_mov_b32 m0, 68608
    s_mov_b32 s73, 602112
    buffer_load_dwordx4 v10, s[36:39], s73 offen lds
    s_mov_b32 m0, 74752
    s_mov_b32 s73, 612864
    buffer_load_dwordx4 v10, s[36:39], s73 offen lds
    s_waitcnt vmcnt(10)
    s_barrier
    s_mov_b32 m0, 83968
    s_mov_b32 s73, 688128
    buffer_load_dwordx4 v8, s[36:39], s73 offen lds
    s_mov_b32 m0, 90112
    s_mov_b32 s73, 698880
    buffer_load_dwordx4 v8, s[36:39], s73 offen lds
    s_mov_b32 m0, 96256
    s_mov_b32 s73, 774144
    buffer_load_dwordx4 v8, s[36:39], s73 offen lds
    s_mov_b32 m0, 102400
    s_mov_b32 s73, 784896
    buffer_load_dwordx4 v8, s[36:39], s73 offen lds
    s_mov_b32 m0, 84992
    s_mov_b32 s73, 688128
    buffer_load_dwordx4 v9, s[36:39], s73 offen lds
    s_mov_b32 m0, 91136
    s_mov_b32 s73, 698880
    buffer_load_dwordx4 v9, s[36:39], s73 offen lds
    s_mov_b32 m0, 97280
    s_mov_b32 s73, 774144
    buffer_load_dwordx4 v9, s[36:39], s73 offen lds
    s_mov_b32 m0, 103424
    s_mov_b32 s73, 784896
    buffer_load_dwordx4 v9, s[36:39], s73 offen lds
    s_mov_b32 m0, 93184
    s_mov_b32 s73, 774144
    buffer_load_dwordx4 v10, s[36:39], s73 offen lds
    s_mov_b32 m0, 99328
    s_mov_b32 s73, 784896
    buffer_load_dwordx4 v10, s[36:39], s73 offen lds
    s_waitcnt vmcnt(10)
    s_barrier
    s_mov_b32 m0, 108544
    s_mov_b32 s73, 860160
    buffer_load_dwordx4 v8, s[36:39], s73 offen lds
    s_mov_b32 m0, 114688
    s_mov_b32 s73, 870912
    buffer_load_dwordx4 v8, s[36:39], s73 offen lds
    s_mov_b32 m0, 120832
    s_mov_b32 s73, 946176
    buffer_load_dwordx4 v8, s[36:39], s73 offen lds
    s_mov_b32 m0, 126976
    s_mov_b32 s73, 956928
    buffer_load_dwordx4 v8, s[36:39], s73 offen lds
    s_mov_b32 m0, 109568
    s_mov_b32 s73, 860160
    buffer_load_dwordx4 v9, s[36:39], s73 offen lds
    s_mov_b32 m0, 115712
    s_mov_b32 s73, 870912
    buffer_load_dwordx4 v9, s[36:39], s73 offen lds
    s_mov_b32 m0, 121856
    s_mov_b32 s73, 946176
    buffer_load_dwordx4 v9, s[36:39], s73 offen lds
    s_mov_b32 m0, 128000
    s_mov_b32 s73, 956928
    buffer_load_dwordx4 v9, s[36:39], s73 offen lds
    s_mov_b32 m0, 117760
    s_mov_b32 s73, 946176
    buffer_load_dwordx4 v10, s[36:39], s73 offen lds
    s_mov_b32 m0, 123904
    s_mov_b32 s73, 956928
    buffer_load_dwordx4 v10, s[36:39], s73 offen lds
    s_waitcnt vmcnt(10)
    s_barrier
    v_add_u32 v25, 64, v0
    v_lshrrev_b32 v26, 3, v25
    v_min_u32 v26, 11, v26
    s_mul_i32 s72, s53, 14
    v_add_u32 v26, s72, v26
    v_lshlrev_b32 v26, 9, v26
    v_and_b32 v25, 7, v25
    v_lshl_add_u32 v26, v25, 4, v26
    s_mov_b32 s72, 32768
    buffer_load_dwordx4 v[32:35], v26, s[44:47], s72 offen offset:0 sc1
    buffer_load_dwordx4 v[36:39], v26, s[44:47], s72 offen offset:128 sc1
    buffer_load_dwordx4 v[40:43], v26, s[44:47], s72 offen offset:256 sc1
    buffer_load_dwordx4 v[44:47], v26, s[44:47], s72 offen offset:384 sc1
    s_mov_b32 m0, 59392
    s_mov_b32 s73, 1032192
    buffer_load_dwordx4 v8, s[36:39], s73 offen lds
    s_mov_b32 m0, 65536
    s_mov_b32 s73, 1042944
    buffer_load_dwordx4 v8, s[36:39], s73 offen lds
    s_mov_b32 m0, 71680
    s_mov_b32 s73, 1118208
    buffer_load_dwordx4 v8, s[36:39], s73 offen lds
    s_mov_b32 m0, 77824
    s_mov_b32 s73, 1128960
    buffer_load_dwordx4 v8, s[36:39], s73 offen lds
    s_mov_b32 m0, 60416
    s_mov_b32 s73, 1032192
    buffer_load_dwordx4 v9, s[36:39], s73 offen lds
    s_mov_b32 m0, 66560
    s_mov_b32 s73, 1042944
    buffer_load_dwordx4 v9, s[36:39], s73 offen lds
    s_mov_b32 m0, 72704
    s_mov_b32 s73, 1118208
    buffer_load_dwordx4 v9, s[36:39], s73 offen lds
    s_mov_b32 m0, 78848
    s_mov_b32 s73, 1128960
    buffer_load_dwordx4 v9, s[36:39], s73 offen lds
    s_mov_b32 m0, 68608
    s_mov_b32 s73, 1118208
    buffer_load_dwordx4 v10, s[36:39], s73 offen lds
    s_mov_b32 m0, 74752
    s_mov_b32 s73, 1128960
    buffer_load_dwordx4 v10, s[36:39], s73 offen lds
    s_waitcnt vmcnt(10)
    v_cmp_eq_u32 vcc, s60, v34
    v_cmp_eq_u32 s[74:75], s61, v35
    s_and_b64 vcc, vcc, s[74:75]
    s_mov_b64 s[76:77], vcc
    v_cmp_eq_u32 vcc, s60, v38
    v_cmp_eq_u32 s[74:75], s61, v39
    s_and_b64 vcc, vcc, s[74:75]
    s_and_b64 s[76:77], s[76:77], vcc
    v_cmp_eq_u32 vcc, s60, v42
    v_cmp_eq_u32 s[74:75], s61, v43
    s_and_b64 vcc, vcc, s[74:75]
    s_and_b64 s[76:77], s[76:77], vcc
    v_cmp_eq_u32 vcc, s60, v46
    v_cmp_eq_u32 s[74:75], s61, v47
    s_and_b64 vcc, vcc, s[74:75]
    s_and_b64 s[76:77], s[76:77], vcc
    s_cmp_eq_u64 s[76:77], -1
    s_cbranch_scc0 p1Al3_retry
p1Al3_tok:
    v_pk_add_f32 v[32:33], v[32:33], v[36:37]
    v_pk_add_f32 v[40:41], v[40:41], v[44:45]
    v_pk_add_f32 v[32:33], v[32:33], v[40:41]
    v_lshlrev_b32 v24, 3, v0
    v_add_u32 v24, 155264, v24
    s_mov_b32 exec_hi, 0xffff
    ds_write_b64 v24, v[32:33]
    s_mov_b64 exec, -1
    s_waitcnt lgkmcnt(0)
    s_barrier
    s_waitcnt vmcnt(0)
    s_barrier
    s_barrier
    s_branch p1Al3_done
p1Al3_retry:
    s_sub_u32 s55, s55, 1
    s_cmp_eq_u32 s55, 0
    s_cbranch_scc1 p1Al3_tok
    v_add_u32 v25, 64, v0
    v_lshrrev_b32 v26, 3, v25
    v_min_u32 v26, 11, v26
    s_mul_i32 s72, s53, 14
    v_add_u32 v26, s72, v26
    v_lshlrev_b32 v26, 9, v26
    v_and_b32 v25, 7, v25
    v_lshl_add_u32 v26, v25, 4, v26
    s_mov_b32 s72, 32768
    buffer_load_dwordx4 v[32:35], v26, s[44:47], s72 offen offset:0 sc1
    buffer_load_dwordx4 v[36:39], v26, s[44:47], s72 offen offset:128 sc1
    buffer_load_dwordx4 v[40:43], v26, s[44:47], s72 offen offset:256 sc1
    buffer_load_dwordx4 v[44:47], v26, s[44:47], s72 offen offset:384 sc1
    s_waitcnt vmcnt(0)
    v_cmp_eq_u32 vcc, s60, v34
    v_cmp_eq_u32 s[74:75], s61, v35
    s_and_b64 vcc, vcc, s[74:75]
    s_mov_b64 s[76:77], vcc
    v_cmp_eq_u32 vcc, s60, v38
    v_cmp_eq_u32 s[74:75], s61, v39
    s_and_b64 vcc, vcc, s[74:75]
    s_and_b64 s[76:77], s[76:77], vcc
    v_cmp_eq_u32 vcc, s60, v42
    v_cmp_eq_u32 s[74:75], s61, v43
    s_and_b64 vcc, vcc, s[74:75]
    s_and_b64 s[76:77], s[76:77], vcc
    v_cmp_eq_u32 vcc, s60, v46
    v_cmp_eq_u32 s[74:75], s61, v47
    s_and_b64 vcc, vcc, s[74:75]
    s_and_b64 s[76:77], s[76:77], vcc
    s_cmp_eq_u64 s[76:77], -1
    s_cbranch_scc0 p1Al3_retry
    s_branch p1Al3_tok
p1Al3_done:
    s_branch f_lr3
f_lB:
    s_cmp_lg_u32 s3, 8
    s_cbranch_scc1 f_lB1
    s_mul_i32 s68, s54, 224
    v_lshrrev_b32 v20, 4, v0
    v_add_u32 v20, 0, v20
    v_and_b32 v21, 7, v0
    v_xor_b32 v20, v20, v21
    v_and_b32 v20, 7, v20
    v_lshlrev_b32 v20, 4, v20
    v_lshrrev_b32 v21, 3, v0
    s_lshl_b32 s72, s52, 7
    s_add_u32 s72, s72, 0
    v_add_u32 v21, s72, v21
    v_mul_u32_u24 v9, 896, v21
    v_add_u32 v9, v9, v20
    v_add_u32 v20, 0, v0
    v_mul_u32_u24 v21, 2341, v20
    v_lshrrev_b32 v21, 16, v21
    v_mul_u32_u24 v22, 28, v21
    v_sub_u32 v22, v20, v22
    v_and_b32 v23, 3, v21
    v_lshrrev_b32 v20, 2, v21
    v_lshl_add_u32 v23, v20, 3, v23
    v_mul_u32_u24 v10, 3584, v23
    v_bfe_u32 v23, v21, 2, 1
    v_lshrrev_b32 v20, 1, v22
    v_xor_b32 v20, v20, v23
    v_lshl_add_u32 v10, v20, 5, v10
    v_mov_b32 v23, 1792
    v_mov_b32 v21, -224
    v_cmp_gt_u32 vcc, 7, v20
    s_nop 1
    v_cndmask_b32 v23, v21, v23, vcc
    v_add_u32 v10, v10, v23
    v_and_b32 v22, 1, v22
    v_lshl_add_u32 v10, v22, 4, v10
    v_add_u32 v10, s68, v10
    s_waitcnt lgkmcnt(0)
    s_mov_b32 s32, s8
    s_mov_b32 s33, s9
    s_mov_b32 s34, 0x1c0000
    s_mov_b32 s35, 0x20000
    s_mov_b32 s36, s16
    s_mov_b32 s37, s17
    s_mov_b32 s38, 0x188000
    s_mov_b32 s39, 0x20000
    s_mov_b32 s44, s28
    s_mov_b32 s45, s29
    s_mov_b32 s46, 0x1600000
    s_mov_b32 s47, 0x20000
    s_mov_b32 m0, 0
    s_mov_b32 s73, 0
    buffer_load_dwordx4 v9, s[32:35], s73 offen lds
    s_mov_b32 m0, 2048
    s_mov_b32 s73, 14336
    buffer_load_dwordx4 v9, s[32:35], s73 offen lds
    s_mov_b32 m0, 4096
    s_mov_b32 s73, 28672
    buffer_load_dwordx4 v9, s[32:35], s73 offen lds
    s_mov_b32 m0, 6144
    s_mov_b32 s73, 43008
    buffer_load_dwordx4 v9, s[32:35], s73 offen lds
    s_mov_b32 m0, 8192
    s_mov_b32 s73, 57344
    buffer_load_dwordx4 v9, s[32:35], s73 offen lds
    s_mov_b32 m0, 10240
    s_mov_b32 s73, 71680
    buffer_load_dwordx4 v9, s[32:35], s73 offen lds
    s_mov_b32 m0, 12288
    s_mov_b32 s73, 86016
    buffer_load_dwordx4 v9, s[32:35], s73 offen lds
    s_mov_b32 m0, 14336
    s_mov_b32 s73, 100352
    buffer_load_dwordx4 v9, s[32:35], s73 offen lds
    s_mov_b32 m0, 55296
    s_mov_b32 s73, 0
    buffer_load_dwordx4 v10, s[36:39], s73 offen lds
    s_mov_b32 m0, 62464
    s_mov_b32 s73, 14336
    buffer_load_dwordx4 v10, s[36:39], s73 offen lds
    s_mov_b32 m0, 69632
    s_mov_b32 s73, 114688
    buffer_load_dwordx4 v10, s[36:39], s73 offen lds
    s_mov_b32 m0, 16384
    s_mov_b32 s73, 128
    buffer_load_dwordx4 v9, s[32:35], s73 offen lds
    s_mov_b32 m0, 18432
    s_mov_b32 s73, 14464
    buffer_load_dwordx4 v9, s[32:35], s73 offen lds
    s_mov_b32 m0, 20480
    s_mov_b32 s73, 28800
    buffer_load_dwordx4 v9, s[32:35], s73 offen lds
    s_mov_b32 m0, 22528
    s_mov_b32 s73, 43136
    buffer_load_dwordx4 v9, s[32:35], s73 offen lds
    s_mov_b32 m0, 24576
    s_mov_b32 s73, 57472
    buffer_load_dwordx4 v9, s[32:35], s73 offen lds
    s_mov_b32 m0, 26624
    s_mov_b32 s73, 71808
    buffer_load_dwordx4 v9, s[32:35], s73 offen lds
    s_mov_b32 m0, 28672
    s_mov_b32 s73, 86144
    buffer_load_dwordx4 v9, s[32:35], s73 offen lds
    s_mov_b32 m0, 30720
    s_mov_b32 s73, 100480
    buffer_load_dwordx4 v9, s[32:35], s73 offen lds
    s_mov_b32 m0, 83968
    s_mov_b32 s73, 229376
    buffer_load_dwordx4 v10, s[36:39], s73 offen lds
    s_mov_b32 m0, 91136
    s_mov_b32 s73, 243712
    buffer_load_dwordx4 v10, s[36:39], s73 offen lds
    s_mov_b32 m0, 98304
    s_mov_b32 s73, 344064
    buffer_load_dwordx4 v10, s[36:39], s73 offen lds
    s_waitcnt vmcnt(11)
    s_barrier
    s_mov_b32 m0, 32768
    s_mov_b32 s73, 256
    buffer_load_dwordx4 v9, s[32:35], s73 offen lds
    s_mov_b32 m0, 34816
    s_mov_b32 s73, 14592
    buffer_load_dwordx4 v9, s[32:35], s73 offen lds
    s_mov_b32 m0, 36864
    s_mov_b32 s73, 28928
    buffer_load_dwordx4 v9, s[32:35], s73 offen lds
    s_mov_b32 m0, 38912
    s_mov_b32 s73, 43264
    buffer_load_dwordx4 v9, s[32:35], s73 offen lds
    s_mov_b32 m0, 40960
    s_mov_b32 s73, 57600
    buffer_load_dwordx4 v9, s[32:35], s73 offen lds
    s_mov_b32 m0, 43008
    s_mov_b32 s73, 71936
    buffer_load_dwordx4 v9, s[32:35], s73 offen lds
    s_mov_b32 m0, 45056
    s_mov_b32 s73, 86272
    buffer_load_dwordx4 v9, s[32:35], s73 offen lds
    s_mov_b32 m0, 47104
    s_mov_b32 s73, 100608
    buffer_load_dwordx4 v9, s[32:35], s73 offen lds
    s_mov_b32 m0, 112640
    s_mov_b32 s73, 458752
    buffer_load_dwordx4 v10, s[36:39], s73 offen lds
    s_mov_b32 m0, 119808
    s_mov_b32 s73, 473088
    buffer_load_dwordx4 v10, s[36:39], s73 offen lds
    s_mov_b32 m0, 126976
    s_mov_b32 s73, 573440
    buffer_load_dwordx4 v10, s[36:39], s73 offen lds
    s_mov_b32 s55, 40000
    s_waitcnt vmcnt(11)
    s_barrier
    v_mov_b32 v24, 155648
    ds_read_b64 v[26:27], v24
    s_waitcnt lgkmcnt(0)
    v_readfirstlane_b32 s60, v26
    v_readfirstlane_b32 s61, v27
    s_mov_b32 m0, 0
    s_mov_b32 s73, 384
    buffer_load_dwordx4 v9, s[32:35], s73 offen lds
    s_mov_b32 m0, 2048
    s_mov_b32 s73, 14720
    buffer_load_dwordx4 v9, s[32:35], s73 offen lds
    s_mov_b32 m0, 4096
    s_mov_b32 s73, 29056
    buffer_load_dwordx4 v9, s[32:35], s73 offen lds
    s_mov_b32 m0, 6144
    s_mov_b32 s73, 43392
    buffer_load_dwordx4 v9, s[32:35], s73 offen lds
    s_mov_b32 m0, 8192
    s_mov_b32 s73, 57728
    buffer_load_dwordx4 v9, s[32:35], s73 offen lds
    s_mov_b32 m0, 10240
    s_mov_b32 s73, 72064
    buffer_load_dwordx4 v9, s[32:35], s73 offen lds
    s_mov_b32 m0, 12288
    s_mov_b32 s73, 86400
    buffer_load_dwordx4 v9, s[32:35], s73 offen lds
    s_mov_b32 m0, 14336
    s_mov_b32 s73, 100736
    buffer_load_dwordx4 v9, s[32:35], s73 offen lds
    s_mov_b32 m0, 55296
    s_mov_b32 s73, 688128
    buffer_load_dwordx4 v10, s[36:39], s73 offen lds
    s_mov_b32 m0, 62464
    s_mov_b32 s73, 702464
    buffer_load_dwordx4 v10, s[36:39], s73 offen lds
    s_mov_b32 m0, 69632
    s_mov_b32 s73, 802816
    buffer_load_dwordx4 v10, s[36:39], s73 offen lds
    s_waitcnt vmcnt(11)
    s_barrier
    s_mov_b32 m0, 16384
    s_mov_b32 s73, 512
    buffer_load_dwordx4 v9, s[32:35], s73 offen lds
    s_mov_b32 m0, 18432
    s_mov_b32 s73, 14848
    buffer_load_dwordx4 v9, s[32:35], s73 offen lds
    s_mov_b32 m0, 20480
    s_mov_b32 s73, 29184
    buffer_load_dwordx4 v9, s[32:35], s73 offen lds
    s_mov_b32 m0, 22528
    s_mov_b32 s73, 43520
    buffer_load_dwordx4 v9, s[32:35], s73 offen lds
    s_mov_b32 m0, 24576
    s_mov_b32 s73, 57856
    buffer_load_dwordx4 v9, s[32:35], s73 offen lds
    s_mov_b32 m0, 26624
    s_mov_b32 s73, 72192
    buffer_load_dwordx4 v9, s[32:35], s73 offen lds
    s_mov_b32 m0, 28672
    s_mov_b32 s73, 86528
    buffer_load_dwordx4 v9, s[32:35], s73 offen lds
    s_mov_b32 m0, 30720
    s_mov_b32 s73, 100864
    buffer_load_dwordx4 v9, s[32:35], s73 offen lds
    s_mov_b32 m0, 83968
    s_mov_b32 s73, 917504
    buffer_load_dwordx4 v10, s[36:39], s73 offen lds
    s_mov_b32 m0, 91136
    s_mov_b32 s73, 931840
    buffer_load_dwordx4 v10, s[36:39], s73 offen lds
    s_mov_b32 m0, 98304
    s_mov_b32 s73, 1032192
    buffer_load_dwordx4 v10, s[36:39], s73 offen lds
    s_waitcnt vmcnt(11)
    s_barrier
    s_mov_b32 m0, 32768
    s_mov_b32 s73, 640
    buffer_load_dwordx4 v9, s[32:35], s73 offen lds
    s_mov_b32 m0, 34816
    s_mov_b32 s73, 14976
    buffer_load_dwordx4 v9, s[32:35], s73 offen lds
    s_mov_b32 m0, 36864
    s_mov_b32 s73, 29312
    buffer_load_dwordx4 v9, s[32:35], s73 offen lds
    s_mov_b32 m0, 38912
    s_mov_b32 s73, 43648
    buffer_load_dwordx4 v9, s[32:35], s73 offen lds
    s_mov_b32 m0, 40960
    s_mov_b32 s73, 57984
    buffer_load_dwordx4 v9, s[32:35], s73 offen lds
    s_mov_b32 m0, 43008
    s_mov_b32 s73, 72320
    buffer_load_dwordx4 v9, s[32:35], s73 offen lds
    s_mov_b32 m0, 45056
    s_mov_b32 s73, 86656
    buffer_load_dwordx4 v9, s[32:35], s73 offen lds
    s_mov_b32 m0, 47104
    s_mov_b32 s73, 100992
    buffer_load_dwordx4 v9, s[32:35], s73 offen lds
    s_mov_b32 m0, 112640
    s_mov_b32 s73, 1146880
    buffer_load_dwordx4 v10, s[36:39], s73 offen lds
    s_mov_b32 m0, 119808
    s_mov_b32 s73, 1161216
    buffer_load_dwordx4 v10, s[36:39], s73 offen lds
    s_mov_b32 m0, 126976
    s_mov_b32 s73, 1261568
    buffer_load_dwordx4 v10, s[36:39], s73 offen lds
    s_waitcnt vmcnt(11)
    s_barrier
    s_lshl_b32 s72, s52, 7
    s_add_u32 s72, s72, 0
    v_add_u32 v24, s72, v0
    v_subrev_u32 v24, 16, v24
    v_max_i32 v24, 0, v24
    v_lshlrev_b32 v24, 4, v24
    buffer_load_dwordx4 v[28:31], v24, s[44:47], 0 offen sc1
    s_mov_b32 m0, 0
    s_mov_b32 s73, 768
    buffer_load_dwordx4 v9, s[32:35], s73 offen lds
    s_mov_b32 m0, 2048
    s_mov_b32 s73, 15104
    buffer_load_dwordx4 v9, s[32:35], s73 offen lds
    s_mov_b32 m0, 4096
    s_mov_b32 s73, 29440
    buffer_load_dwordx4 v9, s[32:35], s73 offen lds
    s_mov_b32 m0, 6144
    s_mov_b32 s73, 43776
    buffer_load_dwordx4 v9, s[32:35], s73 offen lds
    s_mov_b32 m0, 8192
    s_mov_b32 s73, 58112
    buffer_load_dwordx4 v9, s[32:35], s73 offen lds
    s_mov_b32 m0, 10240
    s_mov_b32 s73, 72448
    buffer_load_dwordx4 v9, s[32:35], s73 offen lds
    s_mov_b32 m0, 12288
    s_mov_b32 s73, 86784
    buffer_load_dwordx4 v9, s[32:35], s73 offen lds
    s_mov_b32 m0, 14336
    s_mov_b32 s73, 101120
    buffer_load_dwordx4 v9, s[32:35], s73 offen lds
    s_mov_b32 m0, 55296
    s_mov_b32 s73, 1376256
    buffer_load_dwordx4 v10, s[36:39], s73 offen lds
    s_mov_b32 m0, 62464
    s_mov_b32 s73, 1390592
    buffer_load_dwordx4 v10, s[36:39], s73 offen lds
    s_mov_b32 m0, 69632
    s_mov_b32 s73, 1490944
    buffer_load_dwordx4 v10, s[36:39], s73 offen lds
    s_waitcnt vmcnt(11)
    v_cmp_eq_u32 vcc, s60, v30
    v_cmp_eq_u32 s[74:75], s61, v31
    s_and_b64 vcc, vcc, s[74:75]
    s_mov_b64 s[76:77], vcc
    s_cmp_eq_u64 s[76:77], -1
    s_cbranch_scc0 p1Bl0_retry
p1Bl0_tok:
    v_lshlrev_b32 v24, 2, v0
    v_add_u32 v24, 153600, v24
    ds_write_b32 v24, v28
    ds_write_b32 v24, v29 offset:576
    s_waitcnt lgkmcnt(0)
    s_barrier
    s_mov_b32 s32, s22
    s_mov_b32 s33, s23
    s_mov_b32 s34, 0xc4000
    s_mov_b32 s35, 0x20000
    v_lshrrev_b32 v48, 3, v0
    v_mul_u32_u24 v48, 896, v48
    v_bfe_u32 v20, v0, 1, 2
    v_lshrrev_b32 v21, 4, v0
    v_xor_b32 v20, v20, v21
    v_lshl_add_u32 v48, v20, 5, v48
    v_and_b32 v20, 1, v0
    v_lshl_add_u32 v48, v20, 4, v48
    s_lshl_b32 s72, s30, 7
    v_add_u32 v48, s72, v48
    s_cmp_ge_u32 s30, 7
    s_mov_b32 s72, 0
    s_cselect_b32 s72, 0x7ff00000, s72
    v_add_u32 v48, s72, v48
    s_mov_b32 s73, 0
    buffer_load_dwordx4 v[52:55], v48, s[32:35], s73 offen
    s_mov_b32 s73, 7168
    buffer_load_dwordx4 v[56:59], v48, s[32:35], s73 offen
    s_mov_b32 s73, 14336
    buffer_load_dwordx4 v[60:63], v48, s[32:35], s73 offen
    s_mov_b32 s73, 21504
    buffer_load_dwordx4 v[64:67], v48, s[32:35], s73 offen
    s_mov_b32 s73, 28672
    buffer_load_dwordx4 v[68:71], v48, s[32:35], s73 offen
    s_mov_b32 s73, 35840
    buffer_load_dwordx4 v[72:75], v48, s[32:35], s73 offen
    s_mov_b32 s73, 43008
    buffer_load_dwordx4 v[76:79], v48, s[32:35], s73 offen
    s_mov_b32 s73, 50176
    buffer_load_dwordx4 v[80:83], v48, s[32:35], s73 offen
    s_mov_b32 s73, 57344
    buffer_load_dwordx4 v[84:87], v48, s[32:35], s73 offen
    s_mov_b32 s73, 64512
    buffer_load_dwordx4 v[88:91], v48, s[32:35], s73 offen
    s_mov_b32 s73, 71680
    buffer_load_dwordx4 v[92:95], v48, s[32:35], s73 offen
    s_mov_b32 s73, 78848
    buffer_load_dwordx4 v[96:99], v48, s[32:35], s73 offen
    s_waitcnt vmcnt(12)
    s_barrier
    s_mov_b32 s73, 86016
    buffer_load_dwordx4 v[100:103], v48, s[32:35], s73 offen
    s_mov_b32 s73, 93184
    buffer_load_dwordx4 v[104:107], v48, s[32:35], s73 offen
    s_mov_b32 s73, 100352
    buffer_load_dwordx4 v[108:111], v48, s[32:35], s73 offen
    s_mov_b32 s73, 107520
    buffer_load_dwordx4 v[112:115], v48, s[32:35], s73 offen
    s_mov_b32 s73, 114688
    buffer_load_dwordx4 v[116:119], v48, s[32:35], s73 offen
    s_mov_b32 s73, 121856
    buffer_load_dwordx4 v[120:123], v48, s[32:35], s73 offen
    s_mov_b32 s73, 129024
    buffer_load_dwordx4 v[124:127], v48, s[32:35], s73 offen
    s_mov_b32 s73, 136192
    buffer_load_dwordx4 v[128:131], v48, s[32:35], s73 offen
    s_mov_b32 s73, 143360
    buffer_load_dwordx4 v[132:135], v48, s[32:35], s73 offen
    s_mov_b32 s73, 150528
    buffer_load_dwordx4 v[136:139], v48, s[32:35], s73 offen
    s_mov_b32 s73, 157696
    buffer_load_dwordx4 v[140:143], v48, s[32:35], s73 offen
    s_mov_b32 s73, 164864
    buffer_load_dwordx4 v[144:147], v48, s[32:35], s73 offen
    s_barrier
    s_mov_b32 s73, 172032
    buffer_load_dwordx4 v[148:151], v48, s[32:35], s73 offen
    s_mov_b32 s73, 179200
    buffer_load_dwordx4 v[152:155], v48, s[32:35], s73 offen
    s_mov_b32 s73, 186368
    buffer_load_dwordx4 v[156:159], v48, s[32:35], s73 offen
    s_mov_b32 s73, 193536
    buffer_load_dwordx4 v[160:163], v48, s[32:35], s73 offen
    s_branch p1Bl0_done
p1Bl0_retry:
    s_sub_u32 s55, s55, 1
    s_cmp_eq_u32 s55, 0
    s_cbranch_scc1 p1Bl0_tok
    s_lshl_b32 s72, s52, 7
    s_add_u32 s72, s72, 0
    v_add_u32 v24, s72, v0
    v_subrev_u32 v24, 16, v24
    v_max_i32 v24, 0, v24
    v_lshlrev_b32 v24, 4, v24
    buffer_load_dwordx4 v[28:31], v24, s[44:47], 0 offen sc1
    s_waitcnt vmcnt(0)
    v_cmp_eq_u32 vcc, s60, v30
    v_cmp_eq_u32 s[74:75], s61, v31
    s_and_b64 vcc, vcc, s[74:75]
    s_mov_b64 s[76:77], vcc
    s_cmp_eq_u64 s[76:77], -1
    s_cbranch_scc0 p1Bl0_retry
    s_branch p1Bl0_tok
p1Bl0_done:
    s_branch f_lr0
f_lB1:
    s_cmp_lg_u32 s3, 9
    s_cbranch_scc1 f_lB2
    s_mul_i32 s68, s54, 224
    v_lshrrev_b32 v20, 4, v0
    v_add_u32 v20, 4, v20
    v_and_b32 v21, 7, v0
    v_xor_b32 v20, v20, v21
    v_and_b32 v20, 7, v20
    v_lshlrev_b32 v20, 4, v20
    v_lshrrev_b32 v21, 3, v0
    s_lshl_b32 s72, s52, 7
    s_add_u32 s72, s72, 8
    v_add_u32 v21, s72, v21
    v_mul_u32_u24 v9, 896, v21
    v_add_u32 v9, v9, v20
    v_add_u32 v20, 64, v0
    v_mul_u32_u24 v21, 2341, v20
    v_lshrrev_b32 v21, 16, v21
    v_mul_u32_u24 v22, 28, v21
    v_sub_u32 v22, v20, v22
    v_and_b32 v23, 3, v21
    v_lshrrev_b32 v20, 2, v21
    v_lshl_add_u32 v23, v20, 3, v23
    v_mul_u32_u24 v10, 3584, v23
    v_bfe_u32 v23, v21, 2, 1
    v_lshrrev_b32 v20, 1, v22
    v_xor_b32 v20, v20, v23
    v_lshl_add_u32 v10, v20, 5, v10
    v_mov_b32 v23, 1792
    v_mov_b32 v21, -224
    v_cmp_gt_u32 vcc, 7, v20
    s_nop 1
    v_cndmask_b32 v23, v21, v23, vcc
    v_add_u32 v10, v10, v23
    v_and_b32 v22, 1, v22
    v_lshl_add_u32 v10, v22, 4, v10
    v_add_u32 v10, s68, v10
    s_waitcnt lgkmcnt(0)
    s_mov_b32 s32, s8
    s_mov_b32 s33, s9
    s_mov_b32 s34, 0x1c0000
    s_mov_b32 s35, 0x20000
    s_mov_b32 s36, s16
    s_mov_b32 s37, s17
    s_mov_b32 s38, 0x188000
    s_mov_b32 s39, 0x20000
    s_mov_b32 s44, s28
    s_mov_b32 s45, s29
    s_mov_b32 s46, 0x1600000
    s_mov_b32 s47, 0x20000
    s_mov_b32 m0, 1024
    s_mov_b32 s73, 0
    buffer_load_dwordx4 v9, s[32:35], s73 offen lds
    s_mov_b32 m0, 3072
    s_mov_b32 s73, 14336
    buffer_load_dwordx4 v9, s[32:35], s73 offen lds
    s_mov_b32 m0, 5120
    s_mov_b32 s73, 28672
    buffer_load_dwordx4 v9, s[32:35], s73 offen lds
    s_mov_b32 m0, 7168
    s_mov_b32 s73, 43008
    buffer_load_dwordx4 v9, s[32:35], s73 offen lds
    s_mov_b32 m0, 9216
    s_mov_b32 s73, 57344
    buffer_load_dwordx4 v9, s[32:35], s73 offen lds
    s_mov_b32 m0, 11264
    s_mov_b32 s73, 71680
    buffer_load_dwordx4 v9, s[32:35], s73 offen lds
    s_mov_b32 m0, 13312
    s_mov_b32 s73, 86016
    buffer_load_dwordx4 v9, s[32:35], s73 offen lds
    s_mov_b32 m0, 15360
    s_mov_b32 s73, 100352
    buffer_load_dwordx4 v9, s[32:35], s73 offen lds
    s_mov_b32 m0, 56320
    s_mov_b32 s73, 0
    buffer_load_dwordx4 v10, s[36:39], s73 offen lds
    s_mov_b32 m0, 63488
    s_mov_b32 s73, 14336
    buffer_load_dwordx4 v10, s[36:39], s73 offen lds
    s_mov_b32 m0, 70656
    s_mov_b32 s73, 114688
    buffer_load_dwordx4 v10, s[36:39], s73 offen lds
    s_mov_b32 m0, 17408
    s_mov_b32 s73, 128
    buffer_load_dwordx4 v9, s[32:35], s73 offen lds
    s_mov_b32 m0, 19456
    s_mov_b32 s73, 14464
    buffer_load_dwordx4 v9, s[32:35], s73 offen lds
    s_mov_b32 m0, 21504
    s_mov_b32 s73, 28800
    buffer_load_dwordx4 v9, s[32:35], s73 offen lds
    s_mov_b32 m0, 23552
    s_mov_b32 s73, 43136
    buffer_load_dwordx4 v9, s[32:35], s73 offen lds
    s_mov_b32 m0, 25600
    s_mov_b32 s73, 57472
    buffer_load_dwordx4 v9, s[32:35], s73 offen lds
    s_mov_b32 m0, 27648
    s_mov_b32 s73, 71808
    buffer_load_dwordx4 v9, s[32:35], s73 offen lds
    s_mov_b32 m0, 29696
    s_mov_b32 s73, 86144
    buffer_load_dwordx4 v9, s[32:35], s73 offen lds
    s_mov_b32 m0, 31744
    s_mov_b32 s73, 100480
    buffer_load_dwordx4 v9, s[32:35], s73 offen lds
    s_mov_b32 m0, 84992
    s_mov_b32 s73, 229376
    buffer_load_dwordx4 v10, s[36:39], s73 offen lds
    s_mov_b32 m0, 92160
    s_mov_b32 s73, 243712
    buffer_load_dwordx4 v10, s[36:39], s73 offen lds
    s_mov_b32 m0, 99328
    s_mov_b32 s73, 344064
    buffer_load_dwordx4 v10, s[36:39], s73 offen lds
    s_waitcnt vmcnt(11)
    s_barrier
    s_mov_b32 m0, 33792
    s_mov_b32 s73, 256
    buffer_load_dwordx4 v9, s[32:35], s73 offen lds
    s_mov_b32 m0, 35840
    s_mov_b32 s73, 14592
    buffer_load_dwordx4 v9, s[32:35], s73 offen lds
    s_mov_b32 m0, 37888
    s_mov_b32 s73, 28928
    buffer_load_dwordx4 v9, s[32:35], s73 offen lds
    s_mov_b32 m0, 39936
    s_mov_b32 s73, 43264
    buffer_load_dwordx4 v9, s[32:35], s73 offen lds
    s_mov_b32 m0, 41984
    s_mov_b32 s73, 57600
    buffer_load_dwordx4 v9, s[32:35], s73 offen lds
    s_mov_b32 m0, 44032
    s_mov_b32 s73, 71936
    buffer_load_dwordx4 v9, s[32:35], s73 offen lds
    s_mov_b32 m0, 46080
    s_mov_b32 s73, 86272
    buffer_load_dwordx4 v9, s[32:35], s73 offen lds
    s_mov_b32 m0, 48128
    s_mov_b32 s73, 100608
    buffer_load_dwordx4 v9, s[32:35], s73 offen lds
    s_mov_b32 m0, 113664
    s_mov_b32 s73, 458752
    buffer_load_dwordx4 v10, s[36:39], s73 offen lds
    s_mov_b32 m0, 120832
    s_mov_b32 s73, 473088
    buffer_load_dwordx4 v10, s[36:39], s73 offen lds
    s_mov_b32 m0, 128000
    s_mov_b32 s73, 573440
    buffer_load_dwordx4 v10, s[36:39], s73 offen lds
    s_mov_b32 s55, 40000
    s_waitcnt vmcnt(11)
    s_barrier
    v_mov_b32 v24, 155648
    ds_read_b64 v[26:27], v24
    s_waitcnt lgkmcnt(0)
    v_readfirstlane_b32 s60, v26
    v_readfirstlane_b32 s61, v27
    s_mov_b32 m0, 1024
    s_mov_b32 s73, 384
    buffer_load_dwordx4 v9, s[32:35], s73 offen lds
    s_mov_b32 m0, 3072
    s_mov_b32 s73, 14720
    buffer_load_dwordx4 v9, s[32:35], s73 offen lds
    s_mov_b32 m0, 5120
    s_mov_b32 s73, 29056
    buffer_load_dwordx4 v9, s[32:35], s73 offen lds
    s_mov_b32 m0, 7168
    s_mov_b32 s73, 43392
    buffer_load_dwordx4 v9, s[32:35], s73 offen lds
    s_mov_b32 m0, 9216
    s_mov_b32 s73, 57728
    buffer_load_dwordx4 v9, s[32:35], s73 offen lds
    s_mov_b32 m0, 11264
    s_mov_b32 s73, 72064
    buffer_load_dwordx4 v9, s[32:35], s73 offen lds
    s_mov_b32 m0, 13312
    s_mov_b32 s73, 86400
    buffer_load_dwordx4 v9, s[32:35], s73 offen lds
    s_mov_b32 m0, 15360
    s_mov_b32 s73, 100736
    buffer_load_dwordx4 v9, s[32:35], s73 offen lds
    s_mov_b32 m0, 56320
    s_mov_b32 s73, 688128
    buffer_load_dwordx4 v10, s[36:39], s73 offen lds
    s_mov_b32 m0, 63488
    s_mov_b32 s73, 702464
    buffer_load_dwordx4 v10, s[36:39], s73 offen lds
    s_mov_b32 m0, 70656
    s_mov_b32 s73, 802816
    buffer_load_dwordx4 v10, s[36:39], s73 offen lds
    s_waitcnt vmcnt(11)
    s_barrier
    s_mov_b32 m0, 17408
    s_mov_b32 s73, 512
    buffer_load_dwordx4 v9, s[32:35], s73 offen lds
    s_mov_b32 m0, 19456
    s_mov_b32 s73, 14848
    buffer_load_dwordx4 v9, s[32:35], s73 offen lds
    s_mov_b32 m0, 21504
    s_mov_b32 s73, 29184
    buffer_load_dwordx4 v9, s[32:35], s73 offen lds
    s_mov_b32 m0, 23552
    s_mov_b32 s73, 43520
    buffer_load_dwordx4 v9, s[32:35], s73 offen lds
    s_mov_b32 m0, 25600
    s_mov_b32 s73, 57856
    buffer_load_dwordx4 v9, s[32:35], s73 offen lds
    s_mov_b32 m0, 27648
    s_mov_b32 s73, 72192
    buffer_load_dwordx4 v9, s[32:35], s73 offen lds
    s_mov_b32 m0, 29696
    s_mov_b32 s73, 86528
    buffer_load_dwordx4 v9, s[32:35], s73 offen lds
    s_mov_b32 m0, 31744
    s_mov_b32 s73, 100864
    buffer_load_dwordx4 v9, s[32:35], s73 offen lds
    s_mov_b32 m0, 84992
    s_mov_b32 s73, 917504
    buffer_load_dwordx4 v10, s[36:39], s73 offen lds
    s_mov_b32 m0, 92160
    s_mov_b32 s73, 931840
    buffer_load_dwordx4 v10, s[36:39], s73 offen lds
    s_mov_b32 m0, 99328
    s_mov_b32 s73, 1032192
    buffer_load_dwordx4 v10, s[36:39], s73 offen lds
    s_waitcnt vmcnt(11)
    s_barrier
    s_mov_b32 m0, 33792
    s_mov_b32 s73, 640
    buffer_load_dwordx4 v9, s[32:35], s73 offen lds
    s_mov_b32 m0, 35840
    s_mov_b32 s73, 14976
    buffer_load_dwordx4 v9, s[32:35], s73 offen lds
    s_mov_b32 m0, 37888
    s_mov_b32 s73, 29312
    buffer_load_dwordx4 v9, s[32:35], s73 offen lds
    s_mov_b32 m0, 39936
    s_mov_b32 s73, 43648
    buffer_load_dwordx4 v9, s[32:35], s73 offen lds
    s_mov_b32 m0, 41984
    s_mov_b32 s73, 57984
    buffer_load_dwordx4 v9, s[32:35], s73 offen lds
    s_mov_b32 m0, 44032
    s_mov_b32 s73, 72320
    buffer_load_dwordx4 v9, s[32:35], s73 offen lds
    s_mov_b32 m0, 46080
    s_mov_b32 s73, 86656
    buffer_load_dwordx4 v9, s[32:35], s73 offen lds
    s_mov_b32 m0, 48128
    s_mov_b32 s73, 100992
    buffer_load_dwordx4 v9, s[32:35], s73 offen lds
    s_mov_b32 m0, 113664
    s_mov_b32 s73, 1146880
    buffer_load_dwordx4 v10, s[36:39], s73 offen lds
    s_mov_b32 m0, 120832
    s_mov_b32 s73, 1161216
    buffer_load_dwordx4 v10, s[36:39], s73 offen lds
    s_mov_b32 m0, 128000
    s_mov_b32 s73, 1261568
    buffer_load_dwordx4 v10, s[36:39], s73 offen lds
    s_waitcnt vmcnt(11)
    s_barrier
    s_lshl_b32 s72, s52, 7
    s_add_u32 s72, s72, 64
    v_add_u32 v24, s72, v0
    v_subrev_u32 v24, 16, v24
    v_max_i32 v24, 0, v24
    v_lshlrev_b32 v24, 4, v24
    buffer_load_dwordx4 v[28:31], v24, s[44:47], 0 offen sc1
    s_mov_b32 m0, 1024
    s_mov_b32 s73, 768
    buffer_load_dwordx4 v9, s[32:35], s73 offen lds
    s_mov_b32 m0, 3072
    s_mov_b32 s73, 15104
    buffer_load_dwordx4 v9, s[32:35], s73 offen lds
    s_mov_b32 m0, 5120
    s_mov_b32 s73, 29440
    buffer_load_dwordx4 v9, s[32:35], s73 offen lds
    s_mov_b32 m0, 7168
    s_mov_b32 s73, 43776
    buffer_load_dwordx4 v9, s[32:35], s73 offen lds
    s_mov_b32 m0, 9216
    s_mov_b32 s73, 58112
    buffer_load_dwordx4 v9, s[32:35], s73 offen lds
    s_mov_b32 m0, 11264
    s_mov_b32 s73, 72448
    buffer_load_dwordx4 v9, s[32:35], s73 offen lds
    s_mov_b32 m0, 13312
    s_mov_b32 s73, 86784
    buffer_load_dwordx4 v9, s[32:35], s73 offen lds
    s_mov_b32 m0, 15360
    s_mov_b32 s73, 101120
    buffer_load_dwordx4 v9, s[32:35], s73 offen lds
    s_mov_b32 m0, 56320
    s_mov_b32 s73, 1376256
    buffer_load_dwordx4 v10, s[36:39], s73 offen lds
    s_mov_b32 m0, 63488
    s_mov_b32 s73, 1390592
    buffer_load_dwordx4 v10, s[36:39], s73 offen lds
    s_mov_b32 m0, 70656
    s_mov_b32 s73, 1490944
    buffer_load_dwordx4 v10, s[36:39], s73 offen lds
    s_waitcnt vmcnt(11)
    v_cmp_eq_u32 vcc, s60, v30
    v_cmp_eq_u32 s[74:75], s61, v31
    s_and_b64 vcc, vcc, s[74:75]
    s_mov_b64 s[76:77], vcc
    s_cmp_eq_u64 s[76:77], -1
    s_cbranch_scc0 p1Bl1_retry
p1Bl1_tok:
    v_lshlrev_b32 v24, 2, v0
    v_add_u32 v24, 153856, v24
    ds_write_b32 v24, v28
    ds_write_b32 v24, v29 offset:576
    s_waitcnt lgkmcnt(0)
    s_barrier
    s_mov_b32 s32, s22
    s_mov_b32 s33, s23
    s_mov_b32 s34, 0xc4000
    s_mov_b32 s35, 0x20000
    v_lshrrev_b32 v48, 3, v0
    v_mul_u32_u24 v48, 896, v48
    v_bfe_u32 v20, v0, 1, 2
    v_lshrrev_b32 v21, 4, v0
    v_xor_b32 v20, v20, v21
    v_lshl_add_u32 v48, v20, 5, v48
    v_and_b32 v20, 1, v0
    v_lshl_add_u32 v48, v20, 4, v48
    s_lshl_b32 s72, s30, 7
    v_add_u32 v48, s72, v48
    s_cmp_ge_u32 s30, 7
    s_mov_b32 s72, 0
    s_cselect_b32 s72, 0x7ff00000, s72
    v_add_u32 v48, s72, v48
    s_mov_b32 s73, 200704
    buffer_load_dwordx4 v[52:55], v48, s[32:35], s73 offen
    s_mov_b32 s73, 207872
    buffer_load_dwordx4 v[56:59], v48, s[32:35], s73 offen
    s_mov_b32 s73, 215040
    buffer_load_dwordx4 v[60:63], v48, s[32:35], s73 offen
    s_mov_b32 s73, 222208
    buffer_load_dwordx4 v[64:67], v48, s[32:35], s73 offen
    s_mov_b32 s73, 229376
    buffer_load_dwordx4 v[68:71], v48, s[32:35], s73 offen
    s_mov_b32 s73, 236544
    buffer_load_dwordx4 v[72:75], v48, s[32:35], s73 offen
    s_mov_b32 s73, 243712
    buffer_load_dwordx4 v[76:79], v48, s[32:35], s73 offen
    s_mov_b32 s73, 250880
    buffer_load_dwordx4 v[80:83], v48, s[32:35], s73 offen
    s_mov_b32 s73, 258048
    buffer_load_dwordx4 v[84:87], v48, s[32:35], s73 offen
    s_mov_b32 s73, 265216
    buffer_load_dwordx4 v[88:91], v48, s[32:35], s73 offen
    s_mov_b32 s73, 272384
    buffer_load_dwordx4 v[92:95], v48, s[32:35], s73 offen
    s_mov_b32 s73, 279552
    buffer_load_dwordx4 v[96:99], v48, s[32:35], s73 offen
    s_waitcnt vmcnt(12)
    s_barrier
    s_mov_b32 s73, 286720
    buffer_load_dwordx4 v[100:103], v48, s[32:35], s73 offen
    s_mov_b32 s73, 293888
    buffer_load_dwordx4 v[104:107], v48, s[32:35], s73 offen
    s_mov_b32 s73, 301056
    buffer_load_dwordx4 v[108:111], v48, s[32:35], s73 offen
    s_mov_b32 s73, 308224
    buffer_load_dwordx4 v[112:115], v48, s[32:35], s73 offen
    s_mov_b32 s73, 315392
    buffer_load_dwordx4 v[116:119], v48, s[32:35], s73 offen
    s_mov_b32 s73, 322560
    buffer_load_dwordx4 v[120:123], v48, s[32:35], s73 offen
    s_mov_b32 s73, 329728
    buffer_load_dwordx4 v[124:127], v48, s[32:35], s73 offen
    s_mov_b32 s73, 336896
    buffer_load_dwordx4 v[128:131], v48, s[32:35], s73 offen
    s_mov_b32 s73, 344064
    buffer_load_dwordx4 v[132:135], v48, s[32:35], s73 offen
    s_mov_b32 s73, 351232
    buffer_load_dwordx4 v[136:139], v48, s[32:35], s73 offen
    s_mov_b32 s73, 358400
    buffer_load_dwordx4 v[140:143], v48, s[32:35], s73 offen
    s_mov_b32 s73, 365568
    buffer_load_dwordx4 v[144:147], v48, s[32:35], s73 offen
    s_barrier
    s_mov_b32 s73, 372736
    buffer_load_dwordx4 v[148:151], v48, s[32:35], s73 offen
    s_mov_b32 s73, 379904
    buffer_load_dwordx4 v[152:155], v48, s[32:35], s73 offen
    s_mov_b32 s73, 387072
    buffer_load_dwordx4 v[156:159], v48, s[32:35], s73 offen
    s_mov_b32 s73, 394240
    buffer_load_dwordx4 v[160:163], v48, s[32:35], s73 offen
    s_branch p1Bl1_done
p1Bl1_retry:
    s_sub_u32 s55, s55, 1
    s_cmp_eq_u32 s55, 0
    s_cbranch_scc1 p1Bl1_tok
    s_lshl_b32 s72, s52, 7
    s_add_u32 s72, s72, 64
    v_add_u32 v24, s72, v0
    v_subrev_u32 v24, 16, v24
    v_max_i32 v24, 0, v24
    v_lshlrev_b32 v24, 4, v24
    buffer_load_dwordx4 v[28:31], v24, s[44:47], 0 offen sc1
    s_waitcnt vmcnt(0)
    v_cmp_eq_u32 vcc, s60, v30
    v_cmp_eq_u32 s[74:75], s61, v31
    s_and_b64 vcc, vcc, s[74:75]
    s_mov_b64 s[76:77], vcc
    s_cmp_eq_u64 s[76:77], -1
    s_cbranch_scc0 p1Bl1_retry
    s_branch p1Bl1_tok
p1Bl1_done:
    s_branch f_lr1
f_lB2:
    s_cmp_lg_u32 s3, 10
    s_cbranch_scc1 f_lB3
    s_mul_i32 s68, s54, 224
    v_add_u32 v20, 128, v0
    v_mul_u32_u24 v21, 2341, v20
    v_lshrrev_b32 v21, 16, v21
    v_mul_u32_u24 v22, 28, v21
    v_sub_u32 v22, v20, v22
    v_and_b32 v23, 3, v21
    v_lshrrev_b32 v20, 2, v21
    v_lshl_add_u32 v23, v20, 3, v23
    v_mul_u32_u24 v8, 3584, v23
    v_bfe_u32 v23, v21, 2, 1
    v_lshrrev_b32 v20, 1, v22
    v_xor_b32 v20, v20, v23
    v_lshl_add_u32 v8, v20, 5, v8
    v_mov_b32 v23, 1792
    v_mov_b32 v21, -224
    v_cmp_gt_u32 vcc, 7, v20
    s_nop 1
    v_cndmask_b32 v23, v21, v23, vcc
    v_add_u32 v8, v8, v23
    v_and_b32 v22, 1, v22
    v_lshl_add_u32 v8, v22, 4, v8
    v_add_u32 v8, s68, v8
    v_add_u32 v20, 192, v0
    v_mul_u32_u24 v21, 2341, v20
    v_lshrrev_b32 v21, 16, v21
    v_mul_u32_u24 v22, 28, v21
    v_sub_u32 v22, v20, v22
    v_and_b32 v23, 3, v21
    v_lshrrev_b32 v20, 2, v21
    v_lshl_add_u32 v23, v20, 3, v23
    v_mul_u32_u24 v9, 3584, v23
    v_bfe_u32 v23, v21, 2, 1
    v_lshrrev_b32 v20, 1, v22
    v_xor_b32 v20, v20, v23
    v_lshl_add_u32 v9, v20, 5, v9
    v_mov_b32 v23, 1792
    v_mov_b32 v21, -224
    v_cmp_gt_u32 vcc, 7, v20
    s_nop 1
    v_cndmask_b32 v23, v21, v23, vcc
    v_add_u32 v9, v9, v23
    v_and_b32 v22, 1, v22
    v_lshl_add_u32 v9, v22, 4, v9
    v_add_u32 v9, s68, v9
    v_add_u32 v20, 0, v0
    v_mul_u32_u24 v21, 2341, v20
    v_lshrrev_b32 v21, 16, v21
    v_mul_u32_u24 v22, 28, v21
    v_sub_u32 v22, v20, v22
    v_and_b32 v23, 3, v21
    v_lshrrev_b32 v20, 2, v21
    v_lshl_add_u32 v23, v20, 3, v23
    v_mul_u32_u24 v10, 3584, v23
    v_bfe_u32 v23, v21, 2, 1
    v_lshrrev_b32 v20, 1, v22
    v_xor_b32 v20, v20, v23
    v_lshl_add_u32 v10, v20, 5, v10
    v_mov_b32 v23, 1792
    v_mov_b32 v21, -224
    v_cmp_gt_u32 vcc, 7, v20
    s_nop 1
    v_cndmask_b32 v23, v21, v23, vcc
    v_add_u32 v10, v10, v23
    v_and_b32 v22, 1, v22
    v_lshl_add_u32 v10, v22, 4, v10
    v_add_u32 v10, s68, v10
    v_add_u32 v20, 64, v0
    v_mul_u32_u24 v21, 2341, v20
    v_lshrrev_b32 v21, 16, v21
    v_mul_u32_u24 v22, 28, v21
    v_sub_u32 v22, v20, v22
    v_and_b32 v23, 3, v21
    v_lshrrev_b32 v20, 2, v21
    v_lshl_add_u32 v23, v20, 3, v23
    v_mul_u32_u24 v11, 3584, v23
    v_bfe_u32 v23, v21, 2, 1
    v_lshrrev_b32 v20, 1, v22
    v_xor_b32 v20, v20, v23
    v_lshl_add_u32 v11, v20, 5, v11
    v_mov_b32 v23, 1792
    v_mov_b32 v21, -224
    v_cmp_gt_u32 vcc, 7, v20
    s_nop 1
    v_cndmask_b32 v23, v21, v23, vcc
    v_add_u32 v11, v11, v23
    v_and_b32 v22, 1, v22
    v_lshl_add_u32 v11, v22, 4, v11
    v_add_u32 v11, s68, v11
    v_add_u32 v20, 384, v0
    v_mul_u32_u24 v21, 2341, v20
    v_lshrrev_b32 v21, 16, v21
    v_mul_u32_u24 v22, 28, v21
    v_sub_u32 v22, v20, v22
    v_and_b32 v23, 3, v21
    v_lshrrev_b32 v20, 2, v21
    v_lshl_add_u32 v23, v20, 3, v23
    v_mul_u32_u24 v12, 3584, v23
    v_bfe_u32 v23, v21, 2, 1
    v_lshrrev_b32 v20, 1, v22
    v_xor_b32 v20, v20, v23
    v_lshl_add_u32 v12, v20, 5, v12
    v_mov_b32 v23, 1792
    v_mov_b32 v21, -224
    v_cmp_gt_u32 vcc, 7, v20
    s_nop 1
    v_cndmask_b32 v23, v21, v23, vcc
    v_add_u32 v12, v12, v23
    v_and_b32 v22, 1, v22
    v_lshl_add_u32 v12, v22, 4, v12
    v_add_u32 v12, s68, v12
    s_waitcnt lgkmcnt(0)
    s_mov_b32 s32, s8
    s_mov_b32 s33, s9
    s_mov_b32 s34, 0x1c0000
    s_mov_b32 s35, 0x20000
    s_mov_b32 s36, s16
    s_mov_b32 s37, s17
    s_mov_b32 s38, 0x188000
    s_mov_b32 s39, 0x20000
    s_mov_b32 s44, s28
    s_mov_b32 s45, s29
    s_mov_b32 s46, 0x1600000
    s_mov_b32 s47, 0x20000
    s_mov_b32 m0, 57344
    s_mov_b32 s73, 0
    buffer_load_dwordx4 v8, s[36:39], s73 offen lds
    s_mov_b32 m0, 64512
    s_mov_b32 s73, 14336
    buffer_load_dwordx4 v8, s[36:39], s73 offen lds
    s_mov_b32 m0, 71680
    s_mov_b32 s73, 114688
    buffer_load_dwordx4 v8, s[36:39], s73 offen lds
    s_mov_b32 m0, 78848
    s_mov_b32 s73, 129024
    buffer_load_dwordx4 v8, s[36:39], s73 offen lds
    s_mov_b32 m0, 58368
    s_mov_b32 s73, 0
    buffer_load_dwordx4 v9, s[36:39], s73 offen lds
    s_mov_b32 m0, 65536
    s_mov_b32 s73, 14336
    buffer_load_dwordx4 v9, s[36:39], s73 offen lds
    s_mov_b32 m0, 72704
    s_mov_b32 s73, 114688
    buffer_load_dwordx4 v9, s[36:39], s73 offen lds
    s_mov_b32 m0, 79872
    s_mov_b32 s73, 129024
    buffer_load_dwordx4 v9, s[36:39], s73 offen lds
    s_mov_b32 m0, 76800
    s_mov_b32 s73, 129024
    buffer_load_dwordx4 v10, s[36:39], s73 offen lds
    s_mov_b32 m0, 77824
    s_mov_b32 s73, 129024
    buffer_load_dwordx4 v11, s[36:39], s73 offen lds
    s_mov_b32 m0, 61440
    s_mov_b32 s73, 0
    buffer_load_dwordx4 v12, s[36:39], s73 offen lds
    s_mov_b32 m0, 86016
    s_mov_b32 s73, 229376
    buffer_load_dwordx4 v8, s[36:39], s73 offen lds
    s_mov_b32 m0, 93184
    s_mov_b32 s73, 243712
    buffer_load_dwordx4 v8, s[36:39], s73 offen lds
    s_mov_b32 m0, 100352
    s_mov_b32 s73, 344064
    buffer_load_dwordx4 v8, s[36:39], s73 offen lds
    s_mov_b32 m0, 107520
    s_mov_b32 s73, 358400
    buffer_load_dwordx4 v8, s[36:39], s73 offen lds
    s_mov_b32 m0, 87040
    s_mov_b32 s73, 229376
    buffer_load_dwordx4 v9, s[36:39], s73 offen lds
    s_mov_b32 m0, 94208
    s_mov_b32 s73, 243712
    buffer_load_dwordx4 v9, s[36:39], s73 offen lds
    s_mov_b32 m0, 101376
    s_mov_b32 s73, 344064
    buffer_load_dwordx4 v9, s[36:39], s73 offen lds
    s_mov_b32 m0, 108544
    s_mov_b32 s73, 358400
    buffer_load_dwordx4 v9, s[36:39], s73 offen lds
    s_mov_b32 m0, 105472
    s_mov_b32 s73, 358400
    buffer_load_dwordx4 v10, s[36:39], s73 offen lds
    s_mov_b32 m0, 106496
    s_mov_b32 s73, 358400
    buffer_load_dwordx4 v11, s[36:39], s73 offen lds
    s_mov_b32 m0, 90112
    s_mov_b32 s73, 229376
    buffer_load_dwordx4 v12, s[36:39], s73 offen lds
    s_waitcnt vmcnt(11)
    s_barrier
    s_mov_b32 m0, 114688
    s_mov_b32 s73, 458752
    buffer_load_dwordx4 v8, s[36:39], s73 offen lds
    s_mov_b32 m0, 121856
    s_mov_b32 s73, 473088
    buffer_load_dwordx4 v8, s[36:39], s73 offen lds
    s_mov_b32 m0, 129024
    s_mov_b32 s73, 573440
    buffer_load_dwordx4 v8, s[36:39], s73 offen lds
    s_mov_b32 m0, 136192
    s_mov_b32 s73, 587776
    buffer_load_dwordx4 v8, s[36:39], s73 offen lds
    s_mov_b32 m0, 115712
    s_mov_b32 s73, 458752
    buffer_load_dwordx4 v9, s[36:39], s73 offen lds
    s_mov_b32 m0, 122880
    s_mov_b32 s73, 473088
    buffer_load_dwordx4 v9, s[36:39], s73 offen lds
    s_mov_b32 m0, 130048
    s_mov_b32 s73, 573440
    buffer_load_dwordx4 v9, s[36:39], s73 offen lds
    s_mov_b32 m0, 137216
    s_mov_b32 s73, 587776
    buffer_load_dwordx4 v9, s[36:39], s73 offen lds
    s_mov_b32 m0, 134144
    s_mov_b32 s73, 587776
    buffer_load_dwordx4 v10, s[36:39], s73 offen lds
    s_mov_b32 m0, 135168
    s_mov_b32 s73, 587776
    buffer_load_dwordx4 v11, s[36:39], s73 offen lds
    s_mov_b32 m0, 118784
    s_mov_b32 s73, 458752
    buffer_load_dwordx4 v12, s[36:39], s73 offen lds
    s_mov_b32 s55, 40000
    s_waitcnt vmcnt(11)
    s_barrier
    v_mov_b32 v24, 155648
    ds_read_b64 v[26:27], v24
    s_waitcnt lgkmcnt(0)
    v_readfirstlane_b32 s60, v26
    v_readfirstlane_b32 s61, v27
    s_mov_b32 m0, 57344
    s_mov_b32 s73, 688128
    buffer_load_dwordx4 v8, s[36:39], s73 offen lds
    s_mov_b32 m0, 64512
    s_mov_b32 s73, 702464
    buffer_load_dwordx4 v8, s[36:39], s73 offen lds
    s_mov_b32 m0, 71680
    s_mov_b32 s73, 802816
    buffer_load_dwordx4 v8, s[36:39], s73 offen lds
    s_mov_b32 m0, 78848
    s_mov_b32 s73, 817152
    buffer_load_dwordx4 v8, s[36:39], s73 offen lds
    s_mov_b32 m0, 58368
    s_mov_b32 s73, 688128
    buffer_load_dwordx4 v9, s[36:39], s73 offen lds
    s_mov_b32 m0, 65536
    s_mov_b32 s73, 702464
    buffer_load_dwordx4 v9, s[36:39], s73 offen lds
    s_mov_b32 m0, 72704
    s_mov_b32 s73, 802816
    buffer_load_dwordx4 v9, s[36:39], s73 offen lds
    s_mov_b32 m0, 79872
    s_mov_b32 s73, 817152
    buffer_load_dwordx4 v9, s[36:39], s73 offen lds
    s_mov_b32 m0, 76800
    s_mov_b32 s73, 817152
    buffer_load_dwordx4 v10, s[36:39], s73 offen lds
    s_mov_b32 m0, 77824
    s_mov_b32 s73, 817152
    buffer_load_dwordx4 v11, s[36:39], s73 offen lds
    s_mov_b32 m0, 61440
    s_mov_b32 s73, 688128
    buffer_load_dwordx4 v12, s[36:39], s73 offen lds
    s_waitcnt vmcnt(11)
    s_barrier
    s_mov_b32 m0, 86016
    s_mov_b32 s73, 917504
    buffer_load_dwordx4 v8, s[36:39], s73 offen lds
    s_mov_b32 m0, 93184
    s_mov_b32 s73, 931840
    buffer_load_dwordx4 v8, s[36:39], s73 offen lds
    s_mov_b32 m0, 100352
    s_mov_b32 s73, 1032192
    buffer_load_dwordx4 v8, s[36:39], s73 offen lds
    s_mov_b32 m0, 107520
    s_mov_b32 s73, 1046528
    buffer_load_dwordx4 v8, s[36:39], s73 offen lds
    s_mov_b32 m0, 87040
    s_mov_b32 s73, 917504
    buffer_load_dwordx4 v9, s[36:39], s73 offen lds
    s_mov_b32 m0, 94208
    s_mov_b32 s73, 931840
    buffer_load_dwordx4 v9, s[36:39], s73 offen lds
    s_mov_b32 m0, 101376
    s_mov_b32 s73, 1032192
    buffer_load_dwordx4 v9, s[36:39], s73 offen lds
    s_mov_b32 m0, 108544
    s_mov_b32 s73, 1046528
    buffer_load_dwordx4 v9, s[36:39], s73 offen lds
    s_mov_b32 m0, 105472
    s_mov_b32 s73, 1046528
    buffer_load_dwordx4 v10, s[36:39], s73 offen lds
    s_mov_b32 m0, 106496
    s_mov_b32 s73, 1046528
    buffer_load_dwordx4 v11, s[36:39], s73 offen lds
    s_mov_b32 m0, 90112
    s_mov_b32 s73, 917504
    buffer_load_dwordx4 v12, s[36:39], s73 offen lds
    s_waitcnt vmcnt(11)
    s_barrier
    s_mov_b32 m0, 114688
    s_mov_b32 s73, 1146880
    buffer_load_dwordx4 v8, s[36:39], s73 offen lds
    s_mov_b32 m0, 121856
    s_mov_b32 s73, 1161216
    buffer_load_dwordx4 v8, s[36:39], s73 offen lds
    s_mov_b32 m0, 129024
    s_mov_b32 s73, 1261568
    buffer_load_dwordx4 v8, s[36:39], s73 offen lds
    s_mov_b32 m0, 136192
    s_mov_b32 s73, 1275904
    buffer_load_dwordx4 v8, s[36:39], s73 offen lds
    s_mov_b32 m0, 115712
    s_mov_b32 s73, 1146880
    buffer_load_dwordx4 v9, s[36:39], s73 offen lds
    s_mov_b32 m0, 122880
    s_mov_b32 s73, 1161216
    buffer_load_dwordx4 v9, s[36:39], s73 offen lds
    s_mov_b32 m0, 130048
    s_mov_b32 s73, 1261568
    buffer_load_dwordx4 v9, s[36:39], s73 offen lds
    s_mov_b32 m0, 137216
    s_mov_b32 s73, 1275904
    buffer_load_dwordx4 v9, s[36:39], s73 offen lds
    s_mov_b32 m0, 134144
    s_mov_b32 s73, 1275904
    buffer_load_dwordx4 v10, s[36:39], s73 offen lds
    s_mov_b32 m0, 135168
    s_mov_b32 s73, 1275904
    buffer_load_dwordx4 v11, s[36:39], s73 offen lds
    s_mov_b32 m0, 118784
    s_mov_b32 s73, 1146880
    buffer_load_dwordx4 v12, s[36:39], s73 offen lds
    s_waitcnt vmcnt(11)
    s_barrier
    s_lshl_b32 s72, s52, 7
    s_add_u32 s72, s72, 128
    v_add_u32 v24, s72, v0
    v_subrev_u32 v24, 16, v24
    v_max_i32 v24, 0, v24
    v_lshlrev_b32 v24, 4, v24
    s_lshl_b32 s72, s52, 7
    s_add_u32 s72, s72, 127
    s_lshl_b32 s72, s72, 4
    v_min_u32 v24, s72, v24
    buffer_load_dwordx4 v[28:31], v24, s[44:47], 0 offen sc1
    v_add_u32 v25, 0, v0
    v_lshrrev_b32 v26, 3, v25
    v_min_u32 v26, 13, v26
    s_mul_i32 s72, s53, 14
    v_add_u32 v26, s72, v26
    v_lshlrev_b32 v26, 9, v26
    v_and_b32 v25, 7, v25
    v_lshl_add_u32 v26, v25, 4, v26
    s_mov_b32 s72, 32768
    buffer_load_dwordx4 v[32:35], v26, s[44:47], s72 offen offset:0 sc1
    buffer_load_dwordx4 v[36:39], v26, s[44:47], s72 offen offset:128 sc1
    buffer_load_dwordx4 v[40:43], v26, s[44:47], s72 offen offset:256 sc1
    buffer_load_dwordx4 v[44:47], v26, s[44:47], s72 offen offset:384 sc1
    s_mov_b32 m0, 57344
    s_mov_b32 s73, 1376256
    buffer_load_dwordx4 v8, s[36:39], s73 offen lds
    s_mov_b32 m0, 64512
    s_mov_b32 s73, 1390592
    buffer_load_dwordx4 v8, s[36:39], s73 offen lds
    s_mov_b32 m0, 71680
    s_mov_b32 s73, 1490944
    buffer_load_dwordx4 v8, s[36:39], s73 offen lds
    s_mov_b32 m0, 78848
    s_mov_b32 s73, 1505280
    buffer_load_dwordx4 v8, s[36:39], s73 offen lds
    s_mov_b32 m0, 58368
    s_mov_b32 s73, 1376256
    buffer_load_dwordx4 v9, s[36:39], s73 offen lds
    s_mov_b32 m0, 65536
    s_mov_b32 s73, 1390592
    buffer_load_dwordx4 v9, s[36:39], s73 offen lds
    s_mov_b32 m0, 72704
    s_mov_b32 s73, 1490944
    buffer_load_dwordx4 v9, s[36:39], s73 offen lds
    s_mov_b32 m0, 79872
    s_mov_b32 s73, 1505280
    buffer_load_dwordx4 v9, s[36:39], s73 offen lds
    s_mov_b32 m0, 76800
    s_mov_b32 s73, 1505280
    buffer_load_dwordx4 v10, s[36:39], s73 offen lds
    s_mov_b32 m0, 77824
    s_mov_b32 s73, 1505280
    buffer_load_dwordx4 v11, s[36:39], s73 offen lds
    s_mov_b32 m0, 61440
    s_mov_b32 s73, 1376256
    buffer_load_dwordx4 v12, s[36:39], s73 offen lds
    s_waitcnt vmcnt(11)
    v_cmp_eq_u32 vcc, s60, v30
    v_cmp_eq_u32 s[74:75], s61, v31
    s_and_b64 vcc, vcc, s[74:75]
    s_mov_b64 s[76:77], vcc
    v_cmp_eq_u32 vcc, s60, v34
    v_cmp_eq_u32 s[74:75], s61, v35
    s_and_b64 vcc, vcc, s[74:75]
    s_and_b64 s[76:77], s[76:77], vcc
    v_cmp_eq_u32 vcc, s60, v38
    v_cmp_eq_u32 s[74:75], s61, v39
    s_and_b64 vcc, vcc, s[74:75]
    s_and_b64 s[76:77], s[76:77], vcc
    v_cmp_eq_u32 vcc, s60, v42
    v_cmp_eq_u32 s[74:75], s61, v43
    s_and_b64 vcc, vcc, s[74:75]
    s_and_b64 s[76:77], s[76:77], vcc
    v_cmp_eq_u32 vcc, s60, v46
    v_cmp_eq_u32 s[74:75], s61, v47
    s_and_b64 vcc, vcc, s[74:75]
    s_and_b64 s[76:77], s[76:77], vcc
    s_cmp_eq_u64 s[76:77], -1
    s_cbranch_scc0 p1Bl2_retry
p1Bl2_tok:
    v_lshlrev_b32 v24, 2, v0
    v_add_u32 v24, 154112, v24
    s_mov_b64 exec, 0xffff
    ds_write_b32 v24, v28
    ds_write_b32 v24, v29 offset:576
    s_mov_b64 exec, -1
    v_pk_add_f32 v[32:33], v[32:33], v[36:37]
    v_pk_add_f32 v[40:41], v[40:41], v[44:45]
    v_pk_add_f32 v[32:33], v[32:33], v[40:41]
    v_lshlrev_b32 v24, 3, v0
    v_add_u32 v24, 154752, v24
    ds_write_b64 v24, v[32:33]
    s_waitcnt lgkmcnt(0)
    s_barrier
    s_mov_b32 s32, s22
    s_mov_b32 s33, s23
    s_mov_b32 s34, 0xc4000
    s_mov_b32 s35, 0x20000
    v_lshrrev_b32 v48, 3, v0
    v_mul_u32_u24 v48, 896, v48
    v_bfe_u32 v20, v0, 1, 2
    v_lshrrev_b32 v21, 4, v0
    v_xor_b32 v20, v20, v21
    v_lshl_add_u32 v48, v20, 5, v48
    v_and_b32 v20, 1, v0
    v_lshl_add_u32 v48, v20, 4, v48
    s_lshl_b32 s72, s30, 7
    v_add_u32 v48, s72, v48
    s_cmp_ge_u32 s30, 7
    s_mov_b32 s72, 0
    s_cselect_b32 s72, 0x7ff00000, s72
    v_add_u32 v48, s72, v48
    s_mov_b32 s73, 401408
    buffer_load_dwordx4 v[52:55], v48, s[32:35], s73 offen
    s_mov_b32 s73, 408576
    buffer_load_dwordx4 v[56:59], v48, s[32:35], s73 offen
    s_mov_b32 s73, 415744
    buffer_load_dwordx4 v[60:63], v48, s[32:35], s73 offen
    s_mov_b32 s73, 422912
    buffer_load_dwordx4 v[64:67], v48, s[32:35], s73 offen
    s_mov_b32 s73, 430080
    buffer_load_dwordx4 v[68:71], v48, s[32:35], s73 offen
    s_mov_b32 s73, 437248
    buffer_load_dwordx4 v[72:75], v48, s[32:35], s73 offen
    s_mov_b32 s73, 444416
    buffer_load_dwordx4 v[76:79], v48, s[32:35], s73 offen
    s_mov_b32 s73, 451584
    buffer_load_dwordx4 v[80:83], v48, s[32:35], s73 offen
    s_mov_b32 s73, 458752
    buffer_load_dwordx4 v[84:87], v48, s[32:35], s73 offen
    s_mov_b32 s73, 465920
    buffer_load_dwordx4 v[88:91], v48, s[32:35], s73 offen
    s_mov_b32 s73, 473088
    buffer_load_dwordx4 v[92:95], v48, s[32:35], s73 offen
    s_mov_b32 s73, 480256
    buffer_load_dwordx4 v[96:99], v48, s[32:35], s73 offen
    s_waitcnt vmcnt(12)
    s_barrier
    s_mov_b32 s73, 487424
    buffer_load_dwordx4 v[100:103], v48, s[32:35], s73 offen
    s_mov_b32 s73, 494592
    buffer_load_dwordx4 v[104:107], v48, s[32:35], s73 offen
    s_mov_b32 s73, 501760
    buffer_load_dwordx4 v[108:111], v48, s[32:35], s73 offen
    s_mov_b32 s73, 508928
    buffer_load_dwordx4 v[112:115], v48, s[32:35], s73 offen
    s_mov_b32 s73, 516096
    buffer_load_dwordx4 v[116:119], v48, s[32:35], s73 offen
    s_mov_b32 s73, 523264
    buffer_load_dwordx4 v[120:123], v48, s[32:35], s73 offen
    s_mov_b32 s73, 530432
    buffer_load_dwordx4 v[124:127], v48, s[32:35], s73 offen
    s_mov_b32 s73, 537600
    buffer_load_dwordx4 v[128:131], v48, s[32:35], s73 offen
    s_mov_b32 s73, 544768
    buffer_load_dwordx4 v[132:135], v48, s[32:35], s73 offen
    s_mov_b32 s73, 551936
    buffer_load_dwordx4 v[136:139], v48, s[32:35], s73 offen
    s_mov_b32 s73, 559104
    buffer_load_dwordx4 v[140:143], v48, s[32:35], s73 offen
    s_mov_b32 s73, 566272
    buffer_load_dwordx4 v[144:147], v48, s[32:35], s73 offen
    s_barrier
    s_mov_b32 s73, 573440
    buffer_load_dwordx4 v[148:151], v48, s[32:35], s73 offen
    s_mov_b32 s73, 580608
    buffer_load_dwordx4 v[152:155], v48, s[32:35], s73 offen
    s_mov_b32 s73, 587776
    buffer_load_dwordx4 v[156:159], v48, s[32:35], s73 offen
    s_mov_b32 s73, 594944
    buffer_load_dwordx4 v[160:163], v48, s[32:35], s73 offen
    s_branch p1Bl2_done
p1Bl2_retry:
    s_sub_u32 s55, s55, 1
    s_cmp_eq_u32 s55, 0
    s_cbranch_scc1 p1Bl2_tok
    s_lshl_b32 s72, s52, 7
    s_add_u32 s72, s72, 128
    v_add_u32 v24, s72, v0
    v_subrev_u32 v24, 16, v24
    v_max_i32 v24, 0, v24
    v_lshlrev_b32 v24, 4, v24
    s_lshl_b32 s72, s52, 7
    s_add_u32 s72, s72, 127
    s_lshl_b32 s72, s72, 4
    v_min_u32 v24, s72, v24
    buffer_load_dwordx4 v[28:31], v24, s[44:47], 0 offen sc1
    v_add_u32 v25, 0, v0
    v_lshrrev_b32 v26, 3, v25
    v_min_u32 v26, 13, v26
    s_mul_i32 s72, s53, 14
    v_add_u32 v26, s72, v26
    v_lshlrev_b32 v26, 9, v26
    v_and_b32 v25, 7, v25
    v_lshl_add_u32 v26, v25, 4, v26
    s_mov_b32 s72, 32768
    buffer_load_dwordx4 v[32:35], v26, s[44:47], s72 offen offset:0 sc1
    buffer_load_dwordx4 v[36:39], v26, s[44:47], s72 offen offset:128 sc1
    buffer_load_dwordx4 v[40:43], v26, s[44:47], s72 offen offset:256 sc1
    buffer_load_dwordx4 v[44:47], v26, s[44:47], s72 offen offset:384 sc1
    s_waitcnt vmcnt(0)
    v_cmp_eq_u32 vcc, s60, v30
    v_cmp_eq_u32 s[74:75], s61, v31
    s_and_b64 vcc, vcc, s[74:75]
    s_mov_b64 s[76:77], vcc
    v_cmp_eq_u32 vcc, s60, v34
    v_cmp_eq_u32 s[74:75], s61, v35
    s_and_b64 vcc, vcc, s[74:75]
    s_and_b64 s[76:77], s[76:77], vcc
    v_cmp_eq_u32 vcc, s60, v38
    v_cmp_eq_u32 s[74:75], s61, v39
    s_and_b64 vcc, vcc, s[74:75]
    s_and_b64 s[76:77], s[76:77], vcc
    v_cmp_eq_u32 vcc, s60, v42
    v_cmp_eq_u32 s[74:75], s61, v43
    s_and_b64 vcc, vcc, s[74:75]
    s_and_b64 s[76:77], s[76:77], vcc
    v_cmp_eq_u32 vcc, s60, v46
    v_cmp_eq_u32 s[74:75], s61, v47
    s_and_b64 vcc, vcc, s[74:75]
    s_and_b64 s[76:77], s[76:77], vcc
    s_cmp_eq_u64 s[76:77], -1
    s_cbranch_scc0 p1Bl2_retry
    s_branch p1Bl2_tok
p1Bl2_done:
    s_branch f_lr2
f_lB3:
    s_mul_i32 s68, s54, 224
    v_add_u32 v20, 256, v0
    v_mul_u32_u24 v21, 2341, v20
    v_lshrrev_b32 v21, 16, v21
    v_mul_u32_u24 v22, 28, v21
    v_sub_u32 v22, v20, v22
    v_and_b32 v23, 3, v21
    v_lshrrev_b32 v20, 2, v21
    v_lshl_add_u32 v23, v20, 3, v23
    v_mul_u32_u24 v8, 3584, v23
    v_bfe_u32 v23, v21, 2, 1
    v_lshrrev_b32 v20, 1, v22
    v_xor_b32 v20, v20, v23
    v_lshl_add_u32 v8, v20, 5, v8
    v_mov_b32 v23, 1792
    v_mov_b32 v21, -224
    v_cmp_gt_u32 vcc, 7, v20
    s_nop 1
    v_cndmask_b32 v23, v21, v23, vcc
    v_add_u32 v8, v8, v23
    v_and_b32 v22, 1, v22
    v_lshl_add_u32 v8, v22, 4, v8
    v_add_u32 v8, s68, v8
    v_add_u32 v20, 320, v0
    v_mul_u32_u24 v21, 2341, v20
    v_lshrrev_b32 v21, 16, v21
    v_mul_u32_u24 v22, 28, v21
    v_sub_u32 v22, v20, v22
    v_and_b32 v23, 3, v21
    v_lshrrev_b32 v20, 2, v21
    v_lshl_add_u32 v23, v20, 3, v23
    v_mul_u32_u24 v9, 3584, v23
    v_bfe_u32 v23, v21, 2, 1
    v_lshrrev_b32 v20, 1, v22
    v_xor_b32 v20, v20, v23
    v_lshl_add_u32 v9, v20, 5, v9
    v_mov_b32 v23, 1792
    v_mov_b32 v21, -224
    v_cmp_gt_u32 vcc, 7, v20
    s_nop 1
    v_cndmask_b32 v23, v21, v23, vcc
    v_add_u32 v9, v9, v23
    v_and_b32 v22, 1, v22
    v_lshl_add_u32 v9, v22, 4, v9
    v_add_u32 v9, s68, v9
    v_add_u32 v20, 384, v0
    v_mul_u32_u24 v21, 2341, v20
    v_lshrrev_b32 v21, 16, v21
    v_mul_u32_u24 v22, 28, v21
    v_sub_u32 v22, v20, v22
    v_and_b32 v23, 3, v21
    v_lshrrev_b32 v20, 2, v21
    v_lshl_add_u32 v23, v20, 3, v23
    v_mul_u32_u24 v10, 3584, v23
    v_bfe_u32 v23, v21, 2, 1
    v_lshrrev_b32 v20, 1, v22
    v_xor_b32 v20, v20, v23
    v_lshl_add_u32 v10, v20, 5, v10
    v_mov_b32 v23, 1792
    v_mov_b32 v21, -224
    v_cmp_gt_u32 vcc, 7, v20
    s_nop 1
    v_cndmask_b32 v23, v21, v23, vcc
    v_add_u32 v10, v10, v23
    v_and_b32 v22, 1, v22
    v_lshl_add_u32 v10, v22, 4, v10
    v_add_u32 v10, s68, v10
    s_waitcnt lgkmcnt(0)
    s_mov_b32 s32, s8
    s_mov_b32 s33, s9
    s_mov_b32 s34, 0x1c0000
    s_mov_b32 s35, 0x20000
    s_mov_b32 s36, s16
    s_mov_b32 s37, s17
    s_mov_b32 s38, 0x188000
    s_mov_b32 s39, 0x20000
    s_mov_b32 s44, s28
    s_mov_b32 s45, s29
    s_mov_b32 s46, 0x1600000
    s_mov_b32 s47, 0x20000
    s_mov_b32 m0, 59392
    s_mov_b32 s73, 0
    buffer_load_dwordx4 v8, s[36:39], s73 offen lds
    s_mov_b32 m0, 66560
    s_mov_b32 s73, 14336
    buffer_load_dwordx4 v8, s[36:39], s73 offen lds
    s_mov_b32 m0, 73728
    s_mov_b32 s73, 114688
    buffer_load_dwordx4 v8, s[36:39], s73 offen lds
    s_mov_b32 m0, 80896
    s_mov_b32 s73, 129024
    buffer_load_dwordx4 v8, s[36:39], s73 offen lds
    s_mov_b32 m0, 60416
    s_mov_b32 s73, 0
    buffer_load_dwordx4 v9, s[36:39], s73 offen lds
    s_mov_b32 m0, 67584
    s_mov_b32 s73, 14336
    buffer_load_dwordx4 v9, s[36:39], s73 offen lds
    s_mov_b32 m0, 74752
    s_mov_b32 s73, 114688
    buffer_load_dwordx4 v9, s[36:39], s73 offen lds
    s_mov_b32 m0, 81920
    s_mov_b32 s73, 129024
    buffer_load_dwordx4 v9, s[36:39], s73 offen lds
    s_mov_b32 m0, 68608
    s_mov_b32 s73, 14336
    buffer_load_dwordx4 v10, s[36:39], s73 offen lds
    s_mov_b32 m0, 75776
    s_mov_b32 s73, 114688
    buffer_load_dwordx4 v10, s[36:39], s73 offen lds
    s_mov_b32 m0, 82944
    s_mov_b32 s73, 129024
    buffer_load_dwordx4 v10, s[36:39], s73 offen lds
    s_mov_b32 m0, 88064
    s_mov_b32 s73, 229376
    buffer_load_dwordx4 v8, s[36:39], s73 offen lds
    s_mov_b32 m0, 95232
    s_mov_b32 s73, 243712
    buffer_load_dwordx4 v8, s[36:39], s73 offen lds
    s_mov_b32 m0, 102400
    s_mov_b32 s73, 344064
    buffer_load_dwordx4 v8, s[36:39], s73 offen lds
    s_mov_b32 m0, 109568
    s_mov_b32 s73, 358400
    buffer_load_dwordx4 v8, s[36:39], s73 offen lds
    s_mov_b32 m0, 89088
    s_mov_b32 s73, 229376
    buffer_load_dwordx4 v9, s[36:39], s73 offen lds
    s_mov_b32 m0, 96256
    s_mov_b32 s73, 243712
    buffer_load_dwordx4 v9, s[36:39], s73 offen lds
    s_mov_b32 m0, 103424
    s_mov_b32 s73, 344064
    buffer_load_dwordx4 v9, s[36:39], s73 offen lds
    s_mov_b32 m0, 110592
    s_mov_b32 s73, 358400
    buffer_load_dwordx4 v9, s[36:39], s73 offen lds
    s_mov_b32 m0, 97280
    s_mov_b32 s73, 243712
    buffer_load_dwordx4 v10, s[36:39], s73 offen lds
    s_mov_b32 m0, 104448
    s_mov_b32 s73, 344064
    buffer_load_dwordx4 v10, s[36:39], s73 offen lds
    s_mov_b32 m0, 111616
    s_mov_b32 s73, 358400
    buffer_load_dwordx4 v10, s[36:39], s73 offen lds
    s_waitcnt vmcnt(11)
    s_barrier
    s_mov_b32 s48, s26
    s_mov_b32 s49, s27
    s_mov_b32 s50, 0x100
    s_mov_b32 s51, 0x20000
    v_mov_b32 v25, 0
    s_mov_b64 exec, 1
    buffer_load_dwordx2 v[26:27], v25, s[48:51], 0 offen sc1
    s_mov_b64 exec, -1
    s_mov_b32 m0, 116736
    s_mov_b32 s73, 458752
    buffer_load_dwordx4 v8, s[36:39], s73 offen lds
    s_mov_b32 m0, 123904
    s_mov_b32 s73, 473088
    buffer_load_dwordx4 v8, s[36:39], s73 offen lds
    s_mov_b32 m0, 131072
    s_mov_b32 s73, 573440
    buffer_load_dwordx4 v8, s[36:39], s73 offen lds
    s_mov_b32 m0, 138240
    s_mov_b32 s73, 587776
    buffer_load_dwordx4 v8, s[36:39], s73 offen lds
    s_mov_b32 m0, 117760
    s_mov_b32 s73, 458752
    buffer_load_dwordx4 v9, s[36:39], s73 offen lds
    s_mov_b32 m0, 124928
    s_mov_b32 s73, 473088
    buffer_load_dwordx4 v9, s[36:39], s73 offen lds
    s_mov_b32 m0, 132096
    s_mov_b32 s73, 573440
    buffer_load_dwordx4 v9, s[36:39], s73 offen lds
    s_mov_b32 m0, 139264
    s_mov_b32 s73, 587776
    buffer_load_dwordx4 v9, s[36:39], s73 offen lds
    s_mov_b32 m0, 125952
    s_mov_b32 s73, 473088
    buffer_load_dwordx4 v10, s[36:39], s73 offen lds
    s_mov_b32 m0, 133120
    s_mov_b32 s73, 573440
    buffer_load_dwordx4 v10, s[36:39], s73 offen lds
    s_mov_b32 m0, 140288
    s_mov_b32 s73, 587776
    buffer_load_dwordx4 v10, s[36:39], s73 offen lds
    s_mov_b32 s55, 40000
    s_waitcnt vmcnt(11)
    s_mov_b32 s74, 40000
p1Bl3_npl:
    v_readfirstlane_b32 s75, v26
    s_cmp_lg_u32 s75, 0
    s_cbranch_scc1 p1Bl3_nok
    s_sub_u32 s74, s74, 1
    s_cmp_eq_u32 s74, 0
    s_cbranch_scc1 p1Bl3_nok
    s_mov_b64 exec, 1
    buffer_load_dwordx2 v[26:27], v25, s[48:51], 0 offen sc1
    s_mov_b64 exec, -1
    s_waitcnt vmcnt(0)
    s_branch p1Bl3_npl
p1Bl3_nok:
    v_mov_b32 v24, 155648
    s_mov_b64 exec, 1
    ds_write_b64 v24, v[26:27]
    s_mov_b64 exec, -1
    s_waitcnt lgkmcnt(0)
    s_barrier
    v_mov_b32 v24, 155648
    ds_read_b64 v[26:27], v24
    s_waitcnt lgkmcnt(0)
    v_readfirstlane_b32 s60, v26
    v_readfirstlane_b32 s61, v27
    s_mov_b32 m0, 59392
    s_mov_b32 s73, 688128
    buffer_load_dwordx4 v8, s[36:39], s73 offen lds
    s_mov_b32 m0, 66560
    s_mov_b32 s73, 702464
    buffer_load_dwordx4 v8, s[36:39], s73 offen lds
    s_mov_b32 m0, 73728
    s_mov_b32 s73, 802816
    buffer_load_dwordx4 v8, s[36:39], s73 offen lds
    s_mov_b32 m0, 80896
    s_mov_b32 s73, 817152
    buffer_load_dwordx4 v8, s[36:39], s73 offen lds
    s_mov_b32 m0, 60416
    s_mov_b32 s73, 688128
    buffer_load_dwordx4 v9, s[36:39], s73 offen lds
    s_mov_b32 m0, 67584
    s_mov_b32 s73, 702464
    buffer_load_dwordx4 v9, s[36:39], s73 offen lds
    s_mov_b32 m0, 74752
    s_mov_b32 s73, 802816
    buffer_load_dwordx4 v9, s[36:39], s73 offen lds
    s_mov_b32 m0, 81920
    s_mov_b32 s73, 817152
    buffer_load_dwordx4 v9, s[36:39], s73 offen lds
    s_mov_b32 m0, 68608
    s_mov_b32 s73, 702464
    buffer_load_dwordx4 v10, s[36:39], s73 offen lds
    s_mov_b32 m0, 75776
    s_mov_b32 s73, 802816
    buffer_load_dwordx4 v10, s[36:39], s73 offen lds
    s_mov_b32 m0, 82944
    s_mov_b32 s73, 817152
    buffer_load_dwordx4 v10, s[36:39], s73 offen lds
    s_waitcnt vmcnt(11)
    s_barrier
    s_mov_b32 m0, 88064
    s_mov_b32 s73, 917504
    buffer_load_dwordx4 v8, s[36:39], s73 offen lds
    s_mov_b32 m0, 95232
    s_mov_b32 s73, 931840
    buffer_load_dwordx4 v8, s[36:39], s73 offen lds
    s_mov_b32 m0, 102400
    s_mov_b32 s73, 1032192
    buffer_load_dwordx4 v8, s[36:39], s73 offen lds
    s_mov_b32 m0, 109568
    s_mov_b32 s73, 1046528
    buffer_load_dwordx4 v8, s[36:39], s73 offen lds
    s_mov_b32 m0, 89088
    s_mov_b32 s73, 917504
    buffer_load_dwordx4 v9, s[36:39], s73 offen lds
    s_mov_b32 m0, 96256
    s_mov_b32 s73, 931840
    buffer_load_dwordx4 v9, s[36:39], s73 offen lds
    s_mov_b32 m0, 103424
    s_mov_b32 s73, 1032192
    buffer_load_dwordx4 v9, s[36:39], s73 offen lds
    s_mov_b32 m0, 110592
    s_mov_b32 s73, 1046528
    buffer_load_dwordx4 v9, s[36:39], s73 offen lds
    s_mov_b32 m0, 97280
    s_mov_b32 s73, 931840
    buffer_load_dwordx4 v10, s[36:39], s73 offen lds
    s_mov_b32 m0, 104448
    s_mov_b32 s73, 1032192
    buffer_load_dwordx4 v10, s[36:39], s73 offen lds
    s_mov_b32 m0, 111616
    s_mov_b32 s73, 1046528
    buffer_load_dwordx4 v10, s[36:39], s73 offen lds
    s_waitcnt vmcnt(11)
    s_barrier
    s_mov_b32 m0, 116736
    s_mov_b32 s73, 1146880
    buffer_load_dwordx4 v8, s[36:39], s73 offen lds
    s_mov_b32 m0, 123904
    s_mov_b32 s73, 1161216
    buffer_load_dwordx4 v8, s[36:39], s73 offen lds
    s_mov_b32 m0, 131072
    s_mov_b32 s73, 1261568
    buffer_load_dwordx4 v8, s[36:39], s73 offen lds
    s_mov_b32 m0, 138240
    s_mov_b32 s73, 1275904
    buffer_load_dwordx4 v8, s[36:39], s73 offen lds
    s_mov_b32 m0, 117760
    s_mov_b32 s73, 1146880
    buffer_load_dwordx4 v9, s[36:39], s73 offen lds
    s_mov_b32 m0, 124928
    s_mov_b32 s73, 1161216
    buffer_load_dwordx4 v9, s[36:39], s73 offen lds
    s_mov_b32 m0, 132096
    s_mov_b32 s73, 1261568
    buffer_load_dwordx4 v9, s[36:39], s73 offen lds
    s_mov_b32 m0, 139264
    s_mov_b32 s73, 1275904
    buffer_load_dwordx4 v9, s[36:39], s73 offen lds
    s_mov_b32 m0, 125952
    s_mov_b32 s73, 1161216
    buffer_load_dwordx4 v10, s[36:39], s73 offen lds
    s_mov_b32 m0, 133120
    s_mov_b32 s73, 1261568
    buffer_load_dwordx4 v10, s[36:39], s73 offen lds
    s_mov_b32 m0, 140288
    s_mov_b32 s73, 1275904
    buffer_load_dwordx4 v10, s[36:39], s73 offen lds
    s_waitcnt vmcnt(11)
    s_barrier
    v_add_u32 v25, 64, v0
    v_lshrrev_b32 v26, 3, v25
    v_min_u32 v26, 13, v26
    s_mul_i32 s72, s53, 14
    v_add_u32 v26, s72, v26
    v_lshlrev_b32 v26, 9, v26
    v_and_b32 v25, 7, v25
    v_lshl_add_u32 v26, v25, 4, v26
    s_mov_b32 s72, 32768
    buffer_load_dwordx4 v[32:35], v26, s[44:47], s72 offen offset:0 sc1
    buffer_load_dwordx4 v[36:39], v26, s[44:47], s72 offen offset:128 sc1
    buffer_load_dwordx4 v[40:43], v26, s[44:47], s72 offen offset:256 sc1
    buffer_load_dwordx4 v[44:47], v26, s[44:47], s72 offen offset:384 sc1
    s_mov_b32 m0, 59392
    s_mov_b32 s73, 1376256
    buffer_load_dwordx4 v8, s[36:39], s73 offen lds
    s_mov_b32 m0, 66560
    s_mov_b32 s73, 1390592
    buffer_load_dwordx4 v8, s[36:39], s73 offen lds
    s_mov_b32 m0, 73728
    s_mov_b32 s73, 1490944
    buffer_load_dwordx4 v8, s[36:39], s73 offen lds
    s_mov_b32 m0, 80896
    s_mov_b32 s73, 1505280
    buffer_load_dwordx4 v8, s[36:39], s73 offen lds
    s_mov_b32 m0, 60416
    s_mov_b32 s73, 1376256
    buffer_load_dwordx4 v9, s[36:39], s73 offen lds
    s_mov_b32 m0, 67584
    s_mov_b32 s73, 1390592
    buffer_load_dwordx4 v9, s[36:39], s73 offen lds
    s_mov_b32 m0, 74752
    s_mov_b32 s73, 1490944
    buffer_load_dwordx4 v9, s[36:39], s73 offen lds
    s_mov_b32 m0, 81920
    s_mov_b32 s73, 1505280
    buffer_load_dwordx4 v9, s[36:39], s73 offen lds
    s_mov_b32 m0, 68608
    s_mov_b32 s73, 1390592
    buffer_load_dwordx4 v10, s[36:39], s73 offen lds
    s_mov_b32 m0, 75776
    s_mov_b32 s73, 1490944
    buffer_load_dwordx4 v10, s[36:39], s73 offen lds
    s_mov_b32 m0, 82944
    s_mov_b32 s73, 1505280
    buffer_load_dwordx4 v10, s[36:39], s73 offen lds
    s_waitcnt vmcnt(11)
    v_cmp_eq_u32 vcc, s60, v34
    v_cmp_eq_u32 s[74:75], s61, v35
    s_and_b64 vcc, vcc, s[74:75]
    s_mov_b64 s[76:77], vcc
    v_cmp_eq_u32 vcc, s60, v38
    v_cmp_eq_u32 s[74:75], s61, v39
    s_and_b64 vcc, vcc, s[74:75]
    s_and_b64 s[76:77], s[76:77], vcc
    v_cmp_eq_u32 vcc, s60, v42
    v_cmp_eq_u32 s[74:75], s61, v43
    s_and_b64 vcc, vcc, s[74:75]
    s_and_b64 s[76:77], s[76:77], vcc
    v_cmp_eq_u32 vcc, s60, v46
    v_cmp_eq_u32 s[74:75], s61, v47
    s_and_b64 vcc, vcc, s[74:75]
    s_and_b64 s[76:77], s[76:77], vcc
    s_cmp_eq_u64 s[76:77], -1
    s_cbranch_scc0 p1Bl3_retry
p1Bl3_tok:
    v_pk_add_f32 v[32:33], v[32:33], v[36:37]
    v_pk_add_f32 v[40:41], v[40:41], v[44:45]
    v_pk_add_f32 v[32:33], v[32:33], v[40:41]
    v_lshlrev_b32 v24, 3, v0
    v_add_u32 v24, 155264, v24
    s_mov_b32 exec_hi, 0xffff
    ds_write_b64 v24, v[32:33]
    s_mov_b64 exec, -1
    s_waitcnt lgkmcnt(0)
    s_barrier
    s_mov_b32 s32, s22
    s_mov_b32 s33, s23
    s_mov_b32 s34, 0xc4000
    s_mov_b32 s35, 0x20000
    v_lshrrev_b32 v48, 3, v0
    v_mul_u32_u24 v48, 896, v48
    v_bfe_u32 v20, v0, 1, 2
    v_lshrrev_b32 v21, 4, v0
    v_xor_b32 v20, v20, v21
    v_lshl_add_u32 v48, v20, 5, v48
    v_and_b32 v20, 1, v0
    v_lshl_add_u32 v48, v20, 4, v48
    s_lshl_b32 s72, s30, 7
    v_add_u32 v48, s72, v48
    s_cmp_ge_u32 s30, 7
    s_mov_b32 s72, 0
    s_cselect_b32 s72, 0x7ff00000, s72
    v_add_u32 v48, s72, v48
    s_mov_b32 s73, 602112
    buffer_load_dwordx4 v[52:55], v48, s[32:35], s73 offen
    s_mov_b32 s73, 609280
    buffer_load_dwordx4 v[56:59], v48, s[32:35], s73 offen
    s_mov_b32 s73, 616448
    buffer_load_dwordx4 v[60:63], v48, s[32:35], s73 offen
    s_mov_b32 s73, 623616
    buffer_load_dwordx4 v[64:67], v48, s[32:35], s73 offen
    s_mov_b32 s73, 630784
    buffer_load_dwordx4 v[68:71], v48, s[32:35], s73 offen
    s_mov_b32 s73, 637952
    buffer_load_dwordx4 v[72:75], v48, s[32:35], s73 offen
    s_mov_b32 s73, 645120
    buffer_load_dwordx4 v[76:79], v48, s[32:35], s73 offen
    s_mov_b32 s73, 652288
    buffer_load_dwordx4 v[80:83], v48, s[32:35], s73 offen
    s_mov_b32 s73, 659456
    buffer_load_dwordx4 v[84:87], v48, s[32:35], s73 offen
    s_mov_b32 s73, 666624
    buffer_load_dwordx4 v[88:91], v48, s[32:35], s73 offen
    s_mov_b32 s73, 673792
    buffer_load_dwordx4 v[92:95], v48, s[32:35], s73 offen
    s_mov_b32 s73, 680960
    buffer_load_dwordx4 v[96:99], v48, s[32:35], s73 offen
    s_waitcnt vmcnt(12)
    s_barrier
    s_mov_b32 s73, 688128
    buffer_load_dwordx4 v[100:103], v48, s[32:35], s73 offen
    s_mov_b32 s73, 695296
    buffer_load_dwordx4 v[104:107], v48, s[32:35], s73 offen
    s_mov_b32 s73, 702464
    buffer_load_dwordx4 v[108:111], v48, s[32:35], s73 offen
    s_mov_b32 s73, 709632
    buffer_load_dwordx4 v[112:115], v48, s[32:35], s73 offen
    s_mov_b32 s73, 716800
    buffer_load_dwordx4 v[116:119], v48, s[32:35], s73 offen
    s_mov_b32 s73, 723968
    buffer_load_dwordx4 v[120:123], v48, s[32:35], s73 offen
    s_mov_b32 s73, 731136
    buffer_load_dwordx4 v[124:127], v48, s[32:35], s73 offen
    s_mov_b32 s73, 738304
    buffer_load_dwordx4 v[128:131], v48, s[32:35], s73 offen
    s_mov_b32 s73, 745472
    buffer_load_dwordx4 v[132:135], v48, s[32:35], s73 offen
    s_mov_b32 s73, 752640
    buffer_load_dwordx4 v[136:139], v48, s[32:35], s73 offen
    s_mov_b32 s73, 759808
    buffer_load_dwordx4 v[140:143], v48, s[32:35], s73 offen
    s_mov_b32 s73, 766976
    buffer_load_dwordx4 v[144:147], v48, s[32:35], s73 offen
    s_barrier
    s_mov_b32 s73, 774144
    buffer_load_dwordx4 v[148:151], v48, s[32:35], s73 offen
    s_mov_b32 s73, 781312
    buffer_load_dwordx4 v[152:155], v48, s[32:35], s73 offen
    s_mov_b32 s73, 788480
    buffer_load_dwordx4 v[156:159], v48, s[32:35], s73 offen
    s_mov_b32 s73, 795648
    buffer_load_dwordx4 v[160:163], v48, s[32:35], s73 offen
    s_branch p1Bl3_done
p1Bl3_retry:
    s_sub_u32 s55, s55, 1
    s_cmp_eq_u32 s55, 0
    s_cbranch_scc1 p1Bl3_tok
    v_add_u32 v25, 64, v0
    v_lshrrev_b32 v26, 3, v25
    v_min_u32 v26, 13, v26
    s_mul_i32 s72, s53, 14
    v_add_u32 v26, s72, v26
    v_lshlrev_b32 v26, 9, v26
    v_and_b32 v25, 7, v25
    v_lshl_add_u32 v26, v25, 4, v26
    s_mov_b32 s72, 32768
    buffer_load_dwordx4 v[32:35], v26, s[44:47], s72 offen offset:0 sc1
    buffer_load_dwordx4 v[36:39], v26, s[44:47], s72 offen offset:128 sc1
    buffer_load_dwordx4 v[40:43], v26, s[44:47], s72 offen offset:256 sc1
    buffer_load_dwordx4 v[44:47], v26, s[44:47], s72 offen offset:384 sc1
    s_waitcnt vmcnt(0)
    v_cmp_eq_u32 vcc, s60, v34
    v_cmp_eq_u32 s[74:75], s61, v35
    s_and_b64 vcc, vcc, s[74:75]
    s_mov_b64 s[76:77], vcc
    v_cmp_eq_u32 vcc, s60, v38
    v_cmp_eq_u32 s[74:75], s61, v39
    s_and_b64 vcc, vcc, s[74:75]
    s_and_b64 s[76:77], s[76:77], vcc
    v_cmp_eq_u32 vcc, s60, v42
    v_cmp_eq_u32 s[74:75], s61, v43
    s_and_b64 vcc, vcc, s[74:75]
    s_and_b64 s[76:77], s[76:77], vcc
    v_cmp_eq_u32 vcc, s60, v46
    v_cmp_eq_u32 s[74:75], s61, v47
    s_and_b64 vcc, vcc, s[74:75]
    s_and_b64 s[76:77], s[76:77], vcc
    s_cmp_eq_u64 s[76:77], -1
    s_cbranch_scc0 p1Bl3_retry
    s_branch p1Bl3_tok
p1Bl3_done:
    s_branch f_lr3
f_lr0:
    s_mov_b32 s40, s12
    s_mov_b32 s41, s13
    s_mov_b32 s42, 0x62000
    s_mov_b32 s43, 0x20000
    s_mov_b32 s36, s18
    s_mov_b32 s37, s19
    s_mov_b32 s38, 0x800000
    s_mov_b32 s39, 0x20000
    s_mov_b32 s32, s22
    s_mov_b32 s33, s23
    s_mov_b32 s34, 0xc4000
    s_mov_b32 s35, 0x20000
    v_lshrrev_b32 v8, 3, v0
    v_mul_u32_u24 v8, 896, v8
    v_bfe_u32 v20, v0, 1, 2
    v_lshrrev_b32 v21, 4, v0
    v_xor_b32 v20, v20, v21
    v_lshl_add_u32 v8, v20, 5, v8
    v_and_b32 v20, 1, v0
    v_lshl_add_u32 v8, v20, 4, v8
    s_lshl_b32 s72, s30, 7
    v_add_u32 v8, s72, v8
    s_mov_b32 s68, 0
    s_bfe_u32 s68, s2, 0x10001
    s_lshl_b32 s68, s68, 3
    v_lshrrev_b32 v9, 3, v0
    v_lshrrev_b32 v10, 4, v0
    v_and_b32 v11, 7, v0
    v_xor_b32 v11, v11, v10
    v_xor_b32 v12, 4, v11
    v_lshlrev_b32 v9, 12, v9
    v_lshl_add_u32 v13, v11, 4, v9
    v_lshl_add_u32 v14, v12, 4, v9
    v_add_u32 v14, 32768, v14
    s_lshl_b32 s74, s4, 19
    s_lshl_b32 s75, s6, 11
    s_add_u32 s74, s74, s75
    s_lshl_b32 s75, s68, 7
    s_add_u32 s74, s74, s75
    s_mov_b32 s70, 128
    s_add_u32 s75, s74, 65536
    s_add_u32 s76, s74, 131072
    s_add_u32 s77, s74, 196608
    s_mov_b32 s64, 0
    s_add_u32 m0, s64, 0
    s_nop 0
    buffer_load_dwordx4 v13, s[36:39], s74 offen lds
    s_add_u32 m0, s64, 1024
    s_nop 0
    buffer_load_dwordx4 v14, s[36:39], s74 offen lds
    s_add_u32 m0, s64, 2048
    s_nop 0
    buffer_load_dwordx4 v13, s[36:39], s75 offen lds
    s_add_u32 m0, s64, 3072
    s_nop 0
    buffer_load_dwordx4 v14, s[36:39], s75 offen lds
    s_add_u32 m0, s64, 4096
    s_nop 0
    buffer_load_dwordx4 v13, s[36:39], s76 offen lds
    s_add_u32 m0, s64, 5120
    s_nop 0
    buffer_load_dwordx4 v14, s[36:39], s76 offen lds
    s_add_u32 m0, s64, 6144
    s_nop 0
    buffer_load_dwordx4 v13, s[36:39], s77 offen lds
    s_add_u32 m0, s64, 7168
    s_nop 0
    buffer_load_dwordx4 v14, s[36:39], s77 offen lds
    s_add_u32 s68, s68, 1
    s_and_b32 s68, s68, 15
    s_cselect_b32 s69, s70, -1920
    s_add_u32 s74, s74, s69
    s_add_u32 s75, s75, s69
    s_add_u32 s76, s76, s69
    s_add_u32 s77, s77, s69
    s_add_u32 s64, s64, 16384
    s_cmp_eq_u32 s64, 81920
    s_cselect_b32 s64, 0, s64
    s_add_u32 m0, s64, 0
    s_nop 0
    buffer_load_dwordx4 v13, s[36:39], s74 offen lds
    s_add_u32 m0, s64, 1024
    s_nop 0
    buffer_load_dwordx4 v14, s[36:39], s74 offen lds
    s_add_u32 m0, s64, 2048
    s_nop 0
    buffer_load_dwordx4 v13, s[36:39], s75 offen lds
    s_add_u32 m0, s64, 3072
    s_nop 0
    buffer_load_dwordx4 v14, s[36:39], s75 offen lds
    s_add_u32 m0, s64, 4096
    s_nop 0
    buffer_load_dwordx4 v13, s[36:39], s76 offen lds
    s_add_u32 m0, s64, 5120
    s_nop 0
    buffer_load_dwordx4 v14, s[36:39], s76 offen lds
    s_add_u32 m0, s64, 6144
    s_nop 0
    buffer_load_dwordx4 v13, s[36:39], s77 offen lds
    s_add_u32 m0, s64, 7168
    s_nop 0
    buffer_load_dwordx4 v14, s[36:39], s77 offen lds
    s_add_u32 s68, s68, 1
    s_and_b32 s68, s68, 15
    s_cselect_b32 s69, s70, -1920
    s_add_u32 s74, s74, s69
    s_add_u32 s75, s75, s69
    s_add_u32 s76, s76, s69
    s_add_u32 s77, s77, s69
    s_add_u32 s64, s64, 16384
    s_cmp_eq_u32 s64, 81920
    s_cselect_b32 s64, 0, s64
    s_add_u32 m0, s64, 0
    s_nop 0
    buffer_load_dwordx4 v13, s[36:39], s74 offen lds
    s_add_u32 m0, s64, 1024
    s_nop 0
    buffer_load_dwordx4 v14, s[36:39], s74 offen lds
    s_add_u32 m0, s64, 2048
    s_nop 0
    buffer_load_dwordx4 v13, s[36:39], s75 offen lds
    s_add_u32 m0, s64, 3072
    s_nop 0
    buffer_load_dwordx4 v14, s[36:39], s75 offen lds
    s_add_u32 m0, s64, 4096
    s_nop 0
    buffer_load_dwordx4 v13, s[36:39], s76 offen lds
    s_add_u32 m0, s64, 5120
    s_nop 0
    buffer_load_dwordx4 v14, s[36:39], s76 offen lds
    s_add_u32 m0, s64, 6144
    s_nop 0
    buffer_load_dwordx4 v13, s[36:39], s77 offen lds
    s_add_u32 m0, s64, 7168
    s_nop 0
    buffer_load_dwordx4 v14, s[36:39], s77 offen lds
    s_add_u32 s68, s68, 1
    s_and_b32 s68, s68, 15
    s_cselect_b32 s69, s70, -1920
    s_add_u32 s74, s74, s69
    s_add_u32 s75, s75, s69
    s_add_u32 s76, s76, s69
    s_add_u32 s77, s77, s69
    s_add_u32 s64, s64, 16384
    s_cmp_eq_u32 s64, 81920
    s_cselect_b32 s64, 0, s64
    s_add_u32 m0, s64, 0
    s_nop 0
    buffer_load_dwordx4 v13, s[36:39], s74 offen lds
    s_add_u32 m0, s64, 1024
    s_nop 0
    buffer_load_dwordx4 v14, s[36:39], s74 offen lds
    s_add_u32 m0, s64, 2048
    s_nop 0
    buffer_load_dwordx4 v13, s[36:39], s75 offen lds
    s_add_u32 m0, s64, 3072
    s_nop 0
    buffer_load_dwordx4 v14, s[36:39], s75 offen lds
    s_add_u32 m0, s64, 4096
    s_nop 0
    buffer_load_dwordx4 v13, s[36:39], s76 offen lds
    s_add_u32 m0, s64, 5120
    s_nop 0
    buffer_load_dwordx4 v14, s[36:39], s76 offen lds
    s_add_u32 m0, s64, 6144
    s_nop 0
    buffer_load_dwordx4 v13, s[36:39], s77 offen lds
    s_add_u32 m0, s64, 7168
    s_nop 0
    buffer_load_dwordx4 v14, s[36:39], s77 offen lds
    s_add_u32 s68, s68, 1
    s_and_b32 s68, s68, 15
    s_cselect_b32 s69, s70, -1920
    s_add_u32 s74, s74, s69
    s_add_u32 s75, s75, s69
    s_add_u32 s76, s76, s69
    s_add_u32 s77, s77, s69
    s_add_u32 s64, s64, 16384
    s_cmp_eq_u32 s64, 81920
    s_cselect_b32 s64, 0, s64
    s_cmp_ge_u32 s53, 8
    s_cbranch_scc1 lr0_noimg
    s_cmp_ge_u32 s30, 7
    s_cbranch_scc1 lr0_noimg
    s_mov_b32 s73, 0
    buffer_load_dwordx4 v[52:55], v8, s[32:35], s73 offen
    s_mov_b32 s73, 7168
    buffer_load_dwordx4 v[56:59], v8, s[32:35], s73 offen
    s_mov_b32 s73, 14336
    buffer_load_dwordx4 v[60:63], v8, s[32:35], s73 offen
    s_mov_b32 s73, 21504
    buffer_load_dwordx4 v[64:67], v8, s[32:35], s73 offen
    s_mov_b32 s73, 28672
    buffer_load_dwordx4 v[68:71], v8, s[32:35], s73 offen
    s_mov_b32 s73, 35840
    buffer_load_dwordx4 v[72:75], v8, s[32:35], s73 offen
    s_mov_b32 s73, 43008
    buffer_load_dwordx4 v[76:79], v8, s[32:35], s73 offen
    s_mov_b32 s73, 50176
    buffer_load_dwordx4 v[80:83], v8, s[32:35], s73 offen
    s_mov_b32 s73, 57344
    buffer_load_dwordx4 v[84:87], v8, s[32:35], s73 offen
    s_mov_b32 s73, 64512
    buffer_load_dwordx4 v[88:91], v8, s[32:35], s73 offen
    s_mov_b32 s73, 71680
    buffer_load_dwordx4 v[92:95], v8, s[32:35], s73 offen
    s_mov_b32 s73, 78848
    buffer_load_dwordx4 v[96:99], v8, s[32:35], s73 offen
    s_mov_b32 s73, 86016
    buffer_load_dwordx4 v[100:103], v8, s[32:35], s73 offen
    s_mov_b32 s73, 93184
    buffer_load_dwordx4 v[104:107], v8, s[32:35], s73 offen
    s_mov_b32 s73, 100352
    buffer_load_dwordx4 v[108:111], v8, s[32:35], s73 offen
    s_mov_b32 s73, 107520
    buffer_load_dwordx4 v[112:115], v8, s[32:35], s73 offen
    s_mov_b32 s73, 114688
    buffer_load_dwordx4 v[116:119], v8, s[32:35], s73 offen
    s_mov_b32 s73, 121856
    buffer_load_dwordx4 v[120:123], v8, s[32:35], s73 offen
    s_mov_b32 s73, 129024
    buffer_load_dwordx4 v[124:127], v8, s[32:35], s73 offen
    s_mov_b32 s73, 136192
    buffer_load_dwordx4 v[128:131], v8, s[32:35], s73 offen
    s_mov_b32 s73, 143360
    buffer_load_dwordx4 v[132:135], v8, s[32:35], s73 offen
    s_mov_b32 s73, 150528
    buffer_load_dwordx4 v[136:139], v8, s[32:35], s73 offen
    s_mov_b32 s73, 157696
    buffer_load_dwordx4 v[140:143], v8, s[32:35], s73 offen
    s_mov_b32 s73, 164864
    buffer_load_dwordx4 v[144:147], v8, s[32:35], s73 offen
    s_mov_b32 s73, 172032
    buffer_load_dwordx4 v[148:151], v8, s[32:35], s73 offen
    s_mov_b32 s73, 179200
    buffer_load_dwordx4 v[152:155], v8, s[32:35], s73 offen
    s_mov_b32 s73, 186368
    buffer_load_dwordx4 v[156:159], v8, s[32:35], s73 offen
    s_mov_b32 s73, 193536
    buffer_load_dwordx4 v[160:163], v8, s[32:35], s73 offen
lr0_noimg:
    s_barrier
    s_waitcnt vmcnt(0)
    s_barrier
    s_barrier
    s_mov_b32 s65, 12
lr0_loop:
    s_add_u32 m0, s64, 0
    s_nop 0
    buffer_load_dwordx4 v13, s[36:39], s74 offen lds
    s_add_u32 m0, s64, 1024
    s_nop 0
    buffer_load_dwordx4 v14, s[36:39], s74 offen lds
    s_add_u32 m0, s64, 2048
    s_nop 0
    buffer_load_dwordx4 v13, s[36:39], s75 offen lds
    s_add_u32 m0, s64, 3072
    s_nop 0
    buffer_load_dwordx4 v14, s[36:39], s75 offen lds
    s_add_u32 m0, s64, 4096
    s_nop 0
    buffer_load_dwordx4 v13, s[36:39], s76 offen lds
    s_add_u32 m0, s64, 5120
    s_nop 0
    buffer_load_dwordx4 v14, s[36:39], s76 offen lds
    s_add_u32 m0, s64, 6144
    s_nop 0
    buffer_load_dwordx4 v13, s[36:39], s77 offen lds
    s_add_u32 m0, s64, 7168
    s_nop 0
    buffer_load_dwordx4 v14, s[36:39], s77 offen lds
    s_add_u32 s68, s68, 1
    s_and_b32 s68, s68, 15
    s_cselect_b32 s69, s70, -1920
    s_add_u32 s74, s74, s69
    s_add_u32 s75, s75, s69
    s_add_u32 s76, s76, s69
    s_add_u32 s77, s77, s69
    s_add_u32 s64, s64, 16384
    s_cmp_eq_u32 s64, 81920
    s_cselect_b32 s64, 0, s64
    s_waitcnt vmcnt(16)
    s_barrier
    s_sub_u32 s65, s65, 1
    s_cmp_lg_u32 s65, 0
    s_cbranch_scc1 lr0_loop
    s_waitcnt vmcnt(8)
    s_barrier
    s_waitcnt vmcnt(0)
    s_barrier
    s_cmp_ge_u32 s30, 7
    s_cbranch_scc1 lr0_nowo
    s_mov_b32 m0, 105472
    s_mov_b32 s73, 0
    buffer_load_dwordx4 v8, s[40:43], s73 offen lds
    s_mov_b32 m0, 109568
    s_mov_b32 s73, 28672
    buffer_load_dwordx4 v8, s[40:43], s73 offen lds
    s_mov_b32 m0, 113664
    s_mov_b32 s73, 57344
    buffer_load_dwordx4 v8, s[40:43], s73 offen lds
    s_mov_b32 m0, 117760
    s_mov_b32 s73, 86016
    buffer_load_dwordx4 v8, s[40:43], s73 offen lds
    s_mov_b32 m0, 121856
    s_mov_b32 s73, 114688
    buffer_load_dwordx4 v8, s[40:43], s73 offen lds
    s_mov_b32 m0, 125952
    s_mov_b32 s73, 143360
    buffer_load_dwordx4 v8, s[40:43], s73 offen lds
    s_mov_b32 m0, 130048
    s_mov_b32 s73, 172032
    buffer_load_dwordx4 v8, s[40:43], s73 offen lds
    s_mov_b32 m0, 134144
    s_mov_b32 s73, 200704
    buffer_load_dwordx4 v8, s[40:43], s73 offen lds
    s_mov_b32 m0, 138240
    s_mov_b32 s73, 229376
    buffer_load_dwordx4 v8, s[40:43], s73 offen lds
    s_mov_b32 m0, 142336
    s_mov_b32 s73, 258048
    buffer_load_dwordx4 v8, s[40:43], s73 offen lds
    s_mov_b32 m0, 146432
    s_mov_b32 s73, 286720
    buffer_load_dwordx4 v8, s[40:43], s73 offen lds
    s_mov_b32 m0, 150528
    s_mov_b32 s73, 315392
    buffer_load_dwordx4 v8, s[40:43], s73 offen lds
    s_mov_b32 m0, 154624
    s_mov_b32 s73, 344064
    buffer_load_dwordx4 v8, s[40:43], s73 offen lds
    s_mov_b32 m0, 158720
    s_mov_b32 s73, 372736
    buffer_load_dwordx4 v8, s[40:43], s73 offen lds
    s_mov_b32 m0, 162816
    s_mov_b32 s73, 401408
    buffer_load_dwordx4 v8, s[40:43], s73 offen lds
lr0_nowo:
    s_barrier
    s_barrier
    s_cmp_ge_u32 s30, 7
    s_cbranch_scc1 lr0_end
    v_lshlrev_b32 v9, 4, v0
    v_add_u32 v9, 0, v9
    ds_write_b128 v9, v[52:55] offset:0
    ds_write_b128 v9, v[56:59] offset:1024
    ds_write_b128 v9, v[60:63] offset:2048
    ds_write_b128 v9, v[64:67] offset:3072
    ds_write_b128 v9, v[68:71] offset:4096
    ds_write_b128 v9, v[72:75] offset:5120
    ds_write_b128 v9, v[76:79] offset:6144
    ds_write_b128 v9, v[80:83] offset:7168
    ds_write_b128 v9, v[84:87] offset:8192
    ds_write_b128 v9, v[88:91] offset:9216
    ds_write_b128 v9, v[92:95] offset:10240
    ds_write_b128 v9, v[96:99] offset:11264
    ds_write_b128 v9, v[100:103] offset:12288
    ds_write_b128 v9, v[104:107] offset:13312
    ds_write_b128 v9, v[108:111] offset:14336
    ds_write_b128 v9, v[112:115] offset:15360
    ds_write_b128 v9, v[116:119] offset:16384
    ds_write_b128 v9, v[120:123] offset:17408
    ds_write_b128 v9, v[124:127] offset:18432
    ds_write_b128 v9, v[128:131] offset:19456
    ds_write_b128 v9, v[132:135] offset:20480
    ds_write_b128 v9, v[136:139] offset:21504
    ds_write_b128 v9, v[140:143] offset:22528
    ds_write_b128 v9, v[144:147] offset:23552
    ds_write_b128 v9, v[148:151] offset:24576
    ds_write_b128 v9, v[152:155] offset:25600
    ds_write_b128 v9, v[156:159] offset:26624
    ds_write_b128 v9, v[160:163] offset:27648
    s_waitcnt vmcnt(0) lgkmcnt(0)
    s_barrier
    s_barrier
    s_lshl_b32 s72, s7, 9
    s_add_u32 s72, s72, 20987904
    v_lshlrev_b32 v15, 3, v0
    s_mov_b32 s55, 40000
lr0u_pl:
    buffer_load_dwordx2 v[16:17], v15, s[44:47], s72 offen sc1
    s_waitcnt vmcnt(0)
    v_cmp_eq_u32 vcc, s60, v16
    v_cmp_eq_u32 s[90:91], s61, v17
    s_and_b64 vcc, vcc, s[90:91]
    s_cmp_eq_u64 vcc, -1
    s_cbranch_scc1 lr0u_pok
    s_sub_u32 s55, s55, 1
    s_cmp_lg_u32 s55, 0
    s_cbranch_scc1 lr0u_pl
lr0u_pok:
    s_waitcnt lgkmcnt(0)
    s_barrier
lr0_end:
    s_endpgm
f_lr1:
    s_mov_b32 s40, s12
    s_mov_b32 s41, s13
    s_mov_b32 s42, 0x62000
    s_mov_b32 s43, 0x20000
    s_mov_b32 s36, s18
    s_mov_b32 s37, s19
    s_mov_b32 s38, 0x800000
    s_mov_b32 s39, 0x20000
    s_mov_b32 s32, s22
    s_mov_b32 s33, s23
    s_mov_b32 s34, 0xc4000
    s_mov_b32 s35, 0x20000
    v_lshrrev_b32 v8, 3, v0
    v_mul_u32_u24 v8, 896, v8
    v_bfe_u32 v20, v0, 1, 2
    v_lshrrev_b32 v21, 4, v0
    v_xor_b32 v20, v20, v21
    v_lshl_add_u32 v8, v20, 5, v8
    v_and_b32 v20, 1, v0
    v_lshl_add_u32 v8, v20, 4, v8
    s_lshl_b32 s72, s30, 7
    v_add_u32 v8, s72, v8
    s_mov_b32 s68, 0
    s_bfe_u32 s68, s2, 0x10001
    s_lshl_b32 s68, s68, 3
    v_lshrrev_b32 v9, 3, v0
    v_lshrrev_b32 v10, 4, v0
    v_and_b32 v11, 7, v0
    v_xor_b32 v11, v11, v10
    v_xor_b32 v12, 4, v11
    v_lshlrev_b32 v9, 12, v9
    v_lshl_add_u32 v13, v11, 4, v9
    v_lshl_add_u32 v14, v12, 4, v9
    v_add_u32 v14, 32768, v14
    s_lshl_b32 s74, s4, 19
    s_lshl_b32 s75, s6, 11
    s_add_u32 s74, s74, s75
    s_add_u32 s74, s74, 262144
    s_lshl_b32 s75, s68, 7
    s_add_u32 s74, s74, s75
    s_mov_b32 s70, 128
    s_add_u32 s75, s74, 65536
    s_add_u32 s76, s74, 131072
    s_add_u32 s77, s74, 196608
    s_mov_b32 s64, 0
    s_add_u32 m0, s64, 8192
    s_nop 0
    buffer_load_dwordx4 v13, s[36:39], s74 offen lds
    s_add_u32 m0, s64, 9216
    s_nop 0
    buffer_load_dwordx4 v14, s[36:39], s74 offen lds
    s_add_u32 m0, s64, 10240
    s_nop 0
    buffer_load_dwordx4 v13, s[36:39], s75 offen lds
    s_add_u32 m0, s64, 11264
    s_nop 0
    buffer_load_dwordx4 v14, s[36:39], s75 offen lds
    s_add_u32 m0, s64, 12288
    s_nop 0
    buffer_load_dwordx4 v13, s[36:39], s76 offen lds
    s_add_u32 m0, s64, 13312
    s_nop 0
    buffer_load_dwordx4 v14, s[36:39], s76 offen lds
    s_add_u32 m0, s64, 14336
    s_nop 0
    buffer_load_dwordx4 v13, s[36:39], s77 offen lds
    s_add_u32 m0, s64, 15360
    s_nop 0
    buffer_load_dwordx4 v14, s[36:39], s77 offen lds
    s_add_u32 s68, s68, 1
    s_and_b32 s68, s68, 15
    s_cselect_b32 s69, s70, -1920
    s_add_u32 s74, s74, s69
    s_add_u32 s75, s75, s69
    s_add_u32 s76, s76, s69
    s_add_u32 s77, s77, s69
    s_add_u32 s64, s64, 16384
    s_cmp_eq_u32 s64, 81920
    s_cselect_b32 s64, 0, s64
    s_add_u32 m0, s64, 8192
    s_nop 0
    buffer_load_dwordx4 v13, s[36:39], s74 offen lds
    s_add_u32 m0, s64, 9216
    s_nop 0
    buffer_load_dwordx4 v14, s[36:39], s74 offen lds
    s_add_u32 m0, s64, 10240
    s_nop 0
    buffer_load_dwordx4 v13, s[36:39], s75 offen lds
    s_add_u32 m0, s64, 11264
    s_nop 0
    buffer_load_dwordx4 v14, s[36:39], s75 offen lds
    s_add_u32 m0, s64, 12288
    s_nop 0
    buffer_load_dwordx4 v13, s[36:39], s76 offen lds
    s_add_u32 m0, s64, 13312
    s_nop 0
    buffer_load_dwordx4 v14, s[36:39], s76 offen lds
    s_add_u32 m0, s64, 14336
    s_nop 0
    buffer_load_dwordx4 v13, s[36:39], s77 offen lds
    s_add_u32 m0, s64, 15360
    s_nop 0
    buffer_load_dwordx4 v14, s[36:39], s77 offen lds
    s_add_u32 s68, s68, 1
    s_and_b32 s68, s68, 15
    s_cselect_b32 s69, s70, -1920
    s_add_u32 s74, s74, s69
    s_add_u32 s75, s75, s69
    s_add_u32 s76, s76, s69
    s_add_u32 s77, s77, s69
    s_add_u32 s64, s64, 16384
    s_cmp_eq_u32 s64, 81920
    s_cselect_b32 s64, 0, s64
    s_add_u32 m0, s64, 8192
    s_nop 0
    buffer_load_dwordx4 v13, s[36:39], s74 offen lds
    s_add_u32 m0, s64, 9216
    s_nop 0
    buffer_load_dwordx4 v14, s[36:39], s74 offen lds
    s_add_u32 m0, s64, 10240
    s_nop 0
    buffer_load_dwordx4 v13, s[36:39], s75 offen lds
    s_add_u32 m0, s64, 11264
    s_nop 0
    buffer_load_dwordx4 v14, s[36:39], s75 offen lds
    s_add_u32 m0, s64, 12288
    s_nop 0
    buffer_load_dwordx4 v13, s[36:39], s76 offen lds
    s_add_u32 m0, s64, 13312
    s_nop 0
    buffer_load_dwordx4 v14, s[36:39], s76 offen lds
    s_add_u32 m0, s64, 14336
    s_nop 0
    buffer_load_dwordx4 v13, s[36:39], s77 offen lds
    s_add_u32 m0, s64, 15360
    s_nop 0
    buffer_load_dwordx4 v14, s[36:39], s77 offen lds
    s_add_u32 s68, s68, 1
    s_and_b32 s68, s68, 15
    s_cselect_b32 s69, s70, -1920
    s_add_u32 s74, s74, s69
    s_add_u32 s75, s75, s69
    s_add_u32 s76, s76, s69
    s_add_u32 s77, s77, s69
    s_add_u32 s64, s64, 16384
    s_cmp_eq_u32 s64, 81920
    s_cselect_b32 s64, 0, s64
    s_add_u32 m0, s64, 8192
    s_nop 0
    buffer_load_dwordx4 v13, s[36:39], s74 offen lds
    s_add_u32 m0, s64, 9216
    s_nop 0
    buffer_load_dwordx4 v14, s[36:39], s74 offen lds
    s_add_u32 m0, s64, 10240
    s_nop 0
    buffer_load_dwordx4 v13, s[36:39], s75 offen lds
    s_add_u32 m0, s64, 11264
    s_nop 0
    buffer_load_dwordx4 v14, s[36:39], s75 offen lds
    s_add_u32 m0, s64, 12288
    s_nop 0
    buffer_load_dwordx4 v13, s[36:39], s76 offen lds
    s_add_u32 m0, s64, 13312
    s_nop 0
    buffer_load_dwordx4 v14, s[36:39], s76 offen lds
    s_add_u32 m0, s64, 14336
    s_nop 0
    buffer_load_dwordx4 v13, s[36:39], s77 offen lds
    s_add_u32 m0, s64, 15360
    s_nop 0
    buffer_load_dwordx4 v14, s[36:39], s77 offen lds
    s_add_u32 s68, s68, 1
    s_and_b32 s68, s68, 15
    s_cselect_b32 s69, s70, -1920
    s_add_u32 s74, s74, s69
    s_add_u32 s75, s75, s69
    s_add_u32 s76, s76, s69
    s_add_u32 s77, s77, s69
    s_add_u32 s64, s64, 16384
    s_cmp_eq_u32 s64, 81920
    s_cselect_b32 s64, 0, s64
    s_cmp_ge_u32 s53, 8
    s_cbranch_scc1 lr1_noimg
    s_cmp_ge_u32 s30, 7
    s_cbranch_scc1 lr1_noimg
    s_mov_b32 s73, 200704
    buffer_load_dwordx4 v[52:55], v8, s[32:35], s73 offen
    s_mov_b32 s73, 207872
    buffer_load_dwordx4 v[56:59], v8, s[32:35], s73 offen
    s_mov_b32 s73, 215040
    buffer_load_dwordx4 v[60:63], v8, s[32:35], s73 offen
    s_mov_b32 s73, 222208
    buffer_load_dwordx4 v[64:67], v8, s[32:35], s73 offen
    s_mov_b32 s73, 229376
    buffer_load_dwordx4 v[68:71], v8, s[32:35], s73 offen
    s_mov_b32 s73, 236544
    buffer_load_dwordx4 v[72:75], v8, s[32:35], s73 offen
    s_mov_b32 s73, 243712
    buffer_load_dwordx4 v[76:79], v8, s[32:35], s73 offen
    s_mov_b32 s73, 250880
    buffer_load_dwordx4 v[80:83], v8, s[32:35], s73 offen
    s_mov_b32 s73, 258048
    buffer_load_dwordx4 v[84:87], v8, s[32:35], s73 offen
    s_mov_b32 s73, 265216
    buffer_load_dwordx4 v[88:91], v8, s[32:35], s73 offen
    s_mov_b32 s73, 272384
    buffer_load_dwordx4 v[92:95], v8, s[32:35], s73 offen
    s_mov_b32 s73, 279552
    buffer_load_dwordx4 v[96:99], v8, s[32:35], s73 offen
    s_mov_b32 s73, 286720
    buffer_load_dwordx4 v[100:103], v8, s[32:35], s73 offen
    s_mov_b32 s73, 293888
    buffer_load_dwordx4 v[104:107], v8, s[32:35], s73 offen
    s_mov_b32 s73, 301056
    buffer_load_dwordx4 v[108:111], v8, s[32:35], s73 offen
    s_mov_b32 s73, 308224
    buffer_load_dwordx4 v[112:115], v8, s[32:35], s73 offen
    s_mov_b32 s73, 315392
    buffer_load_dwordx4 v[116:119], v8, s[32:35], s73 offen
    s_mov_b32 s73, 322560
    buffer_load_dwordx4 v[120:123], v8, s[32:35], s73 offen
    s_mov_b32 s73, 329728
    buffer_load_dwordx4 v[124:127], v8, s[32:35], s73 offen
    s_mov_b32 s73, 336896
    buffer_load_dwordx4 v[128:131], v8, s[32:35], s73 offen
    s_mov_b32 s73, 344064
    buffer_load_dwordx4 v[132:135], v8, s[32:35], s73 offen
    s_mov_b32 s73, 351232
    buffer_load_dwordx4 v[136:139], v8, s[32:35], s73 offen
    s_mov_b32 s73, 358400
    buffer_load_dwordx4 v[140:143], v8, s[32:35], s73 offen
    s_mov_b32 s73, 365568
    buffer_load_dwordx4 v[144:147], v8, s[32:35], s73 offen
    s_mov_b32 s73, 372736
    buffer_load_dwordx4 v[148:151], v8, s[32:35], s73 offen
    s_mov_b32 s73, 379904
    buffer_load_dwordx4 v[152:155], v8, s[32:35], s73 offen
    s_mov_b32 s73, 387072
    buffer_load_dwordx4 v[156:159], v8, s[32:35], s73 offen
    s_mov_b32 s73, 394240
    buffer_load_dwordx4 v[160:163], v8, s[32:35], s73 offen
lr1_noimg:
    s_barrier
    s_waitcnt vmcnt(0)
    s_barrier
    s_barrier
    s_mov_b32 s65, 12
lr1_loop:
    s_add_u32 m0, s64, 8192
    s_nop 0
    buffer_load_dwordx4 v13, s[36:39], s74 offen lds
    s_add_u32 m0, s64, 9216
    s_nop 0
    buffer_load_dwordx4 v14, s[36:39], s74 offen lds
    s_add_u32 m0, s64, 10240
    s_nop 0
    buffer_load_dwordx4 v13, s[36:39], s75 offen lds
    s_add_u32 m0, s64, 11264
    s_nop 0
    buffer_load_dwordx4 v14, s[36:39], s75 offen lds
    s_add_u32 m0, s64, 12288
    s_nop 0
    buffer_load_dwordx4 v13, s[36:39], s76 offen lds
    s_add_u32 m0, s64, 13312
    s_nop 0
    buffer_load_dwordx4 v14, s[36:39], s76 offen lds
    s_add_u32 m0, s64, 14336
    s_nop 0
    buffer_load_dwordx4 v13, s[36:39], s77 offen lds
    s_add_u32 m0, s64, 15360
    s_nop 0
    buffer_load_dwordx4 v14, s[36:39], s77 offen lds
    s_add_u32 s68, s68, 1
    s_and_b32 s68, s68, 15
    s_cselect_b32 s69, s70, -1920
    s_add_u32 s74, s74, s69
    s_add_u32 s75, s75, s69
    s_add_u32 s76, s76, s69
    s_add_u32 s77, s77, s69
    s_add_u32 s64, s64, 16384
    s_cmp_eq_u32 s64, 81920
    s_cselect_b32 s64, 0, s64
    s_waitcnt vmcnt(16)
    s_barrier
    s_sub_u32 s65, s65, 1
    s_cmp_lg_u32 s65, 0
    s_cbranch_scc1 lr1_loop
    s_waitcnt vmcnt(8)
    s_barrier
    s_waitcnt vmcnt(0)
    s_barrier
    s_cmp_ge_u32 s30, 7
    s_cbranch_scc1 lr1_nowo
    s_mov_b32 m0, 106496
    s_mov_b32 s73, 7168
    buffer_load_dwordx4 v8, s[40:43], s73 offen lds
    s_mov_b32 m0, 110592
    s_mov_b32 s73, 35840
    buffer_load_dwordx4 v8, s[40:43], s73 offen lds
    s_mov_b32 m0, 114688
    s_mov_b32 s73, 64512
    buffer_load_dwordx4 v8, s[40:43], s73 offen lds
    s_mov_b32 m0, 118784
    s_mov_b32 s73, 93184
    buffer_load_dwordx4 v8, s[40:43], s73 offen lds
    s_mov_b32 m0, 122880
    s_mov_b32 s73, 121856
    buffer_load_dwordx4 v8, s[40:43], s73 offen lds
    s_mov_b32 m0, 126976
    s_mov_b32 s73, 150528
    buffer_load_dwordx4 v8, s[40:43], s73 offen lds
    s_mov_b32 m0, 131072
    s_mov_b32 s73, 179200
    buffer_load_dwordx4 v8, s[40:43], s73 offen lds
    s_mov_b32 m0, 135168
    s_mov_b32 s73, 207872
    buffer_load_dwordx4 v8, s[40:43], s73 offen lds
    s_mov_b32 m0, 139264
    s_mov_b32 s73, 236544
    buffer_load_dwordx4 v8, s[40:43], s73 offen lds
    s_mov_b32 m0, 143360
    s_mov_b32 s73, 265216
    buffer_load_dwordx4 v8, s[40:43], s73 offen lds
    s_mov_b32 m0, 147456
    s_mov_b32 s73, 293888
    buffer_load_dwordx4 v8, s[40:43], s73 offen lds
    s_mov_b32 m0, 151552
    s_mov_b32 s73, 322560
    buffer_load_dwordx4 v8, s[40:43], s73 offen lds
    s_mov_b32 m0, 155648
    s_mov_b32 s73, 351232
    buffer_load_dwordx4 v8, s[40:43], s73 offen lds
    s_mov_b32 m0, 159744
    s_mov_b32 s73, 379904
    buffer_load_dwordx4 v8, s[40:43], s73 offen lds
lr1_nowo:
    s_barrier
    s_barrier
    s_cmp_ge_u32 s30, 7
    s_cbranch_scc1 lr1_end
    v_lshlrev_b32 v9, 4, v0
    v_add_u32 v9, 28672, v9
    ds_write_b128 v9, v[52:55] offset:0
    ds_write_b128 v9, v[56:59] offset:1024
    ds_write_b128 v9, v[60:63] offset:2048
    ds_write_b128 v9, v[64:67] offset:3072
    ds_write_b128 v9, v[68:71] offset:4096
    ds_write_b128 v9, v[72:75] offset:5120
    ds_write_b128 v9, v[76:79] offset:6144
    ds_write_b128 v9, v[80:83] offset:7168
    ds_write_b128 v9, v[84:87] offset:8192
    ds_write_b128 v9, v[88:91] offset:9216
    ds_write_b128 v9, v[92:95] offset:10240
    ds_write_b128 v9, v[96:99] offset:11264
    ds_write_b128 v9, v[100:103] offset:12288
    ds_write_b128 v9, v[104:107] offset:13312
    ds_write_b128 v9, v[108:111] offset:14336
    ds_write_b128 v9, v[112:115] offset:15360
    ds_write_b128 v9, v[116:119] offset:16384
    ds_write_b128 v9, v[120:123] offset:17408
    ds_write_b128 v9, v[124:127] offset:18432
    ds_write_b128 v9, v[128:131] offset:19456
    ds_write_b128 v9, v[132:135] offset:20480
    ds_write_b128 v9, v[136:139] offset:21504
    ds_write_b128 v9, v[140:143] offset:22528
    ds_write_b128 v9, v[144:147] offset:23552
    ds_write_b128 v9, v[148:151] offset:24576
    ds_write_b128 v9, v[152:155] offset:25600
    ds_write_b128 v9, v[156:159] offset:26624
    ds_write_b128 v9, v[160:163] offset:27648
    s_waitcnt vmcnt(0) lgkmcnt(0)
    s_barrier
    s_barrier
    s_waitcnt lgkmcnt(0)
    s_barrier
lr1_end:
    s_endpgm
f_lr2:
    s_mov_b32 s40, s12
    s_mov_b32 s41, s13
    s_mov_b32 s42, 0x62000
    s_mov_b32 s43, 0x20000
    s_mov_b32 s36, s18
    s_mov_b32 s37, s19
    s_mov_b32 s38, 0x800000
    s_mov_b32 s39, 0x20000
    s_mov_b32 s32, s22
    s_mov_b32 s33, s23
    s_mov_b32 s34, 0xc4000
    s_mov_b32 s35, 0x20000
    v_lshrrev_b32 v8, 3, v0
    v_mul_u32_u24 v8, 896, v8
    v_bfe_u32 v20, v0, 1, 2
    v_lshrrev_b32 v21, 4, v0
    v_xor_b32 v20, v20, v21
    v_lshl_add_u32 v8, v20, 5, v8
    v_and_b32 v20, 1, v0
    v_lshl_add_u32 v8, v20, 4, v8
    s_lshl_b32 s72, s30, 7
    v_add_u32 v8, s72, v8
    s_mov_b32 s68, 0
    s_bfe_u32 s68, s2, 0x10001
    s_lshl_b32 s68, s68, 3
    v_lshlrev_b32 v13, 4, v0
    s_mul_i32 s74, s6, 1835008
    s_mul_i32 s75, s5, 7168
    s_add_u32 s74, s74, s75
    s_add_u32 s74, s74, 1048576
    s_mul_i32 s75, s68, 114688
    s_add_u32 s74, s74, s75
    s_mov_b32 s70, 114688
    s_add_u32 s75, s74, 4096
    s_lshl_b32 s78, s5, 14
    s_lshl_b32 s79, s6, 13
    s_add_u32 s78, s78, s79
    s_add_u32 s78, s78, 21037056
    v_add_u32 v15, s68, v0
    v_and_b32 v15, 15, v15
    v_lshlrev_b32 v15, 1, v15
    s_mov_b32 s83, 0
    v_lshlrev_b32 v15, 8, v15
    s_mov_b64 s[80:81], 0
    s_mov_b32 s55, 40000
    s_mov_b32 s64, 0
    s_cmp_ge_u32 s53, 8
    s_cbranch_scc1 lr2_noimg
    s_cmp_ge_u32 s30, 7
    s_cbranch_scc1 lr2_noimg
    s_mov_b32 s73, 401408
    buffer_load_dwordx4 v[52:55], v8, s[32:35], s73 offen
    s_mov_b32 s73, 408576
    buffer_load_dwordx4 v[56:59], v8, s[32:35], s73 offen
    s_mov_b32 s73, 415744
    buffer_load_dwordx4 v[60:63], v8, s[32:35], s73 offen
    s_mov_b32 s73, 422912
    buffer_load_dwordx4 v[64:67], v8, s[32:35], s73 offen
    s_mov_b32 s73, 430080
    buffer_load_dwordx4 v[68:71], v8, s[32:35], s73 offen
    s_mov_b32 s73, 437248
    buffer_load_dwordx4 v[72:75], v8, s[32:35], s73 offen
    s_mov_b32 s73, 444416
    buffer_load_dwordx4 v[76:79], v8, s[32:35], s73 offen
    s_mov_b32 s73, 451584
    buffer_load_dwordx4 v[80:83], v8, s[32:35], s73 offen
    s_mov_b32 s73, 458752
    buffer_load_dwordx4 v[84:87], v8, s[32:35], s73 offen
    s_mov_b32 s73, 465920
    buffer_load_dwordx4 v[88:91], v8, s[32:35], s73 offen
    s_mov_b32 s73, 473088
    buffer_load_dwordx4 v[92:95], v8, s[32:35], s73 offen
    s_mov_b32 s73, 480256
    buffer_load_dwordx4 v[96:99], v8, s[32:35], s73 offen
    s_mov_b32 s73, 487424
    buffer_load_dwordx4 v[100:103], v8, s[32:35], s73 offen
    s_mov_b32 s73, 494592
    buffer_load_dwordx4 v[104:107], v8, s[32:35], s73 offen
    s_mov_b32 s73, 501760
    buffer_load_dwordx4 v[108:111], v8, s[32:35], s73 offen
    s_mov_b32 s73, 508928
    buffer_load_dwordx4 v[112:115], v8, s[32:35], s73 offen
    s_mov_b32 s73, 516096
    buffer_load_dwordx4 v[116:119], v8, s[32:35], s73 offen
    s_mov_b32 s73, 523264
    buffer_load_dwordx4 v[120:123], v8, s[32:35], s73 offen
    s_mov_b32 s73, 530432
    buffer_load_dwordx4 v[124:127], v8, s[32:35], s73 offen
    s_mov_b32 s73, 537600
    buffer_load_dwordx4 v[128:131], v8, s[32:35], s73 offen
    s_mov_b32 s73, 544768
    buffer_load_dwordx4 v[132:135], v8, s[32:35], s73 offen
    s_mov_b32 s73, 551936
    buffer_load_dwordx4 v[136:139], v8, s[32:35], s73 offen
    s_mov_b32 s73, 559104
    buffer_load_dwordx4 v[140:143], v8, s[32:35], s73 offen
    s_mov_b32 s73, 566272
    buffer_load_dwordx4 v[144:147], v8, s[32:35], s73 offen
    s_mov_b32 s73, 573440
    buffer_load_dwordx4 v[148:151], v8, s[32:35], s73 offen
    s_mov_b32 s73, 580608
    buffer_load_dwordx4 v[152:155], v8, s[32:35], s73 offen
    s_mov_b32 s73, 587776
    buffer_load_dwordx4 v[156:159], v8, s[32:35], s73 offen
    s_mov_b32 s73, 594944
    buffer_load_dwordx4 v[160:163], v8, s[32:35], s73 offen
lr2_noimg:
    s_barrier
lr2_z1_chk:
    s_bitcmp1_b64 s[80:81], s83
    s_cbranch_scc1 lr2_z1_ok
    s_cmp_eq_u32 s55, 0
    s_cbranch_scc1 lr2_z1_ok
    s_sub_u32 s55, s55, 1
    s_mov_b64 exec, 0x7
    buffer_load_dwordx2 v[16:17], v15, s[44:47], s78 offen sc1
    s_waitcnt vmcnt(0)
    v_cmp_eq_u32 vcc, s60, v16
    v_cmp_eq_u32 s[90:91], s61, v17
    s_mov_b64 exec, -1
    s_and_b64 s[80:81], vcc, s[90:91]
    s_branch lr2_z1_chk
lr2_z1_ok:
    s_add_u32 m0, s64, 81920
    s_nop 0
    buffer_load_dwordx4 v13, s[44:47], s74 offen offset:0 lds
    buffer_load_dwordx4 v13, s[44:47], s74 offen offset:1024 lds
    buffer_load_dwordx4 v13, s[44:47], s74 offen offset:2048 lds
    buffer_load_dwordx4 v13, s[44:47], s74 offen offset:3072 lds
    s_add_u32 m0, s64, 86016
    s_nop 0
    buffer_load_dwordx4 v13, s[44:47], s75 offen offset:0 lds
    buffer_load_dwordx4 v13, s[44:47], s75 offen offset:1024 lds
    buffer_load_dwordx4 v13, s[44:47], s75 offen offset:2048 lds
    s_add_u32 s83, s83, 1
    s_add_u32 s68, s68, 1
    s_and_b32 s68, s68, 15
    s_cselect_b32 s69, s70, -1720320
    s_add_u32 s74, s74, s69
    s_add_u32 s75, s75, s69
    s_add_u32 s64, s64, 14336
    s_cmp_eq_u32 s64, 71680
    s_cselect_b32 s64, 0, s64
lr2_z2_chk:
    s_bitcmp1_b64 s[80:81], s83
    s_cbranch_scc1 lr2_z2_ok
    s_cmp_eq_u32 s55, 0
    s_cbranch_scc1 lr2_z2_ok
    s_sub_u32 s55, s55, 1
    s_mov_b64 exec, 0x7
    buffer_load_dwordx2 v[16:17], v15, s[44:47], s78 offen sc1
    s_waitcnt vmcnt(0)
    v_cmp_eq_u32 vcc, s60, v16
    v_cmp_eq_u32 s[90:91], s61, v17
    s_mov_b64 exec, -1
    s_and_b64 s[80:81], vcc, s[90:91]
    s_branch lr2_z2_chk
lr2_z2_ok:
    s_add_u32 m0, s64, 81920
    s_nop 0
    buffer_load_dwordx4 v13, s[44:47], s74 offen offset:0 lds
    buffer_load_dwordx4 v13, s[44:47], s74 offen offset:1024 lds
    buffer_load_dwordx4 v13, s[44:47], s74 offen offset:2048 lds
    buffer_load_dwordx4 v13, s[44:47], s74 offen offset:3072 lds
    s_add_u32 m0, s64, 86016
    s_nop 0
    buffer_load_dwordx4 v13, s[44:47], s75 offen offset:0 lds
    buffer_load_dwordx4 v13, s[44:47], s75 offen offset:1024 lds
    buffer_load_dwordx4 v13, s[44:47], s75 offen offset:2048 lds
    s_add_u32 s83, s83, 1
    s_add_u32 s68, s68, 1
    s_and_b32 s68, s68, 15
    s_cselect_b32 s69, s70, -1720320
    s_add_u32 s74, s74, s69
    s_add_u32 s75, s75, s69
    s_add_u32 s64, s64, 14336
    s_cmp_eq_u32 s64, 71680
    s_cselect_b32 s64, 0, s64
lr2_z3_chk:
    s_bitcmp1_b64 s[80:81], s83
    s_cbranch_scc1 lr2_z3_ok
    s_cmp_eq_u32 s55, 0
    s_cbranch_scc1 lr2_z3_ok
    s_sub_u32 s55, s55, 1
    s_mov_b64 exec, 0x7
    buffer_load_dwordx2 v[16:17], v15, s[44:47], s78 offen sc1
    s_waitcnt vmcnt(0)
    v_cmp_eq_u32 vcc, s60, v16
    v_cmp_eq_u32 s[90:91], s61, v17
    s_mov_b64 exec, -1
    s_and_b64 s[80:81], vcc, s[90:91]
    s_branch lr2_z3_chk
lr2_z3_ok:
    s_add_u32 m0, s64, 81920
    s_nop 0
    buffer_load_dwordx4 v13, s[44:47], s74 offen offset:0 lds
    buffer_load_dwordx4 v13, s[44:47], s74 offen offset:1024 lds
    buffer_load_dwordx4 v13, s[44:47], s74 offen offset:2048 lds
    buffer_load_dwordx4 v13, s[44:47], s74 offen offset:3072 lds
    s_add_u32 m0, s64, 86016
    s_nop 0
    buffer_load_dwordx4 v13, s[44:47], s75 offen offset:0 lds
    buffer_load_dwordx4 v13, s[44:47], s75 offen offset:1024 lds
    buffer_load_dwordx4 v13, s[44:47], s75 offen offset:2048 lds
    s_add_u32 s83, s83, 1
    s_add_u32 s68, s68, 1
    s_and_b32 s68, s68, 15
    s_cselect_b32 s69, s70, -1720320
    s_add_u32 s74, s74, s69
    s_add_u32 s75, s75, s69
    s_add_u32 s64, s64, 14336
    s_cmp_eq_u32 s64, 71680
    s_cselect_b32 s64, 0, s64
    s_mov_b64 exec, 0xffff
    buffer_load_dwordx2 v[18:19], v15, s[44:47], s78 offen sc1
    s_mov_b64 exec, -1
    s_waitcnt vmcnt(15)
    s_barrier
    s_waitcnt vmcnt(0)
    v_cmp_eq_u32 vcc, s60, v18
    v_cmp_eq_u32 s[90:91], s61, v19
    s_and_b64 s[80:81], vcc, s[90:91]
    s_and_b32 s80, s80, 0xffff
    s_mov_b32 s81, 0
    s_mov_b32 s65, 13
lr2_loop:
lr2_z4_chk:
    s_bitcmp1_b64 s[80:81], s83
    s_cbranch_scc1 lr2_z4_ok
    s_cmp_eq_u32 s55, 0
    s_cbranch_scc1 lr2_z4_ok
    s_sub_u32 s55, s55, 1
    s_mov_b64 exec, 0xffff
    buffer_load_dwordx2 v[16:17], v15, s[44:47], s78 offen sc1
    s_waitcnt vmcnt(0)
    v_cmp_eq_u32 vcc, s60, v16
    v_cmp_eq_u32 s[90:91], s61, v17
    s_mov_b64 exec, -1
    s_and_b64 s[80:81], vcc, s[90:91]
    s_branch lr2_z4_chk
lr2_z4_ok:
    s_add_u32 m0, s64, 81920
    s_nop 0
    buffer_load_dwordx4 v13, s[44:47], s74 offen offset:0 lds
    buffer_load_dwordx4 v13, s[44:47], s74 offen offset:1024 lds
    buffer_load_dwordx4 v13, s[44:47], s74 offen offset:2048 lds
    buffer_load_dwordx4 v13, s[44:47], s74 offen offset:3072 lds
    s_add_u32 m0, s64, 86016
    s_nop 0
    buffer_load_dwordx4 v13, s[44:47], s75 offen offset:0 lds
    buffer_load_dwordx4 v13, s[44:47], s75 offen offset:1024 lds
    buffer_load_dwordx4 v13, s[44:47], s75 offen offset:2048 lds
    s_add_u32 s83, s83, 1
    s_add_u32 s68, s68, 1
    s_and_b32 s68, s68, 15
    s_cselect_b32 s69, s70, -1720320
    s_add_u32 s74, s74, s69
    s_add_u32 s75, s75, s69
    s_add_u32 s64, s64, 14336
    s_cmp_eq_u32 s64, 71680
    s_cselect_b32 s64, 0, s64
    s_waitcnt vmcnt(14)
    s_barrier
    s_sub_u32 s65, s65, 1
    s_cmp_lg_u32 s65, 0
    s_cbranch_scc1 lr2_loop
    s_waitcnt vmcnt(7)
    s_barrier
    s_waitcnt vmcnt(0)
    s_barrier
    s_cmp_ge_u32 s30, 7
    s_cbranch_scc1 lr2_nowo
    s_mov_b32 m0, 107520
    s_mov_b32 s73, 14336
    buffer_load_dwordx4 v8, s[40:43], s73 offen lds
    s_mov_b32 m0, 111616
    s_mov_b32 s73, 43008
    buffer_load_dwordx4 v8, s[40:43], s73 offen lds
    s_mov_b32 m0, 115712
    s_mov_b32 s73, 71680
    buffer_load_dwordx4 v8, s[40:43], s73 offen lds
    s_mov_b32 m0, 119808
    s_mov_b32 s73, 100352
    buffer_load_dwordx4 v8, s[40:43], s73 offen lds
    s_mov_b32 m0, 123904
    s_mov_b32 s73, 129024
    buffer_load_dwordx4 v8, s[40:43], s73 offen lds
    s_mov_b32 m0, 128000
    s_mov_b32 s73, 157696
    buffer_load_dwordx4 v8, s[40:43], s73 offen lds
    s_mov_b32 m0, 132096
    s_mov_b32 s73, 186368
    buffer_load_dwordx4 v8, s[40:43], s73 offen lds
    s_mov_b32 m0, 136192
    s_mov_b32 s73, 215040
    buffer_load_dwordx4 v8, s[40:43], s73 offen lds
    s_mov_b32 m0, 140288
    s_mov_b32 s73, 243712
    buffer_load_dwordx4 v8, s[40:43], s73 offen lds
    s_mov_b32 m0, 144384
    s_mov_b32 s73, 272384
    buffer_load_dwordx4 v8, s[40:43], s73 offen lds
    s_mov_b32 m0, 148480
    s_mov_b32 s73, 301056
    buffer_load_dwordx4 v8, s[40:43], s73 offen lds
    s_mov_b32 m0, 152576
    s_mov_b32 s73, 329728
    buffer_load_dwordx4 v8, s[40:43], s73 offen lds
    s_mov_b32 m0, 156672
    s_mov_b32 s73, 358400
    buffer_load_dwordx4 v8, s[40:43], s73 offen lds
    s_mov_b32 m0, 160768
    s_mov_b32 s73, 387072
    buffer_load_dwordx4 v8, s[40:43], s73 offen lds
lr2_nowo:
    s_barrier
    s_barrier
    s_cmp_ge_u32 s30, 7
    s_cbranch_scc1 lr2_end
    v_lshlrev_b32 v9, 4, v0
    v_add_u32 v9, 57344, v9
    ds_write_b128 v9, v[52:55] offset:0
    ds_write_b128 v9, v[56:59] offset:1024
    ds_write_b128 v9, v[60:63] offset:2048
    ds_write_b128 v9, v[64:67] offset:3072
    ds_write_b128 v9, v[68:71] offset:4096
    ds_write_b128 v9, v[72:75] offset:5120
    ds_write_b128 v9, v[76:79] offset:6144
    ds_write_b128 v9, v[80:83] offset:7168
    ds_write_b128 v9, v[84:87] offset:8192
    ds_write_b128 v9, v[88:91] offset:9216
    ds_write_b128 v9, v[92:95] offset:10240
    ds_write_b128 v9, v[96:99] offset:11264
    ds_write_b128 v9, v[100:103] offset:12288
    ds_write_b128 v9, v[104:107] offset:13312
    ds_write_b128 v9, v[108:111] offset:14336
    ds_write_b128 v9, v[112:115] offset:15360
    ds_write_b128 v9, v[116:119] offset:16384
    ds_write_b128 v9, v[120:123] offset:17408
    ds_write_b128 v9, v[124:127] offset:18432
    ds_write_b128 v9, v[128:131] offset:19456
    ds_write_b128 v9, v[132:135] offset:20480
    ds_write_b128 v9, v[136:139] offset:21504
    ds_write_b128 v9, v[140:143] offset:22528
    ds_write_b128 v9, v[144:147] offset:23552
    ds_write_b128 v9, v[148:151] offset:24576
    ds_write_b128 v9, v[152:155] offset:25600
    ds_write_b128 v9, v[156:159] offset:26624
    ds_write_b128 v9, v[160:163] offset:27648
    s_waitcnt vmcnt(0) lgkmcnt(0)
    s_barrier
    s_barrier
    s_waitcnt lgkmcnt(0)
    s_barrier
lr2_end:
    s_endpgm
f_lr3:
    s_mov_b32 s40, s12
    s_mov_b32 s41, s13
    s_mov_b32 s42, 0x62000
    s_mov_b32 s43, 0x20000
    s_mov_b32 s36, s18
    s_mov_b32 s37, s19
    s_mov_b32 s38, 0x800000
    s_mov_b32 s39, 0x20000
    s_mov_b32 s32, s22
    s_mov_b32 s33, s23
    s_mov_b32 s34, 0xc4000
    s_mov_b32 s35, 0x20000
    v_lshrrev_b32 v8, 3, v0
    v_mul_u32_u24 v8, 896, v8
    v_bfe_u32 v20, v0, 1, 2
    v_lshrrev_b32 v21, 4, v0
    v_xor_b32 v20, v20, v21
    v_lshl_add_u32 v8, v20, 5, v8
    v_and_b32 v20, 1, v0
    v_lshl_add_u32 v8, v20, 4, v8
    s_lshl_b32 s72, s30, 7
    v_add_u32 v8, s72, v8
    s_mov_b32 s68, 0
    s_bfe_u32 s68, s2, 0x10001
    s_lshl_b32 s68, s68, 3
    v_lshlrev_b32 v13, 4, v0
    s_mul_i32 s74, s6, 1835008
    s_mul_i32 s75, s5, 7168
    s_add_u32 s74, s74, s75
    s_add_u32 s74, s74, 1105920
    s_mul_i32 s75, s68, 114688
    s_add_u32 s74, s74, s75
    s_mov_b32 s70, 114688
    s_add_u32 s75, s74, 4096
    s_lshl_b32 s78, s5, 14
    s_lshl_b32 s79, s6, 13
    s_add_u32 s78, s78, s79
    s_add_u32 s78, s78, 21037056
    v_add_u32 v15, s68, v0
    v_and_b32 v15, 15, v15
    v_lshlrev_b32 v15, 1, v15
    v_add_u32 v15, 1, v15
    s_mov_b32 s83, 0
    v_lshlrev_b32 v15, 8, v15
    s_mov_b64 s[80:81], 0
    s_mov_b32 s55, 40000
    s_mov_b32 s64, 0
    s_cmp_ge_u32 s53, 8
    s_cbranch_scc1 lr3_noimg
    s_cmp_ge_u32 s30, 7
    s_cbranch_scc1 lr3_noimg
    s_mov_b32 s73, 602112
    buffer_load_dwordx4 v[52:55], v8, s[32:35], s73 offen
    s_mov_b32 s73, 609280
    buffer_load_dwordx4 v[56:59], v8, s[32:35], s73 offen
    s_mov_b32 s73, 616448
    buffer_load_dwordx4 v[60:63], v8, s[32:35], s73 offen
    s_mov_b32 s73, 623616
    buffer_load_dwordx4 v[64:67], v8, s[32:35], s73 offen
    s_mov_b32 s73, 630784
    buffer_load_dwordx4 v[68:71], v8, s[32:35], s73 offen
    s_mov_b32 s73, 637952
    buffer_load_dwordx4 v[72:75], v8, s[32:35], s73 offen
    s_mov_b32 s73, 645120
    buffer_load_dwordx4 v[76:79], v8, s[32:35], s73 offen
    s_mov_b32 s73, 652288
    buffer_load_dwordx4 v[80:83], v8, s[32:35], s73 offen
    s_mov_b32 s73, 659456
    buffer_load_dwordx4 v[84:87], v8, s[32:35], s73 offen
    s_mov_b32 s73, 666624
    buffer_load_dwordx4 v[88:91], v8, s[32:35], s73 offen
    s_mov_b32 s73, 673792
    buffer_load_dwordx4 v[92:95], v8, s[32:35], s73 offen
    s_mov_b32 s73, 680960
    buffer_load_dwordx4 v[96:99], v8, s[32:35], s73 offen
    s_mov_b32 s73, 688128
    buffer_load_dwordx4 v[100:103], v8, s[32:35], s73 offen
    s_mov_b32 s73, 695296
    buffer_load_dwordx4 v[104:107], v8, s[32:35], s73 offen
    s_mov_b32 s73, 702464
    buffer_load_dwordx4 v[108:111], v8, s[32:35], s73 offen
    s_mov_b32 s73, 709632
    buffer_load_dwordx4 v[112:115], v8, s[32:35], s73 offen
    s_mov_b32 s73, 716800
    buffer_load_dwordx4 v[116:119], v8, s[32:35], s73 offen
    s_mov_b32 s73, 723968
    buffer_load_dwordx4 v[120:123], v8, s[32:35], s73 offen
    s_mov_b32 s73, 731136
    buffer_load_dwordx4 v[124:127], v8, s[32:35], s73 offen
    s_mov_b32 s73, 738304
    buffer_load_dwordx4 v[128:131], v8, s[32:35], s73 offen
    s_mov_b32 s73, 745472
    buffer_load_dwordx4 v[132:135], v8, s[32:35], s73 offen
    s_mov_b32 s73, 752640
    buffer_load_dwordx4 v[136:139], v8, s[32:35], s73 offen
    s_mov_b32 s73, 759808
    buffer_load_dwordx4 v[140:143], v8, s[32:35], s73 offen
    s_mov_b32 s73, 766976
    buffer_load_dwordx4 v[144:147], v8, s[32:35], s73 offen
    s_mov_b32 s73, 774144
    buffer_load_dwordx4 v[148:151], v8, s[32:35], s73 offen
    s_mov_b32 s73, 781312
    buffer_load_dwordx4 v[152:155], v8, s[32:35], s73 offen
    s_mov_b32 s73, 788480
    buffer_load_dwordx4 v[156:159], v8, s[32:35], s73 offen
    s_mov_b32 s73, 795648
    buffer_load_dwordx4 v[160:163], v8, s[32:35], s73 offen
lr3_noimg:
    s_barrier
lr3_z1_chk:
    s_bitcmp1_b64 s[80:81], s83
    s_cbranch_scc1 lr3_z1_ok
    s_cmp_eq_u32 s55, 0
    s_cbranch_scc1 lr3_z1_ok
    s_sub_u32 s55, s55, 1
    s_mov_b64 exec, 0x7
    buffer_load_dwordx2 v[16:17], v15, s[44:47], s78 offen sc1
    s_waitcnt vmcnt(0)
    v_cmp_eq_u32 vcc, s60, v16
    v_cmp_eq_u32 s[90:91], s61, v17
    s_mov_b64 exec, -1
    s_and_b64 s[80:81], vcc, s[90:91]
    s_branch lr3_z1_chk
lr3_z1_ok:
    s_add_u32 m0, s64, 89088
    s_nop 0
    buffer_load_dwordx4 v13, s[44:47], s74 offen offset:0 lds
    buffer_load_dwordx4 v13, s[44:47], s74 offen offset:1024 lds
    buffer_load_dwordx4 v13, s[44:47], s74 offen offset:2048 lds
    buffer_load_dwordx4 v13, s[44:47], s74 offen offset:3072 lds
    s_add_u32 m0, s64, 93184
    s_nop 0
    buffer_load_dwordx4 v13, s[44:47], s75 offen offset:0 lds
    buffer_load_dwordx4 v13, s[44:47], s75 offen offset:1024 lds
    buffer_load_dwordx4 v13, s[44:47], s75 offen offset:2048 lds
    s_add_u32 s83, s83, 1
    s_add_u32 s68, s68, 1
    s_and_b32 s68, s68, 15
    s_cselect_b32 s69, s70, -1720320
    s_add_u32 s74, s74, s69
    s_add_u32 s75, s75, s69
    s_add_u32 s64, s64, 14336
    s_cmp_eq_u32 s64, 71680
    s_cselect_b32 s64, 0, s64
lr3_z2_chk:
    s_bitcmp1_b64 s[80:81], s83
    s_cbranch_scc1 lr3_z2_ok
    s_cmp_eq_u32 s55, 0
    s_cbranch_scc1 lr3_z2_ok
    s_sub_u32 s55, s55, 1
    s_mov_b64 exec, 0x7
    buffer_load_dwordx2 v[16:17], v15, s[44:47], s78 offen sc1
    s_waitcnt vmcnt(0)
    v_cmp_eq_u32 vcc, s60, v16
    v_cmp_eq_u32 s[90:91], s61, v17
    s_mov_b64 exec, -1
    s_and_b64 s[80:81], vcc, s[90:91]
    s_branch lr3_z2_chk
lr3_z2_ok:
    s_add_u32 m0, s64, 89088
    s_nop 0
    buffer_load_dwordx4 v13, s[44:47], s74 offen offset:0 lds
    buffer_load_dwordx4 v13, s[44:47], s74 offen offset:1024 lds
    buffer_load_dwordx4 v13, s[44:47], s74 offen offset:2048 lds
    buffer_load_dwordx4 v13, s[44:47], s74 offen offset:3072 lds
    s_add_u32 m0, s64, 93184
    s_nop 0
    buffer_load_dwordx4 v13, s[44:47], s75 offen offset:0 lds
    buffer_load_dwordx4 v13, s[44:47], s75 offen offset:1024 lds
    buffer_load_dwordx4 v13, s[44:47], s75 offen offset:2048 lds
    s_add_u32 s83, s83, 1
    s_add_u32 s68, s68, 1
    s_and_b32 s68, s68, 15
    s_cselect_b32 s69, s70, -1720320
    s_add_u32 s74, s74, s69
    s_add_u32 s75, s75, s69
    s_add_u32 s64, s64, 14336
    s_cmp_eq_u32 s64, 71680
    s_cselect_b32 s64, 0, s64
lr3_z3_chk:
    s_bitcmp1_b64 s[80:81], s83
    s_cbranch_scc1 lr3_z3_ok
    s_cmp_eq_u32 s55, 0
    s_cbranch_scc1 lr3_z3_ok
    s_sub_u32 s55, s55, 1
    s_mov_b64 exec, 0x7
    buffer_load_dwordx2 v[16:17], v15, s[44:47], s78 offen sc1
    s_waitcnt vmcnt(0)
    v_cmp_eq_u32 vcc, s60, v16
    v_cmp_eq_u32 s[90:91], s61, v17
    s_mov_b64 exec, -1
    s_and_b64 s[80:81], vcc, s[90:91]
    s_branch lr3_z3_chk
lr3_z3_ok:
    s_add_u32 m0, s64, 89088
    s_nop 0
    buffer_load_dwordx4 v13, s[44:47], s74 offen offset:0 lds
    buffer_load_dwordx4 v13, s[44:47], s74 offen offset:1024 lds
    buffer_load_dwordx4 v13, s[44:47], s74 offen offset:2048 lds
    buffer_load_dwordx4 v13, s[44:47], s74 offen offset:3072 lds
    s_add_u32 m0, s64, 93184
    s_nop 0
    buffer_load_dwordx4 v13, s[44:47], s75 offen offset:0 lds
    buffer_load_dwordx4 v13, s[44:47], s75 offen offset:1024 lds
    buffer_load_dwordx4 v13, s[44:47], s75 offen offset:2048 lds
    s_add_u32 s83, s83, 1
    s_add_u32 s68, s68, 1
    s_and_b32 s68, s68, 15
    s_cselect_b32 s69, s70, -1720320
    s_add_u32 s74, s74, s69
    s_add_u32 s75, s75, s69
    s_add_u32 s64, s64, 14336
    s_cmp_eq_u32 s64, 71680
    s_cselect_b32 s64, 0, s64
    s_mov_b64 exec, 0xffff
    buffer_load_dwordx2 v[18:19], v15, s[44:47], s78 offen sc1
    s_mov_b64 exec, -1
    s_waitcnt vmcnt(15)
    s_barrier
    s_waitcnt vmcnt(0)
    v_cmp_eq_u32 vcc, s60, v18
    v_cmp_eq_u32 s[90:91], s61, v19
    s_and_b64 s[80:81], vcc, s[90:91]
    s_and_b32 s80, s80, 0xffff
    s_mov_b32 s81, 0
    s_mov_b32 s65, 13
lr3_loop:
lr3_z4_chk:
    s_bitcmp1_b64 s[80:81], s83
    s_cbranch_scc1 lr3_z4_ok
    s_cmp_eq_u32 s55, 0
    s_cbranch_scc1 lr3_z4_ok
    s_sub_u32 s55, s55, 1
    s_mov_b64 exec, 0xffff
    buffer_load_dwordx2 v[16:17], v15, s[44:47], s78 offen sc1
    s_waitcnt vmcnt(0)
    v_cmp_eq_u32 vcc, s60, v16
    v_cmp_eq_u32 s[90:91], s61, v17
    s_mov_b64 exec, -1
    s_and_b64 s[80:81], vcc, s[90:91]
    s_branch lr3_z4_chk
lr3_z4_ok:
    s_add_u32 m0, s64, 89088
    s_nop 0
    buffer_load_dwordx4 v13, s[44:47], s74 offen offset:0 lds
    buffer_load_dwordx4 v13, s[44:47], s74 offen offset:1024 lds
    buffer_load_dwordx4 v13, s[44:47], s74 offen offset:2048 lds
    buffer_load_dwordx4 v13, s[44:47], s74 offen offset:3072 lds
    s_add_u32 m0, s64, 93184
    s_nop 0
    buffer_load_dwordx4 v13, s[44:47], s75 offen offset:0 lds
    buffer_load_dwordx4 v13, s[44:47], s75 offen offset:1024 lds
    buffer_load_dwordx4 v13, s[44:47], s75 offen offset:2048 lds
    s_add_u32 s83, s83, 1
    s_add_u32 s68, s68, 1
    s_and_b32 s68, s68, 15
    s_cselect_b32 s69, s70, -1720320
    s_add_u32 s74, s74, s69
    s_add_u32 s75, s75, s69
    s_add_u32 s64, s64, 14336
    s_cmp_eq_u32 s64, 71680
    s_cselect_b32 s64, 0, s64
    s_waitcnt vmcnt(14)
    s_barrier
    s_sub_u32 s65, s65, 1
    s_cmp_lg_u32 s65, 0
    s_cbranch_scc1 lr3_loop
    s_waitcnt vmcnt(7)
    s_barrier
    s_waitcnt vmcnt(0)
    s_barrier
    s_cmp_ge_u32 s30, 7
    s_cbranch_scc1 lr3_nowo
    s_mov_b32 m0, 108544
    s_mov_b32 s73, 21504
    buffer_load_dwordx4 v8, s[40:43], s73 offen lds
    s_mov_b32 m0, 112640
    s_mov_b32 s73, 50176
    buffer_load_dwordx4 v8, s[40:43], s73 offen lds
    s_mov_b32 m0, 116736
    s_mov_b32 s73, 78848
    buffer_load_dwordx4 v8, s[40:43], s73 offen lds
    s_mov_b32 m0, 120832
    s_mov_b32 s73, 107520
    buffer_load_dwordx4 v8, s[40:43], s73 offen lds
    s_mov_b32 m0, 124928
    s_mov_b32 s73, 136192
    buffer_load_dwordx4 v8, s[40:43], s73 offen lds
    s_mov_b32 m0, 129024
    s_mov_b32 s73, 164864
    buffer_load_dwordx4 v8, s[40:43], s73 offen lds
    s_mov_b32 m0, 133120
    s_mov_b32 s73, 193536
    buffer_load_dwordx4 v8, s[40:43], s73 offen lds
    s_mov_b32 m0, 137216
    s_mov_b32 s73, 222208
    buffer_load_dwordx4 v8, s[40:43], s73 offen lds
    s_mov_b32 m0, 141312
    s_mov_b32 s73, 250880
    buffer_load_dwordx4 v8, s[40:43], s73 offen lds
    s_mov_b32 m0, 145408
    s_mov_b32 s73, 279552
    buffer_load_dwordx4 v8, s[40:43], s73 offen lds
    s_mov_b32 m0, 149504
    s_mov_b32 s73, 308224
    buffer_load_dwordx4 v8, s[40:43], s73 offen lds
    s_mov_b32 m0, 153600
    s_mov_b32 s73, 336896
    buffer_load_dwordx4 v8, s[40:43], s73 offen lds
    s_mov_b32 m0, 157696
    s_mov_b32 s73, 365568
    buffer_load_dwordx4 v8, s[40:43], s73 offen lds
    s_mov_b32 m0, 161792
    s_mov_b32 s73, 394240
    buffer_load_dwordx4 v8, s[40:43], s73 offen lds
lr3_nowo:
    s_barrier
    s_barrier
    s_cmp_ge_u32 s30, 7
    s_cbranch_scc1 lr3_end
    v_lshlrev_b32 v9, 4, v0
    v_add_u32 v9, 86016, v9
    ds_write_b128 v9, v[52:55] offset:0
    ds_write_b128 v9, v[56:59] offset:1024
    ds_write_b128 v9, v[60:63] offset:2048
    ds_write_b128 v9, v[64:67] offset:3072
    ds_write_b128 v9, v[68:71] offset:4096
    ds_write_b128 v9, v[72:75] offset:5120
    ds_write_b128 v9, v[76:79] offset:6144
    ds_write_b128 v9, v[80:83] offset:7168
    ds_write_b128 v9, v[84:87] offset:8192
    ds_write_b128 v9, v[88:91] offset:9216
    ds_write_b128 v9, v[92:95] offset:10240
    ds_write_b128 v9, v[96:99] offset:11264
    ds_write_b128 v9, v[100:103] offset:12288
    ds_write_b128 v9, v[104:107] offset:13312
    ds_write_b128 v9, v[108:111] offset:14336
    ds_write_b128 v9, v[112:115] offset:15360
    ds_write_b128 v9, v[116:119] offset:16384
    ds_write_b128 v9, v[120:123] offset:17408
    ds_write_b128 v9, v[124:127] offset:18432
    s_waitcnt vmcnt(0) lgkmcnt(0)
    s_barrier
    s_barrier
    ds_write_b128 v9, v[128:131] offset:19456
    ds_write_b128 v9, v[132:135] offset:20480
    ds_write_b128 v9, v[136:139] offset:21504
    ds_write_b128 v9, v[140:143] offset:22528
    ds_write_b128 v9, v[144:147] offset:23552
    ds_write_b128 v9, v[148:151] offset:24576
    ds_write_b128 v9, v[152:155] offset:25600
    ds_write_b128 v9, v[156:159] offset:26624
    ds_write_b128 v9, v[160:163] offset:27648
    s_waitcnt lgkmcnt(0)
    s_barrier
lr3_end:
    s_endpgm
f_end:
    s_endpgm

.section .rodata,"a"
.p2align 6
.amdhsa_kernel parallel_sum__sliding_local_dilated__mixer_gmlp__prompt_kernel
  .amdhsa_next_free_vgpr 168
  .amdhsa_next_free_sgpr 102
  .amdhsa_accum_offset 168
  .amdhsa_group_segment_fixed_size 0
  .amdhsa_kernarg_size 88
  .amdhsa_user_sgpr_count 2
  .amdhsa_user_sgpr_kernarg_segment_ptr 1
  .amdhsa_system_sgpr_workgroup_id_x 1
.end_amdhsa_kernel
```
